```python
import torch

def _softmax(x, axis=-1):
    return torch.softmax(x, dim=axis)
def _gelu(x):
    return torch.nn.functional.gelu(x, approximate="tanh")
def _silu(x):
    return torch.nn.functional.silu(x)
def _sigmoid(x):
    return torch.sigmoid(x)
def _layernorm(x, axis=-1, eps=1e-5):
    m = x.mean(dim=axis, keepdim=True)
    v = x.var(dim=axis, keepdim=True, unbiased=False)
    return (x - m) / torch.sqrt(v + eps)
def _scatter_add(tgt, idx, src, axis=0):
    return tgt.clone().index_add_(axis, idx, src)
def _segment_sum(src, seg, n):
    out = torch.zeros((n,) + src.shape[1:], dtype=src.dtype)
    return out.index_add_(0, seg, src)
def _pad(x, pw):
    flat = tuple(v for pair in reversed(pw) for v in pair)
    return torch.nn.functional.pad(x, flat)

kernel_name = 'standalone__gqa_block_cached__near_ridge'

def setup_inputs():

    _w = (lambda a: (lambda t: t.to(torch.bfloat16) if t.is_floating_point() else t)(torch.as_tensor(a)))
    B, Sq, D = 16, 192, 512
    Hq, Hkv, Sk, Dh = 32, 32, 512, 128
    assert Hq % Hkv == 0, (Hq, Hkv)
    return {
        "x": _w((lambda *s: torch.randn(*s, dtype=torch.bfloat16) * 0.8)(B, Sq, D)),
        "k_cache": _w((lambda *s: torch.randn(*s, dtype=torch.bfloat16) * 0.8)(B, Hkv, Sk, Dh)),
        "v_cache": _w((lambda *s: torch.randn(*s, dtype=torch.bfloat16) * 0.05)(B, Hkv, Sk, Dh)),
        "wq": _w((lambda *s: torch.randn(*s, dtype=torch.bfloat16) * 0.8)(D, Hq * Dh) * (D ** -0.5)),
        "wo": _w((lambda *s: torch.randn(*s, dtype=torch.bfloat16) * 0.05)(Hq * Dh, D) * ((Hq * Dh) ** -0.5)),
    }

def reference(x, k_cache, v_cache, wq, wo):
    B, Sq, D = x.shape
    Hq, Dh = 32, 128
    Hkv = k_cache.shape[1]
    rep = Hq // Hkv
    q = (lambda x, *d: x.permute(*d))((x @ wq).reshape(B, Sq, Hq, Dh), 0, 2, 1, 3)
    k = (lambda x, n, axis: torch.repeat_interleave(x, n, dim=axis))(k_cache, rep, axis=1)
    v = (lambda x, n, axis: torch.repeat_interleave(x, n, dim=axis))(v_cache, rep, axis=1)
    scores = torch.einsum("bhqd,bhkd->bhqk", q, k) * (Dh ** -0.5)
    p = _softmax(scores, axis=-1)
    o = torch.einsum("bhqk,bhkd->bhqd", p, v)
    return (lambda x, *d: x.permute(*d))(o, 0, 2, 1, 3).reshape(B, Sq, Hq * Dh) @ wo
```

```asm
; @launch grid=(256,1,1) block=(256,1,1) lds=163840
.amdgcn_target "amdgcn-amd-amdhsa--gfx950"
.text
.globl standalone__gqa_block_cached__near_ridge_kernel
.p2align 8
.type standalone__gqa_block_cached__near_ridge_kernel,@function
standalone__gqa_block_cached__near_ridge_kernel:
  s_cmp_ge_u32 s2, 256
  s_cbranch_scc1 L_end
  s_load_dwordx16 s[4:19], s[0:1], 0
  s_getpc_b64 s[64:65]
L_pc:
  s_lshr_b32 s66, s2, 3
  s_and_b32 s66, s66, 1
  s_lshl_b32 s66, s66, 15
  v_lshl_add_u32 v56, v0, 7, s66
  v_min_u32 v56, L_cend-L_pc-4, v56
  v_mov_b32 v57, s65
  v_add_co_u32 v56, vcc, s64, v56
  s_nop 1
  v_addc_co_u32 v57, vcc, 0, v57, vcc
  global_load_dword v59, v[56:57], off
  v_lshrrev_b32 v2, 6, v0
  v_and_b32 v1, 63, v0
  v_readfirstlane_b32 s3, v2
  s_and_b32 s64, s2, 7
  s_lshr_b32 s65, s2, 3
  s_and_b32 s66, s64, 1
  s_lshl_b32 s66, s66, 3
  s_lshr_b32 s67, s65, 2
  s_add_u32 s52, s66, s67
  s_lshr_b32 s53, s64, 1
  s_and_b32 s54, s65, 3
  s_mul_i32 s67, s67, 2
  s_mul_i32 s66, s54, 4
  s_add_u32 s59, s67, s66
  s_and_b32 s59, s59, 15
  s_lshl_b32 s58, s59, 6
  s_lshl_b32 s59, s59, 18
  v_lshrrev_b32 v28, 2, v1
  v_lshlrev_b32 v28, 10, v28
  v_and_b32 v29, 3, v1
  v_lshl_add_u32 v28, v29, 4, v28
  s_mul_i32 s66, s3, 49152
  v_add_u32 v2, s66, v28
  v_add_u32 v3, 0x4000, v2
  v_add_u32 v4, 0x8000, v2
  v_lshrrev_b32 v28, 5, v1
  v_lshlrev_b32 v28, 13, v28
  v_and_b32 v29, 31, v1
  v_lshl_add_u32 v28, v29, 4, v28
  s_lshl_b32 s66, s3, 16
  v_add_u32 v5, s66, v28
  v_add_u32 v6, 0x4000, v5
  v_add_u32 v7, 0x8000, v5
  v_add_u32 v8, 0xc000, v5
  s_mul_i32 s66, s52, 196608
  s_lshl_b32 s67, s53, 2
  s_add_u32 s67, s67, s54
  s_lshl_b32 s67, s67, 9
  s_waitcnt lgkmcnt(0)
  s_add_u32 s24, s10, s67
  s_addc_u32 s25, s11, 0
  s_mov_b32 s26, 0x3fe200
  s_mov_b32 s27, 0x20000
  s_add_u32 s20, s4, s66
  s_addc_u32 s21, s5, 0
  s_mov_b32 s22, 0x30000
  s_mov_b32 s23, 0x20000
  buffer_load_dwordx4 a[224:227], v5, s[24:27], s59 offen
  buffer_load_dwordx4 a[228:231], v6, s[24:27], s59 offen
  buffer_load_dwordx4 a[232:235], v7, s[24:27], s59 offen
  buffer_load_dwordx4 a[236:239], v8, s[24:27], s59 offen
  buffer_load_dwordx4 a[240:243], v2, s[20:23], s58 offen
  buffer_load_dwordx4 a[212:215], v2, s[20:23], s58 offen offset:64
  buffer_load_dwordx4 a[244:247], v3, s[20:23], s58 offen
  buffer_load_dwordx4 a[216:219], v3, s[20:23], s58 offen offset:64
  buffer_load_dwordx4 a[248:251], v4, s[20:23], s58 offen
  buffer_load_dwordx4 a[220:223], v4, s[20:23], s58 offen offset:64
  s_add_u32 s59, s59, 0x40000
  s_and_b32 s59, s59, 0x3fffff
  s_lshr_b32 s58, s59, 12
  buffer_load_dwordx4 a[196:199], v5, s[24:27], s59 offen
  buffer_load_dwordx4 a[200:203], v6, s[24:27], s59 offen
  buffer_load_dwordx4 a[204:207], v7, s[24:27], s59 offen
  buffer_load_dwordx4 a[208:211], v8, s[24:27], s59 offen
  s_add_u32 s59, s59, 0x40000
  s_and_b32 s59, s59, 0x3fffff
  s_lshr_b32 s58, s59, 12
  s_lshr_b32 s64, s3, 1
  s_and_b32 s65, s3, 1
  s_mul_i32 s62, s64, 17408
  s_mul_i32 s66, s65, 8704
  s_add_u32 s62, s62, s66
  s_cmp_eq_u32 s65, 0
  s_cselect_b32 s60, s6, s8
  s_cselect_b32 s61, s7, s9
  s_lshl_b32 s66, s52, 2
  s_add_u32 s66, s66, s53
  s_lshl_b32 s67, s66, 2
  s_add_u32 s67, s67, s54
  s_lshl_b32 s67, s67, 1
  s_add_u32 s67, s67, s64
  s_lshl_b32 s67, s67, 17
  s_add_u32 s28, s60, s67
  s_addc_u32 s29, s61, 0
  s_mov_b32 s30, 0x20000
  s_mov_b32 s31, 0x20000
  v_lshrrev_b32 v28, 4, v1
  s_xor_b32 s66, s65, 1
  v_mul_u32_u24 v28, s66, v28
  v_xor_b32 v28, v28, v1
  v_lshlrev_b32 v18, 4, v28
  v_lshrrev_b32 v28, 4, v1
  v_and_b32 v29, 3, v1
  v_xor_b32 v28, v28, v29
  v_lshlrev_b32 v28, 4, v28
  v_lshrrev_b32 v29, 2, v1
  v_lshl_add_u32 v28, v29, 6, v28
  s_mul_i32 s66, s3, 3072
  s_add_u32 s66, s66, 104448
  v_add_u32 v9, s66, v28
  v_lshrrev_b32 v28, 5, v1
  v_lshlrev_b32 v29, 2, v28
  v_and_b32 v30, 15, v1
  v_xor_b32 v29, v29, v30
  v_lshlrev_b32 v29, 4, v29
  v_lshl_add_u32 v29, v28, 8, v29
  v_bfe_u32 v28, v1, 4, 1
  v_lshl_add_u32 v29, v28, 13, v29
  s_lshl_b32 s66, s3, 11
  s_add_u32 s66, s66, 104448
  v_add_u32 v10, s66, v29
  v_xor_b32 v11, 0x80, v10
  v_lshrrev_b32 v28, 5, v1
  v_bfe_u32 v29, v1, 2, 2
  v_xor_b32 v28, v28, v29
  v_lshlrev_b32 v28, 4, v28
  v_and_b32 v29, 31, v1
  v_lshl_add_u32 v28, v29, 6, v28
  s_mul_i32 s66, s65, 6144
  s_add_u32 s66, s66, 104448
  v_add_u32 v12, s66, v28
  v_xor_b32 v13, 32, v12
  v_bfe_u32 v28, v1, 2, 2
  v_lshrrev_b32 v29, 5, v1
  v_lshl_add_u32 v29, v29, 3, v28
  v_lshlrev_b32 v29, 8, v29
  v_lshl_add_u32 v29, v28, 6, v29
  v_bfe_u32 v28, v1, 4, 1
  v_lshl_add_u32 v29, v28, 5, v29
  v_and_b32 v28, 1, v1
  v_lshl_add_u32 v29, v28, 4, v29
  v_bfe_u32 v28, v1, 1, 1
  v_lshl_add_u32 v29, v28, 3, v29
  s_lshl_b32 s66, s64, 13
  s_add_u32 s66, s66, 104448
  v_add_u32 v14, s66, v29
  v_xor_b32 v15, 64, v14
  v_xor_b32 v16, 128, v14
  v_xor_b32 v17, 192, v14
  s_mov_b32 s55, 0x3e0293ee
  v_mov_b32 v31, 0x44800000
  s_mov_b32 s1, 0x3f803f80
  s_lshl_b32 s66, s52, 2
  s_add_u32 s66, s66, s53
  s_lshl_b32 s67, s66, 4
  s_add_u32 s67, s67, s3
  s_mul_i32 s67, s67, 24576
  s_add_u32 s32, s18, s67
  s_addc_u32 s33, s19, 0
  s_mov_b32 s34, 0x4e000
  s_mov_b32 s35, 0x20000
  s_lshl_b32 s67, s66, 2
  s_add_u32 s67, s67, s3
  s_lshl_b32 s67, s67, 7
  s_add_u32 s67, s67, 0x4000000
  s_add_u32 s44, s18, s67
  s_addc_u32 s45, s19, 0
  s_mov_b32 s46, 0x10
  s_mov_b32 s47, 0x20000
  s_lshl_b32 s67, s52, 2
  s_add_u32 s67, s67, s54
  s_lshl_b32 s67, s67, 4
  s_add_u32 s67, s67, s3
  s_mul_i32 s67, s67, 9344
  s_add_u32 s67, s67, 0x2000000
  s_add_u32 s40, s18, s67
  s_addc_u32 s41, s19, 0
  s_mov_b32 s42, 0x1da80
  s_mov_b32 s43, 0x20000
  s_lshl_b32 s67, s52, 4
  s_add_u32 s48, s16, s67
  s_addc_u32 s49, s17, 0
  s_mov_b32 s50, 0x10
  s_mov_b32 s51, 0x20000
  s_lshl_b32 s67, s53, 3
  s_add_u32 s67, s67, s64
  s_lshl_b32 s67, s67, 17
  s_lshl_b32 s66, s54, 8
  s_add_u32 s67, s67, s66
  s_add_u32 s36, s12, s67
  s_addc_u32 s37, s13, 0
  s_mov_b32 s38, 0xdfd00
  s_mov_b32 s39, 0x20000
  s_lshl_b32 s75, s54, 2
  s_lshl_b32 s76, s53, 2
  s_lshl_b32 s63, s65, 11
  s_lshl_b32 s66, s64, 10
  s_add_u32 s63, s63, s66
  s_xor_b32 s74, s53, 3
  s_xor_b32 s66, s74, 0
  s_mul_i32 s66, s66, 37376
  s_add_u32 s68, s66, 0
  s_xor_b32 s66, s74, 1
  s_mul_i32 s66, s66, 37376
  s_add_u32 s69, s66, 3072
  s_xor_b32 s66, s74, 2
  s_mul_i32 s66, s66, 37376
  s_add_u32 s70, s66, 6144
  s_mul_i32 s71, s53, 37376
  s_xor_b32 s66, s54, 0
  s_mul_i32 s77, s66, 98304
  s_xor_b32 s66, s54, 1
  s_mul_i32 s78, s66, 98304
  s_xor_b32 s66, s54, 2
  s_mul_i32 s79, s66, 98304
  s_xor_b32 s66, s54, 3
  s_mul_i32 s17, s66, 98304
  s_xor_b32 s67, s74, s65
  s_lshl_b32 s67, s67, 6
  s_lshl_b32 s73, s74, 6
  s_lshl_b32 s72, s65, 14
  s_add_u32 s73, s73, s72
  s_xor_b32 s66, s54, 0
  s_lshl_b32 s66, s66, 18
  s_add_u32 s4, s66, s67
  s_xor_b32 s5, s4, 128
  s_xor_b32 s66, s54, 1
  s_lshl_b32 s66, s66, 18
  s_add_u32 s6, s66, s67
  s_add_u32 s66, s66, s73
  s_xor_b32 s9, s66, 128
  s_xor_b32 s12, s66, 192
  s_xor_b32 s66, s54, 2
  s_lshl_b32 s66, s66, 18
  s_add_u32 s7, s66, s67
  s_add_u32 s66, s66, s73
  s_xor_b32 s10, s66, 128
  s_xor_b32 s13, s66, 192
  s_xor_b32 s66, s54, 3
  s_lshl_b32 s66, s66, 18
  s_add_u32 s8, s66, s67
  s_add_u32 s66, s66, s73
  s_xor_b32 s11, s66, 128
  s_xor_b32 s16, s66, 192
  s_getreg_b32 s66, hwreg(HW_REG_XCC_ID, 0, 4)
  s_and_b32 s66, s66, 7
  s_mul_i32 s66, s66, 3
  s_lshl_b32 s72, 1, s66
  s_or_b32 s72, s72, 0x1000000
  v_bfe_u32 v28, v1, 4, 1
  v_and_b32 v29, 3, v1
  v_lshl_add_u32 v28, v28, 2, v29
  v_mul_u32_u24 v28, 0x440, v28
  v_bfe_u32 v29, v1, 2, 1
  v_bfe_u32 v30, v1, 3, 1
  v_lshl_add_u32 v29, v29, 1, v30
  v_lshl_add_u32 v28, v29, 8, v28
  v_lshrrev_b32 v30, 5, v1
  v_xor_b32 v30, v30, v29
  s_mul_i32 s66, s64, 17408
  v_add_u32 v28, s66, v28
  v_lshl_add_u32 v19, v30, 4, v28
  v_xor_b32 v30, 2, v30
  v_lshl_add_u32 v20, v30, 4, v28
  v_add_u32 v21, 0x11000, v19
  v_add_u32 v22, 0x11000, v20
  v_bfe_u32 v28, v1, 2, 2
  v_mul_u32_u24 v28, 0x440, v28
  v_lshrrev_b32 v29, 5, v1
  v_lshl_add_u32 v28, v29, 9, v28
  v_bfe_u32 v29, v1, 4, 1
  v_lshl_add_u32 v28, v29, 5, v28
  v_and_b32 v29, 3, v1
  v_lshl_add_u32 v28, v29, 3, v28
  s_add_u32 s66, s66, 8704
  v_add_u32 v23, s66, v28
  v_add_u32 v24, 0x11000, v23
  v_lshlrev_b32 v25, 4, v1
  v_mov_b32 v26, 0
  v_mov_b32 v60, -1
  v_mov_b32 v61, -1
  v_mov_b32 v62, -1
  v_mov_b32 v63, -1
  v_lshlrev_b32 v27, 7, v1
  s_waitcnt vmcnt(13)
  ds_write_b128 v10, a[224:227] offset:0
  s_waitcnt vmcnt(12)
  ds_write_b128 v11, a[228:231] offset:512
  s_waitcnt vmcnt(11)
  ds_write_b128 v10, a[232:235] offset:1024
  s_waitcnt vmcnt(10)
  ds_write_b128 v11, a[236:239] offset:1536
  s_waitcnt vmcnt(9)
  ds_write_b128 v9, a[240:243] offset:32768
  s_waitcnt vmcnt(7)
  ds_write_b128 v9, a[244:247] offset:33792
  s_waitcnt vmcnt(5)
  ds_write_b128 v9, a[248:251] offset:34816
  s_waitcnt lgkmcnt(0)
  s_barrier
  ds_read_b128 a[16:19], v12 offset:32768
  ds_read_b64_tr_b16 a[0:1], v14 offset:0
  ds_read_b64_tr_b16 a[2:3], v14 offset:1024
  ds_read_b64_tr_b16 a[4:5], v15 offset:0
  ds_read_b64_tr_b16 a[6:7], v15 offset:1024
  ds_read_b64_tr_b16 a[8:9], v16 offset:0
  ds_read_b64_tr_b16 a[10:11], v16 offset:1024
  ds_read_b64_tr_b16 a[12:13], v17 offset:0
  ds_read_b64_tr_b16 a[14:15], v17 offset:1024
  ds_read_b128 a[20:23], v12 offset:34816
  ds_read_b128 a[24:27], v12 offset:36864
  s_waitcnt lgkmcnt(8)
  v_mfma_f32_32x32x16_bf16 v[192:207], a[0:3], a[16:19], 0
  buffer_load_dwordx4 a[168:171], v5, s[24:27], s59 offen
  ds_read_b128 a[44:47], v13 offset:32768
  ds_read_b64_tr_b16 a[28:29], v14 offset:4096
  ds_read_b64_tr_b16 a[30:31], v14 offset:5120
  s_waitcnt lgkmcnt(9)
  v_mfma_f32_32x32x16_bf16 v[208:223], a[4:7], a[16:19], 0
  buffer_load_dwordx4 a[172:175], v6, s[24:27], s59 offen
  ds_read_b64_tr_b16 a[32:33], v15 offset:4096
  ds_read_b64_tr_b16 a[34:35], v15 offset:5120
  ds_read_b64_tr_b16 a[36:37], v16 offset:4096
  s_waitcnt lgkmcnt(10)
  v_mfma_f32_32x32x16_bf16 v[224:239], a[8:11], a[16:19], 0
  buffer_load_dwordx4 a[176:179], v7, s[24:27], s59 offen
  ds_read_b64_tr_b16 a[38:39], v16 offset:5120
  ds_read_b64_tr_b16 a[40:41], v17 offset:4096
  ds_read_b64_tr_b16 a[42:43], v17 offset:5120
  s_waitcnt lgkmcnt(11)
  v_mfma_f32_32x32x16_bf16 v[240:255], a[12:15], a[16:19], 0
  buffer_load_dwordx4 a[180:183], v8, s[24:27], s59 offen
  ds_read_b128 a[48:51], v13 offset:34816
  ds_read_b128 a[52:55], v13 offset:36864
  s_waitcnt lgkmcnt(12)
  v_mfma_f32_32x32x16_bf16 v[128:143], a[0:3], a[20:23], 0
  s_waitcnt vmcnt(7)
  ds_write_b128 v10, a[196:199] offset:16384
  v_mfma_f32_32x32x16_bf16 v[144:159], a[4:7], a[20:23], 0
  s_waitcnt vmcnt(6)
  ds_write_b128 v11, a[200:203] offset:16896
  v_mfma_f32_32x32x16_bf16 v[160:175], a[8:11], a[20:23], 0
  s_waitcnt vmcnt(5)
  ds_write_b128 v10, a[204:207] offset:17408
  v_mfma_f32_32x32x16_bf16 v[176:191], a[12:15], a[20:23], 0
  s_waitcnt vmcnt(4)
  ds_write_b128 v11, a[208:211] offset:17920
  s_waitcnt lgkmcnt(15)
  v_mfma_f32_32x32x16_bf16 v[64:79], a[0:3], a[24:27], 0
  ds_write_b128 v9, a[212:215] offset:45056
  v_mfma_f32_32x32x16_bf16 v[80:95], a[4:7], a[24:27], 0
  ds_write_b128 v9, a[216:219] offset:46080
  v_mfma_f32_32x32x16_bf16 v[96:111], a[8:11], a[24:27], 0
  ds_write_b128 v9, a[220:223] offset:47104
  v_mfma_f32_32x32x16_bf16 v[112:127], a[12:15], a[24:27], 0
  s_waitcnt lgkmcnt(0)
  s_barrier
  v_mfma_f32_32x32x16_bf16 v[192:207], a[28:31], a[44:47], v[192:207]
  buffer_load_dwordx4 a[184:187], v2, s[20:23], s58 offen
  ds_read_b128 a[16:19], v12 offset:45056
  ds_read_b64_tr_b16 a[0:1], v14 offset:16384
  ds_read_b64_tr_b16 a[2:3], v14 offset:17408
  v_mfma_f32_32x32x16_bf16 v[208:223], a[32:35], a[44:47], v[208:223]
  buffer_load_dwordx4 v[48:51], v2, s[20:23], s58 offen offset:64
  ds_read_b64_tr_b16 a[4:5], v15 offset:16384
  ds_read_b64_tr_b16 a[6:7], v15 offset:17408
  ds_read_b64_tr_b16 a[8:9], v16 offset:16384
  v_mfma_f32_32x32x16_bf16 v[224:239], a[36:39], a[44:47], v[224:239]
  buffer_load_dwordx4 a[188:191], v3, s[20:23], s58 offen
  ds_read_b64_tr_b16 a[10:11], v16 offset:17408
  ds_read_b64_tr_b16 a[12:13], v17 offset:16384
  ds_read_b64_tr_b16 a[14:15], v17 offset:17408
  v_mfma_f32_32x32x16_bf16 v[240:255], a[40:43], a[44:47], v[240:255]
  buffer_load_dwordx4 v[52:55], v3, s[20:23], s58 offen offset:64
  ds_read_b128 a[20:23], v12 offset:47104
  ds_read_b128 a[24:27], v12 offset:49152
  v_mfma_f32_32x32x16_bf16 v[128:143], a[28:31], a[48:51], v[128:143]
  s_waitcnt vmcnt(7)
  ds_write_b128 v10, a[168:171] offset:0
  v_mfma_f32_32x32x16_bf16 v[144:159], a[32:35], a[48:51], v[144:159]
  buffer_load_dwordx4 a[192:195], v4, s[20:23], s58 offen
  v_mfma_f32_32x32x16_bf16 v[160:175], a[36:39], a[48:51], v[160:175]
  s_waitcnt vmcnt(7)
  ds_write_b128 v11, a[172:175] offset:512
  v_mfma_f32_32x32x16_bf16 v[176:191], a[40:43], a[48:51], v[176:191]
  buffer_load_dwordx4 v[56:59], v4, s[20:23], s58 offen offset:64
  s_add_u32 s59, s59, 0x40000
  s_and_b32 s59, s59, 0x3fffff
  s_lshr_b32 s58, s59, 12
  v_mfma_f32_32x32x16_bf16 v[64:79], a[28:31], a[52:55], v[64:79]
  s_waitcnt vmcnt(7)
  ds_write_b128 v10, a[176:179] offset:1024
  v_mfma_f32_32x32x16_bf16 v[80:95], a[32:35], a[52:55], v[80:95]
  buffer_load_dwordx4 v[32:35], v5, s[24:27], s59 offen
  v_mfma_f32_32x32x16_bf16 v[96:111], a[36:39], a[52:55], v[96:111]
  s_waitcnt vmcnt(7)
  ds_write_b128 v11, a[180:183] offset:1536
  v_mfma_f32_32x32x16_bf16 v[112:127], a[40:43], a[52:55], v[112:127]
  buffer_load_dwordx4 v[36:39], v6, s[24:27], s59 offen
  s_waitcnt lgkmcnt(12)
  v_mfma_f32_32x32x16_bf16 v[192:207], a[0:3], a[16:19], v[192:207]
  buffer_load_dwordx4 v[40:43], v7, s[24:27], s59 offen
  ds_read_b128 a[44:47], v13 offset:45056
  ds_read_b64_tr_b16 a[28:29], v14 offset:20480
  ds_read_b64_tr_b16 a[30:31], v14 offset:21504
  s_waitcnt lgkmcnt(13)
  v_mfma_f32_32x32x16_bf16 v[208:223], a[4:7], a[16:19], v[208:223]
  buffer_load_dwordx4 v[44:47], v8, s[24:27], s59 offen
  ds_read_b64_tr_b16 a[32:33], v15 offset:20480
  ds_read_b64_tr_b16 a[34:35], v15 offset:21504
  ds_read_b64_tr_b16 a[36:37], v16 offset:20480
  s_add_u32 s59, s59, 0x40000
  s_and_b32 s59, s59, 0x3fffff
  s_lshr_b32 s58, s59, 12
  s_waitcnt lgkmcnt(14)
  v_mfma_f32_32x32x16_bf16 v[224:239], a[8:11], a[16:19], v[224:239]
  buffer_load_dwordx4 a[140:143], v5, s[24:27], s59 offen
  ds_read_b64_tr_b16 a[38:39], v16 offset:21504
  ds_read_b64_tr_b16 a[40:41], v17 offset:20480
  ds_read_b64_tr_b16 a[42:43], v17 offset:21504
  s_waitcnt lgkmcnt(15)
  v_mfma_f32_32x32x16_bf16 v[240:255], a[12:15], a[16:19], v[240:255]
  buffer_load_dwordx4 a[144:147], v6, s[24:27], s59 offen
  ds_read_b128 a[48:51], v13 offset:47104
  ds_read_b128 a[52:55], v13 offset:49152
  s_waitcnt lgkmcnt(15)
  v_mfma_f32_32x32x16_bf16 v[128:143], a[0:3], a[20:23], v[128:143]
  s_waitcnt vmcnt(11)
  ds_write_b128 v9, a[184:187] offset:32768
  v_mfma_f32_32x32x16_bf16 v[144:159], a[4:7], a[20:23], v[144:159]
  buffer_load_dwordx4 a[148:151], v7, s[24:27], s59 offen
  v_mfma_f32_32x32x16_bf16 v[160:175], a[8:11], a[20:23], v[160:175]
  s_waitcnt vmcnt(10)
  ds_write_b128 v9, a[188:191] offset:33792
  v_mfma_f32_32x32x16_bf16 v[176:191], a[12:15], a[20:23], v[176:191]
  buffer_load_dwordx4 a[152:155], v8, s[24:27], s59 offen
  v_mfma_f32_32x32x16_bf16 v[64:79], a[0:3], a[24:27], v[64:79]
  s_waitcnt vmcnt(9)
  ds_write_b128 v9, a[192:195] offset:34816
  v_mfma_f32_32x32x16_bf16 v[80:95], a[4:7], a[24:27], v[80:95]
  buffer_load_dwordx4 a[156:159], v2, s[20:23], s58 offen
  v_mfma_f32_32x32x16_bf16 v[96:111], a[8:11], a[24:27], v[96:111]
  buffer_load_dwordx4 a[128:131], v2, s[20:23], s58 offen offset:64
  v_mfma_f32_32x32x16_bf16 v[112:127], a[12:15], a[24:27], v[112:127]
  s_waitcnt lgkmcnt(0)
  s_barrier
  v_mfma_f32_32x32x16_bf16 v[192:207], a[28:31], a[44:47], v[192:207]
  buffer_load_dwordx4 a[160:163], v3, s[20:23], s58 offen
  ds_read_b128 a[16:19], v12 offset:32768
  ds_read_b64_tr_b16 a[0:1], v14 offset:0
  ds_read_b64_tr_b16 a[2:3], v14 offset:1024
  v_mfma_f32_32x32x16_bf16 v[208:223], a[32:35], a[44:47], v[208:223]
  buffer_load_dwordx4 a[132:135], v3, s[20:23], s58 offen offset:64
  ds_read_b64_tr_b16 a[4:5], v15 offset:0
  ds_read_b64_tr_b16 a[6:7], v15 offset:1024
  ds_read_b64_tr_b16 a[8:9], v16 offset:0
  v_mfma_f32_32x32x16_bf16 v[224:239], a[36:39], a[44:47], v[224:239]
  buffer_load_dwordx4 a[164:167], v4, s[20:23], s58 offen
  ds_read_b64_tr_b16 a[10:11], v16 offset:1024
  ds_read_b64_tr_b16 a[12:13], v17 offset:0
  ds_read_b64_tr_b16 a[14:15], v17 offset:1024
  v_mfma_f32_32x32x16_bf16 v[240:255], a[40:43], a[44:47], v[240:255]
  buffer_load_dwordx4 a[136:139], v4, s[20:23], s58 offen offset:64
  ds_read_b128 a[20:23], v12 offset:34816
  ds_read_b128 a[24:27], v12 offset:36864
  s_add_u32 s59, s59, 0x40000
  s_and_b32 s59, s59, 0x3fffff
  s_lshr_b32 s58, s59, 12
  v_mfma_f32_32x32x16_bf16 v[128:143], a[28:31], a[48:51], v[128:143]
  s_waitcnt vmcnt(13)
  ds_write_b128 v10, v[32:35] offset:16384
  v_mfma_f32_32x32x16_bf16 v[144:159], a[32:35], a[48:51], v[144:159]
  buffer_load_dwordx4 a[112:115], v5, s[24:27], s59 offen
  v_mfma_f32_32x32x16_bf16 v[160:175], a[36:39], a[48:51], v[160:175]
  s_waitcnt vmcnt(13)
  ds_write_b128 v11, v[36:39] offset:16896
  v_mfma_f32_32x32x16_bf16 v[176:191], a[40:43], a[48:51], v[176:191]
  buffer_load_dwordx4 a[116:119], v6, s[24:27], s59 offen
  v_mfma_f32_32x32x16_bf16 v[64:79], a[28:31], a[52:55], v[64:79]
  s_waitcnt vmcnt(13)
  ds_write_b128 v10, v[40:43] offset:17408
  v_mfma_f32_32x32x16_bf16 v[80:95], a[32:35], a[52:55], v[80:95]
  buffer_load_dwordx4 a[120:123], v7, s[24:27], s59 offen
  v_mfma_f32_32x32x16_bf16 v[96:111], a[36:39], a[52:55], v[96:111]
  s_waitcnt vmcnt(13)
  ds_write_b128 v11, v[44:47] offset:17920
  v_mfma_f32_32x32x16_bf16 v[112:127], a[40:43], a[52:55], v[112:127]
  buffer_load_dwordx4 a[124:127], v8, s[24:27], s59 offen
  s_add_u32 s59, s59, 0x40000
  s_and_b32 s59, s59, 0x3fffff
  s_lshr_b32 s58, s59, 12
  s_waitcnt lgkmcnt(12)
  v_mfma_f32_32x32x16_bf16 v[192:207], a[0:3], a[16:19], v[192:207]
  buffer_load_dwordx4 a[84:87], v5, s[24:27], s59 offen
  ds_read_b128 a[44:47], v13 offset:32768
  ds_read_b64_tr_b16 a[28:29], v14 offset:4096
  ds_read_b64_tr_b16 a[30:31], v14 offset:5120
  s_waitcnt lgkmcnt(13)
  v_mfma_f32_32x32x16_bf16 v[208:223], a[4:7], a[16:19], v[208:223]
  buffer_load_dwordx4 a[88:91], v6, s[24:27], s59 offen
  ds_read_b64_tr_b16 a[32:33], v15 offset:4096
  ds_read_b64_tr_b16 a[34:35], v15 offset:5120
  ds_read_b64_tr_b16 a[36:37], v16 offset:4096
  s_waitcnt lgkmcnt(14)
  v_mfma_f32_32x32x16_bf16 v[224:239], a[8:11], a[16:19], v[224:239]
  buffer_load_dwordx4 a[92:95], v7, s[24:27], s59 offen
  ds_read_b64_tr_b16 a[38:39], v16 offset:5120
  ds_read_b64_tr_b16 a[40:41], v17 offset:4096
  ds_read_b64_tr_b16 a[42:43], v17 offset:5120
  s_waitcnt lgkmcnt(15)
  v_mfma_f32_32x32x16_bf16 v[240:255], a[12:15], a[16:19], v[240:255]
  buffer_load_dwordx4 a[96:99], v8, s[24:27], s59 offen
  ds_read_b128 a[48:51], v13 offset:34816
  ds_read_b128 a[52:55], v13 offset:36864
  s_waitcnt lgkmcnt(15)
  v_mfma_f32_32x32x16_bf16 v[128:143], a[0:3], a[20:23], v[128:143]
  ds_write_b128 v9, v[48:51] offset:45056
  v_mfma_f32_32x32x16_bf16 v[144:159], a[4:7], a[20:23], v[144:159]
  buffer_load_dwordx4 a[100:103], v2, s[20:23], s58 offen
  v_mfma_f32_32x32x16_bf16 v[160:175], a[8:11], a[20:23], v[160:175]
  ds_write_b128 v9, v[52:55] offset:46080
  v_mfma_f32_32x32x16_bf16 v[176:191], a[12:15], a[20:23], v[176:191]
  buffer_load_dwordx4 a[72:75], v2, s[20:23], s58 offen offset:64
  v_mfma_f32_32x32x16_bf16 v[64:79], a[0:3], a[24:27], v[64:79]
  ds_write_b128 v9, v[56:59] offset:47104
  v_mfma_f32_32x32x16_bf16 v[80:95], a[4:7], a[24:27], v[80:95]
  buffer_load_dwordx4 a[104:107], v3, s[20:23], s58 offen
  v_mfma_f32_32x32x16_bf16 v[96:111], a[8:11], a[24:27], v[96:111]
  buffer_load_dwordx4 a[76:79], v3, s[20:23], s58 offen offset:64
  v_mfma_f32_32x32x16_bf16 v[112:127], a[12:15], a[24:27], v[112:127]
  s_waitcnt lgkmcnt(0)
  s_barrier
  v_mfma_f32_32x32x16_bf16 v[192:207], a[28:31], a[44:47], v[192:207]
  buffer_load_dwordx4 a[108:111], v4, s[20:23], s58 offen
  ds_read_b128 a[16:19], v12 offset:45056
  ds_read_b64_tr_b16 a[0:1], v14 offset:16384
  ds_read_b64_tr_b16 a[2:3], v14 offset:17408
  v_mfma_f32_32x32x16_bf16 v[208:223], a[32:35], a[44:47], v[208:223]
  ds_read_b64_tr_b16 a[4:5], v15 offset:16384
  ds_read_b64_tr_b16 a[6:7], v15 offset:17408
  ds_read_b64_tr_b16 a[8:9], v16 offset:16384
  v_mfma_f32_32x32x16_bf16 v[224:239], a[36:39], a[44:47], v[224:239]
  buffer_load_dwordx4 a[80:83], v4, s[20:23], s58 offen offset:64
  ds_read_b64_tr_b16 a[10:11], v16 offset:17408
  ds_read_b64_tr_b16 a[12:13], v17 offset:16384
  ds_read_b64_tr_b16 a[14:15], v17 offset:17408
  s_add_u32 s59, s59, 0x40000
  s_and_b32 s59, s59, 0x3fffff
  s_lshr_b32 s58, s59, 12
  v_mfma_f32_32x32x16_bf16 v[240:255], a[40:43], a[44:47], v[240:255]
  ds_read_b128 a[20:23], v12 offset:47104
  ds_read_b128 a[24:27], v12 offset:49152
  v_mfma_f32_32x32x16_bf16 v[128:143], a[28:31], a[48:51], v[128:143]
  s_waitcnt vmcnt(23)
  ds_write_b128 v10, a[140:143] offset:0
  v_mfma_f32_32x32x16_bf16 v[144:159], a[32:35], a[48:51], v[144:159]
  buffer_load_dwordx4 a[56:59], v5, s[24:27], s59 offen
  v_mfma_f32_32x32x16_bf16 v[160:175], a[36:39], a[48:51], v[160:175]
  s_waitcnt vmcnt(23)
  ds_write_b128 v11, a[144:147] offset:512
  v_mfma_f32_32x32x16_bf16 v[176:191], a[40:43], a[48:51], v[176:191]
  buffer_load_dwordx4 a[60:63], v6, s[24:27], s59 offen
  v_mfma_f32_32x32x16_bf16 v[64:79], a[28:31], a[52:55], v[64:79]
  s_waitcnt vmcnt(23)
  ds_write_b128 v10, a[148:151] offset:1024
  v_mfma_f32_32x32x16_bf16 v[80:95], a[32:35], a[52:55], v[80:95]
  buffer_load_dwordx4 a[64:67], v7, s[24:27], s59 offen
  v_mfma_f32_32x32x16_bf16 v[96:111], a[36:39], a[52:55], v[96:111]
  s_waitcnt vmcnt(23)
  ds_write_b128 v11, a[152:155] offset:1536
  v_mfma_f32_32x32x16_bf16 v[112:127], a[40:43], a[52:55], v[112:127]
  buffer_load_dwordx4 a[68:71], v8, s[24:27], s59 offen
  s_add_u32 s59, s59, 0x40000
  s_and_b32 s59, s59, 0x3fffff
  s_lshr_b32 s58, s59, 12
  s_waitcnt lgkmcnt(12)
  v_mfma_f32_32x32x16_bf16 v[192:207], a[0:3], a[16:19], v[192:207]
  buffer_load_dwordx4 a[224:227], v5, s[24:27], s59 offen
  ds_read_b128 a[44:47], v13 offset:45056
  ds_read_b64_tr_b16 a[28:29], v14 offset:20480
  ds_read_b64_tr_b16 a[30:31], v14 offset:21504
  s_waitcnt lgkmcnt(13)
  v_mfma_f32_32x32x16_bf16 v[208:223], a[4:7], a[16:19], v[208:223]
  ds_read_b64_tr_b16 a[32:33], v15 offset:20480
  ds_read_b64_tr_b16 a[34:35], v15 offset:21504
  ds_read_b64_tr_b16 a[36:37], v16 offset:20480
  s_waitcnt lgkmcnt(14)
  v_mfma_f32_32x32x16_bf16 v[224:239], a[8:11], a[16:19], v[224:239]
  buffer_load_dwordx4 a[228:231], v6, s[24:27], s59 offen
  ds_read_b64_tr_b16 a[38:39], v16 offset:21504
  ds_read_b64_tr_b16 a[40:41], v17 offset:20480
  ds_read_b64_tr_b16 a[42:43], v17 offset:21504
  s_waitcnt lgkmcnt(15)
  v_mfma_f32_32x32x16_bf16 v[240:255], a[12:15], a[16:19], v[240:255]
  ds_read_b128 a[48:51], v13 offset:47104
  ds_read_b128 a[52:55], v13 offset:49152
  s_waitcnt lgkmcnt(15)
  v_mfma_f32_32x32x16_bf16 v[128:143], a[0:3], a[20:23], v[128:143]
  s_waitcnt vmcnt(25)
  ds_write_b128 v9, a[156:159] offset:32768
  v_mfma_f32_32x32x16_bf16 v[144:159], a[4:7], a[20:23], v[144:159]
  buffer_load_dwordx4 a[232:235], v7, s[24:27], s59 offen
  v_mfma_f32_32x32x16_bf16 v[160:175], a[8:11], a[20:23], v[160:175]
  s_waitcnt vmcnt(24)
  ds_write_b128 v9, a[160:163] offset:33792
  v_mfma_f32_32x32x16_bf16 v[176:191], a[12:15], a[20:23], v[176:191]
  buffer_load_dwordx4 a[236:239], v8, s[24:27], s59 offen
  v_mfma_f32_32x32x16_bf16 v[64:79], a[0:3], a[24:27], v[64:79]
  s_waitcnt vmcnt(23)
  ds_write_b128 v9, a[164:167] offset:34816
  v_mfma_f32_32x32x16_bf16 v[80:95], a[4:7], a[24:27], v[80:95]
  buffer_load_dwordx4 a[240:243], v2, s[20:23], s58 offen
  v_mfma_f32_32x32x16_bf16 v[96:111], a[8:11], a[24:27], v[96:111]
  v_mfma_f32_32x32x16_bf16 v[112:127], a[12:15], a[24:27], v[112:127]
  s_waitcnt lgkmcnt(0)
  s_barrier
  v_mfma_f32_32x32x16_bf16 v[192:207], a[28:31], a[44:47], v[192:207]
  buffer_load_dwordx4 a[212:215], v2, s[20:23], s58 offen offset:64
  ds_read_b128 a[16:19], v12 offset:32768
  ds_read_b64_tr_b16 a[0:1], v14 offset:0
  ds_read_b64_tr_b16 a[2:3], v14 offset:1024
  v_mfma_f32_32x32x16_bf16 v[208:223], a[32:35], a[44:47], v[208:223]
  buffer_load_dwordx4 a[244:247], v3, s[20:23], s58 offen
  ds_read_b64_tr_b16 a[4:5], v15 offset:0
  ds_read_b64_tr_b16 a[6:7], v15 offset:1024
  ds_read_b64_tr_b16 a[8:9], v16 offset:0
  v_mfma_f32_32x32x16_bf16 v[224:239], a[36:39], a[44:47], v[224:239]
  ds_read_b64_tr_b16 a[10:11], v16 offset:1024
  ds_read_b64_tr_b16 a[12:13], v17 offset:0
  ds_read_b64_tr_b16 a[14:15], v17 offset:1024
  v_mfma_f32_32x32x16_bf16 v[240:255], a[40:43], a[44:47], v[240:255]
  buffer_load_dwordx4 a[216:219], v3, s[20:23], s58 offen offset:64
  ds_read_b128 a[20:23], v12 offset:34816
  ds_read_b128 a[24:27], v12 offset:36864
  v_mfma_f32_32x32x16_bf16 v[128:143], a[28:31], a[48:51], v[128:143]
  s_waitcnt vmcnt(25)
  ds_write_b128 v10, a[112:115] offset:16384
  v_mfma_f32_32x32x16_bf16 v[144:159], a[32:35], a[48:51], v[144:159]
  buffer_load_dwordx4 a[248:251], v4, s[20:23], s58 offen
  v_mfma_f32_32x32x16_bf16 v[160:175], a[36:39], a[48:51], v[160:175]
  s_waitcnt vmcnt(25)
  ds_write_b128 v11, a[116:119] offset:16896
  v_mfma_f32_32x32x16_bf16 v[176:191], a[40:43], a[48:51], v[176:191]
  buffer_load_dwordx4 a[220:223], v4, s[20:23], s58 offen offset:64
  s_add_u32 s59, s59, 0x40000
  s_and_b32 s59, s59, 0x3fffff
  s_lshr_b32 s58, s59, 12
  v_mfma_f32_32x32x16_bf16 v[64:79], a[28:31], a[52:55], v[64:79]
  s_waitcnt vmcnt(25)
  ds_write_b128 v10, a[120:123] offset:17408
  v_mfma_f32_32x32x16_bf16 v[80:95], a[32:35], a[52:55], v[80:95]
  buffer_load_dwordx4 a[196:199], v5, s[24:27], s59 offen
  v_mfma_f32_32x32x16_bf16 v[96:111], a[36:39], a[52:55], v[96:111]
  s_waitcnt vmcnt(25)
  ds_write_b128 v11, a[124:127] offset:17920
  v_mfma_f32_32x32x16_bf16 v[112:127], a[40:43], a[52:55], v[112:127]
  buffer_load_dwordx4 a[200:203], v6, s[24:27], s59 offen
  s_waitcnt lgkmcnt(12)
  v_mfma_f32_32x32x16_bf16 v[192:207], a[0:3], a[16:19], v[192:207]
  ds_read_b128 a[44:47], v13 offset:32768
  ds_read_b64_tr_b16 a[28:29], v14 offset:4096
  ds_read_b64_tr_b16 a[30:31], v14 offset:5120
  s_waitcnt lgkmcnt(13)
  v_mfma_f32_32x32x16_bf16 v[208:223], a[4:7], a[16:19], v[208:223]
  buffer_load_dwordx4 a[204:207], v7, s[24:27], s59 offen
  ds_read_b64_tr_b16 a[32:33], v15 offset:4096
  ds_read_b64_tr_b16 a[34:35], v15 offset:5120
  ds_read_b64_tr_b16 a[36:37], v16 offset:4096
  s_waitcnt lgkmcnt(14)
  v_mfma_f32_32x32x16_bf16 v[224:239], a[8:11], a[16:19], v[224:239]
  ds_read_b64_tr_b16 a[38:39], v16 offset:5120
  ds_read_b64_tr_b16 a[40:41], v17 offset:4096
  ds_read_b64_tr_b16 a[42:43], v17 offset:5120
  s_waitcnt lgkmcnt(15)
  v_mfma_f32_32x32x16_bf16 v[240:255], a[12:15], a[16:19], v[240:255]
  ds_read_b128 a[48:51], v13 offset:34816
  ds_read_b128 a[52:55], v13 offset:36864
  s_waitcnt lgkmcnt(15)
  v_mfma_f32_32x32x16_bf16 v[128:143], a[0:3], a[20:23], v[128:143]
  ds_write_b128 v9, a[128:131] offset:45056
  v_mfma_f32_32x32x16_bf16 v[144:159], a[4:7], a[20:23], v[144:159]
  buffer_load_dwordx4 a[208:211], v8, s[24:27], s59 offen
  s_add_u32 s59, s59, 0x40000
  s_and_b32 s59, s59, 0x3fffff
  s_lshr_b32 s58, s59, 12
  v_mfma_f32_32x32x16_bf16 v[160:175], a[8:11], a[20:23], v[160:175]
  ds_write_b128 v9, a[132:135] offset:46080
  v_mfma_f32_32x32x16_bf16 v[176:191], a[12:15], a[20:23], v[176:191]
  buffer_load_dwordx4 a[168:171], v5, s[24:27], s59 offen
  v_mfma_f32_32x32x16_bf16 v[64:79], a[0:3], a[24:27], v[64:79]
  ds_write_b128 v9, a[136:139] offset:47104
  v_mfma_f32_32x32x16_bf16 v[80:95], a[4:7], a[24:27], v[80:95]
  buffer_load_dwordx4 a[172:175], v6, s[24:27], s59 offen
  v_mfma_f32_32x32x16_bf16 v[96:111], a[8:11], a[24:27], v[96:111]
  buffer_load_dwordx4 a[176:179], v7, s[24:27], s59 offen
  v_mfma_f32_32x32x16_bf16 v[112:127], a[12:15], a[24:27], v[112:127]
  s_waitcnt lgkmcnt(0)
  s_barrier
  v_mfma_f32_32x32x16_bf16 v[192:207], a[28:31], a[44:47], v[192:207]
  buffer_load_dwordx4 a[180:183], v8, s[24:27], s59 offen
  ds_read_b128 a[16:19], v12 offset:45056
  ds_read_b64_tr_b16 a[0:1], v14 offset:16384
  ds_read_b64_tr_b16 a[2:3], v14 offset:17408
  v_mfma_f32_32x32x16_bf16 v[208:223], a[32:35], a[44:47], v[208:223]
  ds_read_b64_tr_b16 a[4:5], v15 offset:16384
  ds_read_b64_tr_b16 a[6:7], v15 offset:17408
  ds_read_b64_tr_b16 a[8:9], v16 offset:16384
  v_mfma_f32_32x32x16_bf16 v[224:239], a[36:39], a[44:47], v[224:239]
  buffer_load_dwordx4 a[184:187], v2, s[20:23], s58 offen
  ds_read_b64_tr_b16 a[10:11], v16 offset:17408
  ds_read_b64_tr_b16 a[12:13], v17 offset:16384
  ds_read_b64_tr_b16 a[14:15], v17 offset:17408
  v_mfma_f32_32x32x16_bf16 v[240:255], a[40:43], a[44:47], v[240:255]
  ds_read_b128 a[20:23], v12 offset:47104
  ds_read_b128 a[24:27], v12 offset:49152
  v_mfma_f32_32x32x16_bf16 v[128:143], a[28:31], a[48:51], v[128:143]
  s_waitcnt vmcnt(32)
  ds_write_b128 v10, a[84:87] offset:0
  v_mfma_f32_32x32x16_bf16 v[144:159], a[32:35], a[48:51], v[144:159]
  buffer_load_dwordx4 v[48:51], v2, s[20:23], s58 offen offset:64
  v_mfma_f32_32x32x16_bf16 v[160:175], a[36:39], a[48:51], v[160:175]
  s_waitcnt vmcnt(32)
  ds_write_b128 v11, a[88:91] offset:512
  v_mfma_f32_32x32x16_bf16 v[176:191], a[40:43], a[48:51], v[176:191]
  buffer_load_dwordx4 a[188:191], v3, s[20:23], s58 offen
  v_mfma_f32_32x32x16_bf16 v[64:79], a[28:31], a[52:55], v[64:79]
  s_waitcnt vmcnt(32)
  ds_write_b128 v10, a[92:95] offset:1024
  v_mfma_f32_32x32x16_bf16 v[80:95], a[32:35], a[52:55], v[80:95]
  buffer_load_dwordx4 v[52:55], v3, s[20:23], s58 offen offset:64
  v_mfma_f32_32x32x16_bf16 v[96:111], a[36:39], a[52:55], v[96:111]
  s_waitcnt vmcnt(32)
  ds_write_b128 v11, a[96:99] offset:1536
  v_mfma_f32_32x32x16_bf16 v[112:127], a[40:43], a[52:55], v[112:127]
  buffer_load_dwordx4 a[192:195], v4, s[20:23], s58 offen
  s_waitcnt lgkmcnt(12)
  v_mfma_f32_32x32x16_bf16 v[192:207], a[0:3], a[16:19], v[192:207]
  ds_read_b128 a[44:47], v13 offset:45056
  ds_read_b64_tr_b16 a[28:29], v14 offset:20480
  ds_read_b64_tr_b16 a[30:31], v14 offset:21504
  s_waitcnt lgkmcnt(13)
  v_mfma_f32_32x32x16_bf16 v[208:223], a[4:7], a[16:19], v[208:223]
  buffer_load_dwordx4 v[56:59], v4, s[20:23], s58 offen offset:64
  ds_read_b64_tr_b16 a[32:33], v15 offset:20480
  ds_read_b64_tr_b16 a[34:35], v15 offset:21504
  ds_read_b64_tr_b16 a[36:37], v16 offset:20480
  s_add_u32 s59, s59, 0x40000
  s_and_b32 s59, s59, 0x3fffff
  s_lshr_b32 s58, s59, 12
  s_waitcnt lgkmcnt(14)
  v_mfma_f32_32x32x16_bf16 v[224:239], a[8:11], a[16:19], v[224:239]
  ds_read_b64_tr_b16 a[38:39], v16 offset:21504
  ds_read_b64_tr_b16 a[40:41], v17 offset:20480
  ds_read_b64_tr_b16 a[42:43], v17 offset:21504
  s_waitcnt lgkmcnt(15)
  v_mfma_f32_32x32x16_bf16 v[240:255], a[12:15], a[16:19], v[240:255]
  buffer_load_dwordx4 v[32:35], v5, s[24:27], s59 offen
  ds_read_b128 a[48:51], v13 offset:47104
  ds_read_b128 a[52:55], v13 offset:49152
  s_waitcnt lgkmcnt(15)
  v_mfma_f32_32x32x16_bf16 v[128:143], a[0:3], a[20:23], v[128:143]
  s_waitcnt vmcnt(34)
  ds_write_b128 v9, a[100:103] offset:32768
  v_mfma_f32_32x32x16_bf16 v[144:159], a[4:7], a[20:23], v[144:159]
  buffer_load_dwordx4 v[36:39], v6, s[24:27], s59 offen
  v_mfma_f32_32x32x16_bf16 v[160:175], a[8:11], a[20:23], v[160:175]
  s_waitcnt vmcnt(33)
  ds_write_b128 v9, a[104:107] offset:33792
  v_mfma_f32_32x32x16_bf16 v[176:191], a[12:15], a[20:23], v[176:191]
  buffer_load_dwordx4 v[40:43], v7, s[24:27], s59 offen
  v_mfma_f32_32x32x16_bf16 v[64:79], a[0:3], a[24:27], v[64:79]
  s_waitcnt vmcnt(32)
  ds_write_b128 v9, a[108:111] offset:34816
  v_mfma_f32_32x32x16_bf16 v[80:95], a[4:7], a[24:27], v[80:95]
  buffer_load_dwordx4 v[44:47], v8, s[24:27], s59 offen
  s_add_u32 s59, s59, 0x40000
  s_and_b32 s59, s59, 0x3fffff
  s_lshr_b32 s58, s59, 12
  v_mfma_f32_32x32x16_bf16 v[96:111], a[8:11], a[24:27], v[96:111]
  v_mfma_f32_32x32x16_bf16 v[112:127], a[12:15], a[24:27], v[112:127]
  s_waitcnt lgkmcnt(0)
  s_barrier
  v_mfma_f32_32x32x16_bf16 v[192:207], a[28:31], a[44:47], v[192:207]
  buffer_load_dwordx4 a[140:143], v5, s[24:27], s59 offen
  ds_read_b128 a[16:19], v12 offset:32768
  ds_read_b64_tr_b16 a[0:1], v14 offset:0
  ds_read_b64_tr_b16 a[2:3], v14 offset:1024
  v_mfma_f32_32x32x16_bf16 v[208:223], a[32:35], a[44:47], v[208:223]
  buffer_load_dwordx4 a[144:147], v6, s[24:27], s59 offen
  ds_read_b64_tr_b16 a[4:5], v15 offset:0
  ds_read_b64_tr_b16 a[6:7], v15 offset:1024
  ds_read_b64_tr_b16 a[8:9], v16 offset:0
  v_mfma_f32_32x32x16_bf16 v[224:239], a[36:39], a[44:47], v[224:239]
  ds_read_b64_tr_b16 a[10:11], v16 offset:1024
  ds_read_b64_tr_b16 a[12:13], v17 offset:0
  ds_read_b64_tr_b16 a[14:15], v17 offset:1024
  v_mfma_f32_32x32x16_bf16 v[240:255], a[40:43], a[44:47], v[240:255]
  buffer_load_dwordx4 a[148:151], v7, s[24:27], s59 offen
  ds_read_b128 a[20:23], v12 offset:34816
  ds_read_b128 a[24:27], v12 offset:36864
  v_mfma_f32_32x32x16_bf16 v[128:143], a[28:31], a[48:51], v[128:143]
  s_waitcnt vmcnt(34)
  ds_write_b128 v10, a[56:59] offset:16384
  v_mfma_f32_32x32x16_bf16 v[144:159], a[32:35], a[48:51], v[144:159]
  buffer_load_dwordx4 a[152:155], v8, s[24:27], s59 offen
  v_mfma_f32_32x32x16_bf16 v[160:175], a[36:39], a[48:51], v[160:175]
  s_waitcnt vmcnt(34)
  ds_write_b128 v11, a[60:63] offset:16896
  v_mfma_f32_32x32x16_bf16 v[176:191], a[40:43], a[48:51], v[176:191]
  buffer_load_dwordx4 a[156:159], v2, s[20:23], s58 offen
  v_mfma_f32_32x32x16_bf16 v[64:79], a[28:31], a[52:55], v[64:79]
  s_waitcnt vmcnt(34)
  ds_write_b128 v10, a[64:67] offset:17408
  v_mfma_f32_32x32x16_bf16 v[80:95], a[32:35], a[52:55], v[80:95]
  v_mfma_f32_32x32x16_bf16 v[96:111], a[36:39], a[52:55], v[96:111]
  s_waitcnt vmcnt(33)
  ds_write_b128 v11, a[68:71] offset:17920
  v_mfma_f32_32x32x16_bf16 v[112:127], a[40:43], a[52:55], v[112:127]
  buffer_load_dwordx4 a[128:131], v2, s[20:23], s58 offen offset:64
  s_waitcnt lgkmcnt(12)
  v_mfma_f32_32x32x16_bf16 v[192:207], a[0:3], a[16:19], v[192:207]
  buffer_load_dwordx4 a[160:163], v3, s[20:23], s58 offen
  ds_read_b128 a[44:47], v13 offset:32768
  ds_read_b64_tr_b16 a[28:29], v14 offset:4096
  ds_read_b64_tr_b16 a[30:31], v14 offset:5120
  s_waitcnt lgkmcnt(13)
  v_mfma_f32_32x32x16_bf16 v[208:223], a[4:7], a[16:19], v[208:223]
  ds_read_b64_tr_b16 a[32:33], v15 offset:4096
  ds_read_b64_tr_b16 a[34:35], v15 offset:5120
  ds_read_b64_tr_b16 a[36:37], v16 offset:4096
  s_waitcnt lgkmcnt(14)
  v_mfma_f32_32x32x16_bf16 v[224:239], a[8:11], a[16:19], v[224:239]
  buffer_load_dwordx4 a[132:135], v3, s[20:23], s58 offen offset:64
  ds_read_b64_tr_b16 a[38:39], v16 offset:5120
  ds_read_b64_tr_b16 a[40:41], v17 offset:4096
  ds_read_b64_tr_b16 a[42:43], v17 offset:5120
  s_waitcnt lgkmcnt(15)
  v_mfma_f32_32x32x16_bf16 v[240:255], a[12:15], a[16:19], v[240:255]
  ds_read_b128 a[48:51], v13 offset:34816
  ds_read_b128 a[52:55], v13 offset:36864
  s_waitcnt lgkmcnt(15)
  v_mfma_f32_32x32x16_bf16 v[128:143], a[0:3], a[20:23], v[128:143]
  ds_write_b128 v9, a[72:75] offset:45056
  v_mfma_f32_32x32x16_bf16 v[144:159], a[4:7], a[20:23], v[144:159]
  buffer_load_dwordx4 a[164:167], v4, s[20:23], s58 offen
  v_mfma_f32_32x32x16_bf16 v[160:175], a[8:11], a[20:23], v[160:175]
  ds_write_b128 v9, a[76:79] offset:46080
  v_mfma_f32_32x32x16_bf16 v[176:191], a[12:15], a[20:23], v[176:191]
  buffer_load_dwordx4 a[136:139], v4, s[20:23], s58 offen offset:64
  s_add_u32 s59, s59, 0x40000
  s_and_b32 s59, s59, 0x3fffff
  s_lshr_b32 s58, s59, 12
  v_mfma_f32_32x32x16_bf16 v[64:79], a[0:3], a[24:27], v[64:79]
  ds_write_b128 v9, a[80:83] offset:47104
  v_mfma_f32_32x32x16_bf16 v[80:95], a[4:7], a[24:27], v[80:95]
  buffer_load_dwordx4 a[112:115], v5, s[24:27], s59 offen
  v_mfma_f32_32x32x16_bf16 v[96:111], a[8:11], a[24:27], v[96:111]
  buffer_load_dwordx4 a[116:119], v6, s[24:27], s59 offen
  v_mfma_f32_32x32x16_bf16 v[112:127], a[12:15], a[24:27], v[112:127]
  s_waitcnt lgkmcnt(0)
  s_barrier
  v_mfma_f32_32x32x16_bf16 v[192:207], a[28:31], a[44:47], v[192:207]
  buffer_load_dwordx4 a[120:123], v7, s[24:27], s59 offen
  ds_read_b128 a[16:19], v12 offset:45056
  ds_read_b64_tr_b16 a[0:1], v14 offset:16384
  ds_read_b64_tr_b16 a[2:3], v14 offset:17408
  v_mfma_f32_32x32x16_bf16 v[208:223], a[32:35], a[44:47], v[208:223]
  ds_read_b64_tr_b16 a[4:5], v15 offset:16384
  ds_read_b64_tr_b16 a[6:7], v15 offset:17408
  ds_read_b64_tr_b16 a[8:9], v16 offset:16384
  v_mfma_f32_32x32x16_bf16 v[224:239], a[36:39], a[44:47], v[224:239]
  buffer_load_dwordx4 a[124:127], v8, s[24:27], s59 offen
  ds_read_b64_tr_b16 a[10:11], v16 offset:17408
  ds_read_b64_tr_b16 a[12:13], v17 offset:16384
  ds_read_b64_tr_b16 a[14:15], v17 offset:17408
  s_add_u32 s59, s59, 0x40000
  s_and_b32 s59, s59, 0x3fffff
  s_lshr_b32 s58, s59, 12
  v_mfma_f32_32x32x16_bf16 v[240:255], a[40:43], a[44:47], v[240:255]
  ds_read_b128 a[20:23], v12 offset:47104
  ds_read_b128 a[24:27], v12 offset:49152
  v_mfma_f32_32x32x16_bf16 v[128:143], a[28:31], a[48:51], v[128:143]
  s_waitcnt vmcnt(41)
  ds_write_b128 v10, a[224:227] offset:0
  v_mfma_f32_32x32x16_bf16 v[144:159], a[32:35], a[48:51], v[144:159]
  buffer_load_dwordx4 a[84:87], v5, s[24:27], s59 offen
  v_mfma_f32_32x32x16_bf16 v[160:175], a[36:39], a[48:51], v[160:175]
  s_waitcnt vmcnt(41)
  ds_write_b128 v11, a[228:231] offset:512
  v_mfma_f32_32x32x16_bf16 v[176:191], a[40:43], a[48:51], v[176:191]
  buffer_load_dwordx4 a[88:91], v6, s[24:27], s59 offen
  v_mfma_f32_32x32x16_bf16 v[64:79], a[28:31], a[52:55], v[64:79]
  s_waitcnt vmcnt(41)
  ds_write_b128 v10, a[232:235] offset:1024
  v_mfma_f32_32x32x16_bf16 v[80:95], a[32:35], a[52:55], v[80:95]
  buffer_load_dwordx4 a[92:95], v7, s[24:27], s59 offen
  v_mfma_f32_32x32x16_bf16 v[96:111], a[36:39], a[52:55], v[96:111]
  s_waitcnt vmcnt(41)
  ds_write_b128 v11, a[236:239] offset:1536
  v_mfma_f32_32x32x16_bf16 v[112:127], a[40:43], a[52:55], v[112:127]
  buffer_load_dwordx4 a[96:99], v8, s[24:27], s59 offen
  s_waitcnt lgkmcnt(12)
  v_mfma_f32_32x32x16_bf16 v[192:207], a[0:3], a[16:19], v[192:207]
  ds_read_b128 a[44:47], v13 offset:45056
  ds_read_b64_tr_b16 a[28:29], v14 offset:20480
  ds_read_b64_tr_b16 a[30:31], v14 offset:21504
  s_waitcnt lgkmcnt(13)
  v_mfma_f32_32x32x16_bf16 v[208:223], a[4:7], a[16:19], v[208:223]
  buffer_load_dwordx4 a[100:103], v2, s[20:23], s58 offen
  ds_read_b64_tr_b16 a[32:33], v15 offset:20480
  ds_read_b64_tr_b16 a[34:35], v15 offset:21504
  ds_read_b64_tr_b16 a[36:37], v16 offset:20480
  s_waitcnt lgkmcnt(14)
  v_mfma_f32_32x32x16_bf16 v[224:239], a[8:11], a[16:19], v[224:239]
  ds_read_b64_tr_b16 a[38:39], v16 offset:21504
  ds_read_b64_tr_b16 a[40:41], v17 offset:20480
  ds_read_b64_tr_b16 a[42:43], v17 offset:21504
  s_waitcnt lgkmcnt(15)
  v_mfma_f32_32x32x16_bf16 v[240:255], a[12:15], a[16:19], v[240:255]
  buffer_load_dwordx4 a[72:75], v2, s[20:23], s58 offen offset:64
  ds_read_b128 a[48:51], v13 offset:47104
  ds_read_b128 a[52:55], v13 offset:49152
  s_waitcnt lgkmcnt(15)
  v_mfma_f32_32x32x16_bf16 v[128:143], a[0:3], a[20:23], v[128:143]
  s_waitcnt vmcnt(43)
  ds_write_b128 v9, a[240:243] offset:32768
  v_mfma_f32_32x32x16_bf16 v[144:159], a[4:7], a[20:23], v[144:159]
  buffer_load_dwordx4 a[104:107], v3, s[20:23], s58 offen
  v_mfma_f32_32x32x16_bf16 v[160:175], a[8:11], a[20:23], v[160:175]
  s_waitcnt vmcnt(42)
  ds_write_b128 v9, a[244:247] offset:33792
  v_mfma_f32_32x32x16_bf16 v[176:191], a[12:15], a[20:23], v[176:191]
  buffer_load_dwordx4 a[76:79], v3, s[20:23], s58 offen offset:64
  v_mfma_f32_32x32x16_bf16 v[64:79], a[0:3], a[24:27], v[64:79]
  s_waitcnt vmcnt(41)
  ds_write_b128 v9, a[248:251] offset:34816
  v_mfma_f32_32x32x16_bf16 v[80:95], a[4:7], a[24:27], v[80:95]
  buffer_load_dwordx4 a[108:111], v4, s[20:23], s58 offen
  v_mfma_f32_32x32x16_bf16 v[96:111], a[8:11], a[24:27], v[96:111]
  v_mfma_f32_32x32x16_bf16 v[112:127], a[12:15], a[24:27], v[112:127]
  s_waitcnt lgkmcnt(0)
  s_barrier
  v_mfma_f32_32x32x16_bf16 v[192:207], a[28:31], a[44:47], v[192:207]
  buffer_load_dwordx4 a[80:83], v4, s[20:23], s58 offen offset:64
  ds_read_b128 a[16:19], v12 offset:32768
  ds_read_b64_tr_b16 a[0:1], v14 offset:0
  ds_read_b64_tr_b16 a[2:3], v14 offset:1024
  s_add_u32 s59, s59, 0x40000
  s_and_b32 s59, s59, 0x3fffff
  s_lshr_b32 s58, s59, 12
  v_mfma_f32_32x32x16_bf16 v[208:223], a[32:35], a[44:47], v[208:223]
  buffer_load_dwordx4 a[56:59], v5, s[24:27], s59 offen
  ds_read_b64_tr_b16 a[4:5], v15 offset:0
  ds_read_b64_tr_b16 a[6:7], v15 offset:1024
  ds_read_b64_tr_b16 a[8:9], v16 offset:0
  v_mfma_f32_32x32x16_bf16 v[224:239], a[36:39], a[44:47], v[224:239]
  ds_read_b64_tr_b16 a[10:11], v16 offset:1024
  ds_read_b64_tr_b16 a[12:13], v17 offset:0
  ds_read_b64_tr_b16 a[14:15], v17 offset:1024
  v_mfma_f32_32x32x16_bf16 v[240:255], a[40:43], a[44:47], v[240:255]
  ds_read_b128 a[20:23], v12 offset:34816
  ds_read_b128 a[24:27], v12 offset:36864
  v_mfma_f32_32x32x16_bf16 v[128:143], a[28:31], a[48:51], v[128:143]
  s_waitcnt vmcnt(42)
  ds_write_b128 v10, a[196:199] offset:16384
  v_mfma_f32_32x32x16_bf16 v[144:159], a[32:35], a[48:51], v[144:159]
  buffer_load_dwordx4 a[60:63], v6, s[24:27], s59 offen
  v_mfma_f32_32x32x16_bf16 v[160:175], a[36:39], a[48:51], v[160:175]
  s_waitcnt vmcnt(42)
  ds_write_b128 v11, a[200:203] offset:16896
  v_mfma_f32_32x32x16_bf16 v[176:191], a[40:43], a[48:51], v[176:191]
  buffer_load_dwordx4 a[64:67], v7, s[24:27], s59 offen
  v_mfma_f32_32x32x16_bf16 v[64:79], a[28:31], a[52:55], v[64:79]
  s_waitcnt vmcnt(42)
  ds_write_b128 v10, a[204:207] offset:17408
  v_mfma_f32_32x32x16_bf16 v[80:95], a[32:35], a[52:55], v[80:95]
  buffer_load_dwordx4 a[68:71], v8, s[24:27], s59 offen
  s_add_u32 s59, s59, 0x40000
  s_and_b32 s59, s59, 0x3fffff
  s_lshr_b32 s58, s59, 12
  v_mfma_f32_32x32x16_bf16 v[96:111], a[36:39], a[52:55], v[96:111]
  s_waitcnt vmcnt(42)
  ds_write_b128 v11, a[208:211] offset:17920
  v_mfma_f32_32x32x16_bf16 v[112:127], a[40:43], a[52:55], v[112:127]
  s_mov_b32 s60, 0
  s_add_u32 m0, s62, 0
  s_waitcnt lgkmcnt(12)
  v_mfma_f32_32x32x16_bf16 v[192:207], a[0:3], a[16:19], v[192:207]
  buffer_load_dwordx4 v18, s[28:31], s60 offen offset:0 nt lds
  ds_read_b128 a[44:47], v13 offset:32768
  ds_read_b64_tr_b16 a[28:29], v14 offset:4096
  ds_read_b64_tr_b16 a[30:31], v14 offset:5120
  s_waitcnt lgkmcnt(13)
  v_mfma_f32_32x32x16_bf16 v[208:223], a[4:7], a[16:19], v[208:223]
  ds_read_b64_tr_b16 a[32:33], v15 offset:4096
  ds_read_b64_tr_b16 a[34:35], v15 offset:5120
  ds_read_b64_tr_b16 a[36:37], v16 offset:4096
  s_and_b32 s66, s52, 7
  s_lshl_b32 s66, s66, 1
  s_and_b32 s61, s3, 1
  s_add_u32 s66, s66, s61
  s_lshl_b32 s66, s66, 13
  s_lshl_b32 s61, s54, 18
  s_add_u32 s61, s61, s66
  v_lshlrev_b32 v29, 4, v1
  s_waitcnt lgkmcnt(14)
  v_mfma_f32_32x32x16_bf16 v[224:239], a[8:11], a[16:19], v[224:239]
  ds_read_b64_tr_b16 a[38:39], v16 offset:5120
  ds_read_b64_tr_b16 a[40:41], v17 offset:4096
  ds_read_b64_tr_b16 a[42:43], v17 offset:5120
  s_waitcnt lgkmcnt(15)
  v_mfma_f32_32x32x16_bf16 v[240:255], a[12:15], a[16:19], v[240:255]
  buffer_load_dword v28, v29, s[36:39], s61 offen
  ds_read_b128 a[48:51], v13 offset:34816
  ds_read_b128 a[52:55], v13 offset:36864
  s_waitcnt lgkmcnt(15)
  v_mfma_f32_32x32x16_bf16 v[128:143], a[0:3], a[20:23], v[128:143]
  ds_write_b128 v9, a[212:215] offset:45056
  v_mfma_f32_32x32x16_bf16 v[144:159], a[4:7], a[20:23], v[144:159]
  v_mfma_f32_32x32x16_bf16 v[160:175], a[8:11], a[20:23], v[160:175]
  ds_write_b128 v9, a[216:219] offset:46080
  v_mfma_f32_32x32x16_bf16 v[176:191], a[12:15], a[20:23], v[176:191]
  v_mfma_f32_32x32x16_bf16 v[64:79], a[0:3], a[24:27], v[64:79]
  ds_write_b128 v9, a[220:223] offset:47104
  s_add_u32 m0, s62, 64
  v_mfma_f32_32x32x16_bf16 v[80:95], a[4:7], a[24:27], v[80:95]
  buffer_load_dwordx4 v18, s[28:31], s60 offen offset:1024 nt lds
  s_add_u32 s61, s61, 1024
  v_mfma_f32_32x32x16_bf16 v[96:111], a[8:11], a[24:27], v[96:111]
  buffer_load_dword v28, v29, s[36:39], s61 offen
  v_mfma_f32_32x32x16_bf16 v[112:127], a[12:15], a[24:27], v[112:127]
  s_waitcnt lgkmcnt(0)
  s_barrier
  s_add_u32 m0, s62, 128
  v_mfma_f32_32x32x16_bf16 v[192:207], a[28:31], a[44:47], v[192:207]
  buffer_load_dwordx4 v18, s[28:31], s60 offen offset:2048 nt lds
  ds_read_b128 a[16:19], v12 offset:45056
  ds_read_b64_tr_b16 a[0:1], v14 offset:16384
  ds_read_b64_tr_b16 a[2:3], v14 offset:17408
  v_mfma_f32_32x32x16_bf16 v[208:223], a[32:35], a[44:47], v[208:223]
  ds_read_b64_tr_b16 a[4:5], v15 offset:16384
  ds_read_b64_tr_b16 a[6:7], v15 offset:17408
  ds_read_b64_tr_b16 a[8:9], v16 offset:16384
  v_mfma_f32_32x32x16_bf16 v[224:239], a[36:39], a[44:47], v[224:239]
  ds_read_b64_tr_b16 a[10:11], v16 offset:17408
  ds_read_b64_tr_b16 a[12:13], v17 offset:16384
  ds_read_b64_tr_b16 a[14:15], v17 offset:17408
  s_add_u32 s61, s61, 1024
  v_mfma_f32_32x32x16_bf16 v[240:255], a[40:43], a[44:47], v[240:255]
  buffer_load_dword v28, v29, s[36:39], s61 offen
  ds_read_b128 a[20:23], v12 offset:47104
  ds_read_b128 a[24:27], v12 offset:49152
  v_mfma_f32_32x32x16_bf16 v[128:143], a[28:31], a[48:51], v[128:143]
  s_waitcnt vmcnt(47)
  ds_write_b128 v10, a[168:171] offset:0
  v_mfma_f32_32x32x16_bf16 v[144:159], a[32:35], a[48:51], v[144:159]
  v_mfma_f32_32x32x16_bf16 v[160:175], a[36:39], a[48:51], v[160:175]
  s_waitcnt vmcnt(46)
  ds_write_b128 v11, a[172:175] offset:512
  v_mfma_f32_32x32x16_bf16 v[176:191], a[40:43], a[48:51], v[176:191]
  v_mfma_f32_32x32x16_bf16 v[64:79], a[28:31], a[52:55], v[64:79]
  s_waitcnt vmcnt(45)
  ds_write_b128 v10, a[176:179] offset:1024
  s_add_u32 s61, s61, 1024
  v_mfma_f32_32x32x16_bf16 v[80:95], a[32:35], a[52:55], v[80:95]
  buffer_load_dword v28, v29, s[36:39], s61 offen
  v_mfma_f32_32x32x16_bf16 v[96:111], a[36:39], a[52:55], v[96:111]
  s_waitcnt vmcnt(45)
  ds_write_b128 v11, a[180:183] offset:1536
  s_add_u32 m0, s62, 192
  v_mfma_f32_32x32x16_bf16 v[112:127], a[40:43], a[52:55], v[112:127]
  buffer_load_dwordx4 v18, s[28:31], s60 offen offset:3072 nt lds
  s_mov_b32 s60, 4096
  s_add_u32 m0, s62, 4352
  s_waitcnt lgkmcnt(12)
  v_mfma_f32_32x32x16_bf16 v[192:207], a[0:3], a[16:19], v[192:207]
  buffer_load_dwordx4 v18, s[28:31], s60 offen offset:0 nt lds
  ds_read_b128 a[44:47], v13 offset:45056
  ds_read_b64_tr_b16 a[28:29], v14 offset:20480
  ds_read_b64_tr_b16 a[30:31], v14 offset:21504
  s_waitcnt lgkmcnt(13)
  v_mfma_f32_32x32x16_bf16 v[208:223], a[4:7], a[16:19], v[208:223]
  ds_read_b64_tr_b16 a[32:33], v15 offset:20480
  ds_read_b64_tr_b16 a[34:35], v15 offset:21504
  ds_read_b64_tr_b16 a[36:37], v16 offset:20480
  s_waitcnt lgkmcnt(14)
  v_mfma_f32_32x32x16_bf16 v[224:239], a[8:11], a[16:19], v[224:239]
  ds_read_b64_tr_b16 a[38:39], v16 offset:21504
  ds_read_b64_tr_b16 a[40:41], v17 offset:20480
  ds_read_b64_tr_b16 a[42:43], v17 offset:21504
  s_add_u32 s61, s61, 1024
  s_waitcnt lgkmcnt(15)
  v_mfma_f32_32x32x16_bf16 v[240:255], a[12:15], a[16:19], v[240:255]
  buffer_load_dword v28, v29, s[36:39], s61 offen
  ds_read_b128 a[48:51], v13 offset:47104
  ds_read_b128 a[52:55], v13 offset:49152
  s_waitcnt lgkmcnt(15)
  v_mfma_f32_32x32x16_bf16 v[128:143], a[0:3], a[20:23], v[128:143]
  s_waitcnt vmcnt(47)
  ds_write_b128 v9, a[184:187] offset:32768
  v_mfma_f32_32x32x16_bf16 v[144:159], a[4:7], a[20:23], v[144:159]
  v_mfma_f32_32x32x16_bf16 v[160:175], a[8:11], a[20:23], v[160:175]
  s_waitcnt vmcnt(45)
  ds_write_b128 v9, a[188:191] offset:33792
  v_mfma_f32_32x32x16_bf16 v[176:191], a[12:15], a[20:23], v[176:191]
  v_mfma_f32_32x32x16_bf16 v[64:79], a[0:3], a[24:27], v[64:79]
  s_waitcnt vmcnt(43)
  ds_write_b128 v9, a[192:195] offset:34816
  s_add_u32 m0, s62, 4416
  v_mfma_f32_32x32x16_bf16 v[80:95], a[4:7], a[24:27], v[80:95]
  buffer_load_dwordx4 v18, s[28:31], s60 offen offset:1024 nt lds
  s_add_u32 s61, s61, 1024
  v_mfma_f32_32x32x16_bf16 v[96:111], a[8:11], a[24:27], v[96:111]
  buffer_load_dword v28, v29, s[36:39], s61 offen
  v_mfma_f32_32x32x16_bf16 v[112:127], a[12:15], a[24:27], v[112:127]
  s_waitcnt lgkmcnt(0)
  s_barrier
  s_add_u32 m0, s62, 4480
  v_mfma_f32_32x32x16_bf16 v[192:207], a[28:31], a[44:47], v[192:207]
  buffer_load_dwordx4 v18, s[28:31], s60 offen offset:2048 nt lds
  ds_read_b128 a[16:19], v12 offset:32768
  ds_read_b64_tr_b16 a[0:1], v14 offset:0
  ds_read_b64_tr_b16 a[2:3], v14 offset:1024
  v_mfma_f32_32x32x16_bf16 v[208:223], a[32:35], a[44:47], v[208:223]
  ds_read_b64_tr_b16 a[4:5], v15 offset:0
  ds_read_b64_tr_b16 a[6:7], v15 offset:1024
  ds_read_b64_tr_b16 a[8:9], v16 offset:0
  v_mfma_f32_32x32x16_bf16 v[224:239], a[36:39], a[44:47], v[224:239]
  ds_read_b64_tr_b16 a[10:11], v16 offset:1024
  ds_read_b64_tr_b16 a[12:13], v17 offset:0
  ds_read_b64_tr_b16 a[14:15], v17 offset:1024
  s_add_u32 s61, s61, 1024
  v_mfma_f32_32x32x16_bf16 v[240:255], a[40:43], a[44:47], v[240:255]
  buffer_load_dword v28, v29, s[36:39], s61 offen
  ds_read_b128 a[20:23], v12 offset:34816
  ds_read_b128 a[24:27], v12 offset:36864
  v_mfma_f32_32x32x16_bf16 v[128:143], a[28:31], a[48:51], v[128:143]
  s_waitcnt vmcnt(45)
  ds_write_b128 v10, v[32:35] offset:16384
  v_mfma_f32_32x32x16_bf16 v[144:159], a[32:35], a[48:51], v[144:159]
  v_mfma_f32_32x32x16_bf16 v[160:175], a[36:39], a[48:51], v[160:175]
  s_waitcnt vmcnt(44)
  ds_write_b128 v11, v[36:39] offset:16896
  v_mfma_f32_32x32x16_bf16 v[176:191], a[40:43], a[48:51], v[176:191]
  v_mfma_f32_32x32x16_bf16 v[64:79], a[28:31], a[52:55], v[64:79]
  s_waitcnt vmcnt(43)
  ds_write_b128 v10, v[40:43] offset:17408
  s_add_u32 s61, s61, 1024
  v_mfma_f32_32x32x16_bf16 v[80:95], a[32:35], a[52:55], v[80:95]
  buffer_load_dword v28, v29, s[36:39], s61 offen
  v_mfma_f32_32x32x16_bf16 v[96:111], a[36:39], a[52:55], v[96:111]
  s_waitcnt vmcnt(43)
  ds_write_b128 v11, v[44:47] offset:17920
  s_add_u32 m0, s62, 4544
  v_mfma_f32_32x32x16_bf16 v[112:127], a[40:43], a[52:55], v[112:127]
  buffer_load_dwordx4 v18, s[28:31], s60 offen offset:3072 nt lds
  s_waitcnt lgkmcnt(12)
  v_mfma_f32_32x32x16_bf16 v[192:207], a[0:3], a[16:19], v[192:207]
  ds_read_b128 a[44:47], v13 offset:32768
  ds_read_b64_tr_b16 a[28:29], v14 offset:4096
  ds_read_b64_tr_b16 a[30:31], v14 offset:5120
  s_waitcnt lgkmcnt(13)
  v_mfma_f32_32x32x16_bf16 v[208:223], a[4:7], a[16:19], v[208:223]
  ds_read_b64_tr_b16 a[32:33], v15 offset:4096
  ds_read_b64_tr_b16 a[34:35], v15 offset:5120
  ds_read_b64_tr_b16 a[36:37], v16 offset:4096
  s_waitcnt lgkmcnt(14)
  v_mfma_f32_32x32x16_bf16 v[224:239], a[8:11], a[16:19], v[224:239]
  ds_read_b64_tr_b16 a[38:39], v16 offset:5120
  ds_read_b64_tr_b16 a[40:41], v17 offset:4096
  ds_read_b64_tr_b16 a[42:43], v17 offset:5120
  s_waitcnt lgkmcnt(15)
  v_mfma_f32_32x32x16_bf16 v[240:255], a[12:15], a[16:19], v[240:255]
  ds_read_b128 a[48:51], v13 offset:34816
  ds_read_b128 a[52:55], v13 offset:36864
  s_waitcnt lgkmcnt(15)
  v_mfma_f32_32x32x16_bf16 v[128:143], a[0:3], a[20:23], v[128:143]
  ds_write_b128 v9, v[48:51] offset:45056
  v_mfma_f32_32x32x16_bf16 v[144:159], a[4:7], a[20:23], v[144:159]
  v_mfma_f32_32x32x16_bf16 v[160:175], a[8:11], a[20:23], v[160:175]
  ds_write_b128 v9, v[52:55] offset:46080
  v_mfma_f32_32x32x16_bf16 v[176:191], a[12:15], a[20:23], v[176:191]
  v_mfma_f32_32x32x16_bf16 v[64:79], a[0:3], a[24:27], v[64:79]
  ds_write_b128 v9, v[56:59] offset:47104
  s_mov_b32 s60, 8192
  s_add_u32 m0, s62, 34816
  v_mfma_f32_32x32x16_bf16 v[80:95], a[4:7], a[24:27], v[80:95]
  buffer_load_dwordx4 v18, s[28:31], s60 offen offset:0 nt lds
  v_mfma_f32_32x32x16_bf16 v[96:111], a[8:11], a[24:27], v[96:111]
  v_mfma_f32_32x32x16_bf16 v[112:127], a[12:15], a[24:27], v[112:127]
  s_waitcnt lgkmcnt(0)
  s_barrier
  v_mfma_f32_32x32x16_bf16 v[192:207], a[28:31], a[44:47], v[192:207]
  ds_read_b128 a[16:19], v12 offset:45056
  ds_read_b64_tr_b16 a[0:1], v14 offset:16384
  ds_read_b64_tr_b16 a[2:3], v14 offset:17408
  s_add_u32 m0, s62, 34880
  v_mfma_f32_32x32x16_bf16 v[208:223], a[32:35], a[44:47], v[208:223]
  buffer_load_dwordx4 v18, s[28:31], s60 offen offset:1024 nt lds
  ds_read_b64_tr_b16 a[4:5], v15 offset:16384
  ds_read_b64_tr_b16 a[6:7], v15 offset:17408
  ds_read_b64_tr_b16 a[8:9], v16 offset:16384
  v_mfma_f32_32x32x16_bf16 v[224:239], a[36:39], a[44:47], v[224:239]
  ds_read_b64_tr_b16 a[10:11], v16 offset:17408
  ds_read_b64_tr_b16 a[12:13], v17 offset:16384
  ds_read_b64_tr_b16 a[14:15], v17 offset:17408
  v_mfma_f32_32x32x16_bf16 v[240:255], a[40:43], a[44:47], v[240:255]
  ds_read_b128 a[20:23], v12 offset:47104
  ds_read_b128 a[24:27], v12 offset:49152
  v_mfma_f32_32x32x16_bf16 v[128:143], a[28:31], a[48:51], v[128:143]
  s_waitcnt vmcnt(45)
  ds_write_b128 v10, a[140:143] offset:0
  v_mfma_f32_32x32x16_bf16 v[144:159], a[32:35], a[48:51], v[144:159]
  v_mfma_f32_32x32x16_bf16 v[160:175], a[36:39], a[48:51], v[160:175]
  s_waitcnt vmcnt(44)
  ds_write_b128 v11, a[144:147] offset:512
  v_mfma_f32_32x32x16_bf16 v[176:191], a[40:43], a[48:51], v[176:191]
  v_mfma_f32_32x32x16_bf16 v[64:79], a[28:31], a[52:55], v[64:79]
  s_waitcnt vmcnt(43)
  ds_write_b128 v10, a[148:151] offset:1024
  v_mfma_f32_32x32x16_bf16 v[80:95], a[32:35], a[52:55], v[80:95]
  v_mfma_f32_32x32x16_bf16 v[96:111], a[36:39], a[52:55], v[96:111]
  s_waitcnt vmcnt(42)
  ds_write_b128 v11, a[152:155] offset:1536
  s_add_u32 m0, s62, 34944
  v_mfma_f32_32x32x16_bf16 v[112:127], a[40:43], a[52:55], v[112:127]
  buffer_load_dwordx4 v18, s[28:31], s60 offen offset:2048 nt lds
  s_waitcnt lgkmcnt(12)
  v_mfma_f32_32x32x16_bf16 v[192:207], a[0:3], a[16:19], v[192:207]
  ds_read_b128 a[44:47], v13 offset:45056
  ds_read_b64_tr_b16 a[28:29], v14 offset:20480
  ds_read_b64_tr_b16 a[30:31], v14 offset:21504
  s_waitcnt lgkmcnt(13)
  v_mfma_f32_32x32x16_bf16 v[208:223], a[4:7], a[16:19], v[208:223]
  ds_read_b64_tr_b16 a[32:33], v15 offset:20480
  ds_read_b64_tr_b16 a[34:35], v15 offset:21504
  ds_read_b64_tr_b16 a[36:37], v16 offset:20480
  s_waitcnt lgkmcnt(14)
  v_mfma_f32_32x32x16_bf16 v[224:239], a[8:11], a[16:19], v[224:239]
  ds_read_b64_tr_b16 a[38:39], v16 offset:21504
  ds_read_b64_tr_b16 a[40:41], v17 offset:20480
  ds_read_b64_tr_b16 a[42:43], v17 offset:21504
  s_waitcnt lgkmcnt(15)
  v_mfma_f32_32x32x16_bf16 v[240:255], a[12:15], a[16:19], v[240:255]
  ds_read_b128 a[48:51], v13 offset:47104
  ds_read_b128 a[52:55], v13 offset:49152
  s_waitcnt lgkmcnt(15)
  v_mfma_f32_32x32x16_bf16 v[128:143], a[0:3], a[20:23], v[128:143]
  s_waitcnt vmcnt(42)
  ds_write_b128 v9, a[156:159] offset:32768
  v_mfma_f32_32x32x16_bf16 v[144:159], a[4:7], a[20:23], v[144:159]
  v_mfma_f32_32x32x16_bf16 v[160:175], a[8:11], a[20:23], v[160:175]
  s_waitcnt vmcnt(40)
  ds_write_b128 v9, a[160:163] offset:33792
  v_mfma_f32_32x32x16_bf16 v[176:191], a[12:15], a[20:23], v[176:191]
  v_mfma_f32_32x32x16_bf16 v[64:79], a[0:3], a[24:27], v[64:79]
  s_waitcnt vmcnt(38)
  ds_write_b128 v9, a[164:167] offset:34816
  s_add_u32 m0, s62, 35008
  v_mfma_f32_32x32x16_bf16 v[80:95], a[4:7], a[24:27], v[80:95]
  buffer_load_dwordx4 v18, s[28:31], s60 offen offset:3072 nt lds
  s_mov_b32 s60, 12288
  s_add_u32 m0, s62, 39168
  v_mfma_f32_32x32x16_bf16 v[96:111], a[8:11], a[24:27], v[96:111]
  buffer_load_dwordx4 v18, s[28:31], s60 offen offset:0 nt lds
  v_mfma_f32_32x32x16_bf16 v[112:127], a[12:15], a[24:27], v[112:127]
  s_waitcnt lgkmcnt(0)
  s_barrier
  v_mfma_f32_32x32x16_bf16 v[192:207], a[28:31], a[44:47], v[192:207]
  ds_read_b128 a[16:19], v12 offset:32768
  ds_read_b64_tr_b16 a[0:1], v14 offset:0
  ds_read_b64_tr_b16 a[2:3], v14 offset:1024
  v_mfma_f32_32x32x16_bf16 v[208:223], a[32:35], a[44:47], v[208:223]
  ds_read_b64_tr_b16 a[4:5], v15 offset:0
  ds_read_b64_tr_b16 a[6:7], v15 offset:1024
  ds_read_b64_tr_b16 a[8:9], v16 offset:0
  v_mfma_f32_32x32x16_bf16 v[224:239], a[36:39], a[44:47], v[224:239]
  ds_read_b64_tr_b16 a[10:11], v16 offset:1024
  ds_read_b64_tr_b16 a[12:13], v17 offset:0
  ds_read_b64_tr_b16 a[14:15], v17 offset:1024
  v_mfma_f32_32x32x16_bf16 v[240:255], a[40:43], a[44:47], v[240:255]
  ds_read_b128 a[20:23], v12 offset:34816
  ds_read_b128 a[24:27], v12 offset:36864
  v_mfma_f32_32x32x16_bf16 v[128:143], a[28:31], a[48:51], v[128:143]
  s_waitcnt vmcnt(38)
  ds_write_b128 v10, a[112:115] offset:16384
  v_mfma_f32_32x32x16_bf16 v[144:159], a[32:35], a[48:51], v[144:159]
  v_mfma_f32_32x32x16_bf16 v[160:175], a[36:39], a[48:51], v[160:175]
  s_waitcnt vmcnt(37)
  ds_write_b128 v11, a[116:119] offset:16896
  v_mfma_f32_32x32x16_bf16 v[176:191], a[40:43], a[48:51], v[176:191]
  v_mfma_f32_32x32x16_bf16 v[64:79], a[28:31], a[52:55], v[64:79]
  s_waitcnt vmcnt(36)
  ds_write_b128 v10, a[120:123] offset:17408
  v_mfma_f32_32x32x16_bf16 v[80:95], a[32:35], a[52:55], v[80:95]
  v_mfma_f32_32x32x16_bf16 v[96:111], a[36:39], a[52:55], v[96:111]
  s_waitcnt vmcnt(35)
  ds_write_b128 v11, a[124:127] offset:17920
  s_add_u32 m0, s62, 39232
  v_mfma_f32_32x32x16_bf16 v[112:127], a[40:43], a[52:55], v[112:127]
  buffer_load_dwordx4 v18, s[28:31], s60 offen offset:1024 nt lds
  s_add_u32 m0, s62, 39296
  s_waitcnt lgkmcnt(12)
  v_mfma_f32_32x32x16_bf16 v[192:207], a[0:3], a[16:19], v[192:207]
  buffer_load_dwordx4 v18, s[28:31], s60 offen offset:2048 nt lds
  ds_read_b128 a[44:47], v13 offset:32768
  ds_read_b64_tr_b16 a[28:29], v14 offset:4096
  ds_read_b64_tr_b16 a[30:31], v14 offset:5120
  s_waitcnt lgkmcnt(13)
  v_mfma_f32_32x32x16_bf16 v[208:223], a[4:7], a[16:19], v[208:223]
  ds_read_b64_tr_b16 a[32:33], v15 offset:4096
  ds_read_b64_tr_b16 a[34:35], v15 offset:5120
  ds_read_b64_tr_b16 a[36:37], v16 offset:4096
  s_waitcnt lgkmcnt(14)
  v_mfma_f32_32x32x16_bf16 v[224:239], a[8:11], a[16:19], v[224:239]
  ds_read_b64_tr_b16 a[38:39], v16 offset:5120
  ds_read_b64_tr_b16 a[40:41], v17 offset:4096
  ds_read_b64_tr_b16 a[42:43], v17 offset:5120
  s_waitcnt lgkmcnt(15)
  v_mfma_f32_32x32x16_bf16 v[240:255], a[12:15], a[16:19], v[240:255]
  ds_read_b128 a[48:51], v13 offset:34816
  ds_read_b128 a[52:55], v13 offset:36864
  s_waitcnt lgkmcnt(15)
  v_mfma_f32_32x32x16_bf16 v[128:143], a[0:3], a[20:23], v[128:143]
  ds_write_b128 v9, a[128:131] offset:45056
  v_mfma_f32_32x32x16_bf16 v[144:159], a[4:7], a[20:23], v[144:159]
  v_mfma_f32_32x32x16_bf16 v[160:175], a[8:11], a[20:23], v[160:175]
  ds_write_b128 v9, a[132:135] offset:46080
  v_mfma_f32_32x32x16_bf16 v[176:191], a[12:15], a[20:23], v[176:191]
  v_mfma_f32_32x32x16_bf16 v[64:79], a[0:3], a[24:27], v[64:79]
  ds_write_b128 v9, a[136:139] offset:47104
  s_add_u32 m0, s62, 39360
  v_mfma_f32_32x32x16_bf16 v[80:95], a[4:7], a[24:27], v[80:95]
  buffer_load_dwordx4 v18, s[28:31], s60 offen offset:3072 nt lds
  v_mfma_f32_32x32x16_bf16 v[96:111], a[8:11], a[24:27], v[96:111]
  v_mfma_f32_32x32x16_bf16 v[112:127], a[12:15], a[24:27], v[112:127]
  s_waitcnt lgkmcnt(0)
  s_barrier
  s_mov_b32 s60, 16384
  s_add_u32 m0, s62, 69632
  v_mfma_f32_32x32x16_bf16 v[192:207], a[28:31], a[44:47], v[192:207]
  buffer_load_dwordx4 v18, s[28:31], s60 offen offset:0 nt lds
  ds_read_b128 a[16:19], v12 offset:45056
  ds_read_b64_tr_b16 a[0:1], v14 offset:16384
  ds_read_b64_tr_b16 a[2:3], v14 offset:17408
  v_mfma_f32_32x32x16_bf16 v[208:223], a[32:35], a[44:47], v[208:223]
  ds_read_b64_tr_b16 a[4:5], v15 offset:16384
  ds_read_b64_tr_b16 a[6:7], v15 offset:17408
  ds_read_b64_tr_b16 a[8:9], v16 offset:16384
  v_mfma_f32_32x32x16_bf16 v[224:239], a[36:39], a[44:47], v[224:239]
  ds_read_b64_tr_b16 a[10:11], v16 offset:17408
  ds_read_b64_tr_b16 a[12:13], v17 offset:16384
  ds_read_b64_tr_b16 a[14:15], v17 offset:17408
  v_mfma_f32_32x32x16_bf16 v[240:255], a[40:43], a[44:47], v[240:255]
  ds_read_b128 a[20:23], v12 offset:47104
  ds_read_b128 a[24:27], v12 offset:49152
  v_mfma_f32_32x32x16_bf16 v[128:143], a[28:31], a[48:51], v[128:143]
  s_waitcnt vmcnt(38)
  ds_write_b128 v10, a[84:87] offset:0
  v_mfma_f32_32x32x16_bf16 v[144:159], a[32:35], a[48:51], v[144:159]
  v_mfma_f32_32x32x16_bf16 v[160:175], a[36:39], a[48:51], v[160:175]
  s_waitcnt vmcnt(37)
  ds_write_b128 v11, a[88:91] offset:512
  v_mfma_f32_32x32x16_bf16 v[176:191], a[40:43], a[48:51], v[176:191]
  v_mfma_f32_32x32x16_bf16 v[64:79], a[28:31], a[52:55], v[64:79]
  s_waitcnt vmcnt(36)
  ds_write_b128 v10, a[92:95] offset:1024
  v_mfma_f32_32x32x16_bf16 v[80:95], a[32:35], a[52:55], v[80:95]
  v_mfma_f32_32x32x16_bf16 v[96:111], a[36:39], a[52:55], v[96:111]
  s_waitcnt vmcnt(35)
  ds_write_b128 v11, a[96:99] offset:1536
  s_add_u32 m0, s62, 69696
  v_mfma_f32_32x32x16_bf16 v[112:127], a[40:43], a[52:55], v[112:127]
  buffer_load_dwordx4 v18, s[28:31], s60 offen offset:1024 nt lds
  s_waitcnt lgkmcnt(12)
  v_mfma_f32_32x32x16_bf16 v[192:207], a[0:3], a[16:19], v[192:207]
  ds_read_b128 a[44:47], v13 offset:45056
  ds_read_b64_tr_b16 a[28:29], v14 offset:20480
  ds_read_b64_tr_b16 a[30:31], v14 offset:21504
  s_add_u32 m0, s62, 69760
  s_waitcnt lgkmcnt(13)
  v_mfma_f32_32x32x16_bf16 v[208:223], a[4:7], a[16:19], v[208:223]
  buffer_load_dwordx4 v18, s[28:31], s60 offen offset:2048 nt lds
  ds_read_b64_tr_b16 a[32:33], v15 offset:20480
  ds_read_b64_tr_b16 a[34:35], v15 offset:21504
  ds_read_b64_tr_b16 a[36:37], v16 offset:20480
  s_waitcnt lgkmcnt(14)
  v_mfma_f32_32x32x16_bf16 v[224:239], a[8:11], a[16:19], v[224:239]
  ds_read_b64_tr_b16 a[38:39], v16 offset:21504
  ds_read_b64_tr_b16 a[40:41], v17 offset:20480
  ds_read_b64_tr_b16 a[42:43], v17 offset:21504
  s_waitcnt lgkmcnt(15)
  v_mfma_f32_32x32x16_bf16 v[240:255], a[12:15], a[16:19], v[240:255]
  ds_read_b128 a[48:51], v13 offset:47104
  ds_read_b128 a[52:55], v13 offset:49152
  s_waitcnt lgkmcnt(15)
  v_mfma_f32_32x32x16_bf16 v[128:143], a[0:3], a[20:23], v[128:143]
  s_waitcnt vmcnt(36)
  ds_write_b128 v9, a[100:103] offset:32768
  v_mfma_f32_32x32x16_bf16 v[144:159], a[4:7], a[20:23], v[144:159]
  v_mfma_f32_32x32x16_bf16 v[160:175], a[8:11], a[20:23], v[160:175]
  s_waitcnt vmcnt(34)
  ds_write_b128 v9, a[104:107] offset:33792
  v_mfma_f32_32x32x16_bf16 v[176:191], a[12:15], a[20:23], v[176:191]
  v_mfma_f32_32x32x16_bf16 v[64:79], a[0:3], a[24:27], v[64:79]
  s_waitcnt vmcnt(32)
  ds_write_b128 v9, a[108:111] offset:34816
  s_add_u32 m0, s62, 69824
  v_mfma_f32_32x32x16_bf16 v[80:95], a[4:7], a[24:27], v[80:95]
  buffer_load_dwordx4 v18, s[28:31], s60 offen offset:3072 nt lds
  v_mfma_f32_32x32x16_bf16 v[96:111], a[8:11], a[24:27], v[96:111]
  v_mfma_f32_32x32x16_bf16 v[112:127], a[12:15], a[24:27], v[112:127]
  s_waitcnt vmcnt(12)
  s_waitcnt lgkmcnt(0)
  s_barrier
  v_mfma_f32_32x32x16_bf16 v[192:207], a[28:31], a[44:47], v[192:207]
  ds_read_b128 a[16:19], v12 offset:32768
  ds_read_b64_tr_b16 a[0:1], v14 offset:0
  ds_read_b64_tr_b16 a[2:3], v14 offset:1024
  v_mfma_f32_32x32x16_bf16 v[208:223], a[32:35], a[44:47], v[208:223]
  ds_read_b64_tr_b16 a[4:5], v15 offset:0
  ds_read_b64_tr_b16 a[6:7], v15 offset:1024
  ds_read_b64_tr_b16 a[8:9], v16 offset:0
  v_mfma_f32_32x32x16_bf16 v[224:239], a[36:39], a[44:47], v[224:239]
  ds_read_b64_tr_b16 a[10:11], v16 offset:1024
  ds_read_b64_tr_b16 a[12:13], v17 offset:0
  ds_read_b64_tr_b16 a[14:15], v17 offset:1024
  v_mfma_f32_32x32x16_bf16 v[240:255], a[40:43], a[44:47], v[240:255]
  ds_read_b128 a[20:23], v12 offset:34816
  ds_read_b128 a[24:27], v12 offset:36864
  v_mfma_f32_32x32x16_bf16 v[128:143], a[28:31], a[48:51], v[128:143]
  ds_write_b128 v10, a[56:59] offset:16384
  ds_read_b64_tr_b16 a[224:225], v23 offset:0
  v_mfma_f32_32x32x16_bf16 v[144:159], a[32:35], a[48:51], v[144:159]
  ds_read_b128 a[192:195], v19 offset:0
  ds_read_b128 a[196:199], v20 offset:0
  ds_read_b64_tr_b16 a[232:233], v23 offset:128
  v_mfma_f32_32x32x16_bf16 v[160:175], a[36:39], a[48:51], v[160:175]
  ds_write_b128 v11, a[60:63] offset:16896
  ds_read_b64_tr_b16 a[226:227], v23 offset:256
  v_mfma_f32_32x32x16_bf16 v[176:191], a[40:43], a[48:51], v[176:191]
  buffer_store_dword v26, v25, s[44:47], s75 offen sc1
  ds_read_b128 a[200:203], v19 offset:64
  ds_read_b128 a[204:207], v20 offset:64
  ds_read_b64_tr_b16 a[234:235], v23 offset:384
  v_mfma_f32_32x32x16_bf16 v[64:79], a[28:31], a[52:55], v[64:79]
  ds_write_b128 v10, a[64:67] offset:17408
  ds_read_b64_tr_b16 a[228:229], v23 offset:64
  s_add_u32 s67, s68, 9216
  v_mfma_f32_32x32x16_bf16 v[80:95], a[32:35], a[52:55], v[80:95]
  buffer_store_dword v26, off, s[40:43], s67 sc1
  ds_read_b128 a[208:211], v19 offset:128
  ds_read_b128 a[212:215], v20 offset:128
  ds_read_b64_tr_b16 a[236:237], v23 offset:192
  v_mfma_f32_32x32x16_bf16 v[96:111], a[36:39], a[52:55], v[96:111]
  ds_write_b128 v11, a[68:71] offset:17920
  ds_read_b64_tr_b16 a[230:231], v23 offset:320
  s_mov_b32 s60, 20480
  s_add_u32 m0, s62, 73984
  v_mfma_f32_32x32x16_bf16 v[112:127], a[40:43], a[52:55], v[112:127]
  buffer_load_dwordx4 v18, s[28:31], s60 offen offset:0 nt lds
  ds_read_b128 a[216:219], v19 offset:192
  ds_read_b128 a[220:223], v20 offset:192
  ds_read_b64_tr_b16 a[238:239], v23 offset:448
  s_add_u32 m0, s62, 74048
  s_waitcnt lgkmcnt(15)
  v_mfma_f32_32x32x16_bf16 v[192:207], a[0:3], a[16:19], v[192:207]
  buffer_load_dwordx4 v18, s[28:31], s60 offen offset:1024 nt lds
  ds_read_b128 a[44:47], v13 offset:32768
  ds_read_b64_tr_b16 a[28:29], v14 offset:4096
  ds_read_b64_tr_b16 a[30:31], v14 offset:5120
  s_add_u32 s67, s69, 6148
  v_mfma_f32_32x32x16_bf16 v[208:223], a[4:7], a[16:19], v[208:223]
  buffer_store_dword v26, off, s[40:43], s67 sc1
  ds_read_b64_tr_b16 a[32:33], v15 offset:4096
  ds_read_b64_tr_b16 a[34:35], v15 offset:5120
  ds_read_b64_tr_b16 a[36:37], v16 offset:4096
  v_mfma_f32_32x32x16_bf16 v[224:239], a[8:11], a[16:19], v[224:239]
  ds_read_b64_tr_b16 a[38:39], v16 offset:5120
  ds_read_b64_tr_b16 a[40:41], v17 offset:4096
  ds_read_b64_tr_b16 a[42:43], v17 offset:5120
  v_mfma_f32_32x32x16_bf16 v[240:255], a[12:15], a[16:19], v[240:255]
  ds_read_b128 a[48:51], v13 offset:34816
  ds_read_b128 a[52:55], v13 offset:36864
  v_mfma_f32_32x32x16_bf16 v[128:143], a[0:3], a[20:23], v[128:143]
  ds_write_b128 v9, a[72:75] offset:45056
  v_mfma_f32_32x32x16_bf16 v[144:159], a[4:7], a[20:23], v[144:159]
  ds_read_b64_tr_b16 a[240:241], v23 offset:4352
  ds_read_b64_tr_b16 a[242:243], v23 offset:4608
  ds_read_b64_tr_b16 a[244:245], v23 offset:4416
  v_mfma_f32_32x32x16_bf16 v[160:175], a[8:11], a[20:23], v[160:175]
  ds_write_b128 v9, a[76:79] offset:46080
  v_mfma_f32_32x32x16_bf16 v[176:191], a[12:15], a[20:23], v[176:191]
  buffer_store_dwordx4 v[60:63], v25, s[40:43], s70 offen offset:0 sc1
  ds_read_b64_tr_b16 a[246:247], v23 offset:4672
  ds_read_b64_tr_b16 a[248:249], v23 offset:4480
  ds_read_b64_tr_b16 a[250:251], v23 offset:4736
  v_mfma_f32_32x32x16_bf16 v[64:79], a[0:3], a[24:27], v[64:79]
  ds_write_b128 v9, a[80:83] offset:47104
  s_add_u32 m0, s62, 74112
  v_mfma_f32_32x32x16_bf16 v[80:95], a[4:7], a[24:27], v[80:95]
  buffer_load_dwordx4 v18, s[28:31], s60 offen offset:2048 nt lds
  ds_read_b64_tr_b16 a[252:253], v23 offset:4544
  ds_read_b64_tr_b16 a[254:255], v23 offset:4800
  v_mfma_f32_32x32x16_bf16 v[96:111], a[8:11], a[24:27], v[96:111]
  v_mfma_f32_32x32x16_bf16 v[112:127], a[12:15], a[24:27], v[112:127]
  s_waitcnt lgkmcnt(0)
  s_barrier
  s_add_u32 m0, s62, 74176
  v_mfma_f32_32x32x16_bf16 v[192:207], a[28:31], a[44:47], v[192:207]
  buffer_load_dwordx4 v18, s[28:31], s60 offen offset:3072 nt lds
  ds_read_b128 a[16:19], v12 offset:45056
  ds_read_b64_tr_b16 a[0:1], v14 offset:16384
  ds_read_b64_tr_b16 a[2:3], v14 offset:17408
  v_mfma_f32_32x32x16_bf16 v[208:223], a[32:35], a[44:47], v[208:223]
  buffer_store_dwordx4 v[60:63], v25, s[40:43], s70 offen offset:1024 sc1
  ds_read_b64_tr_b16 a[4:5], v15 offset:16384
  ds_read_b64_tr_b16 a[6:7], v15 offset:17408
  ds_read_b64_tr_b16 a[8:9], v16 offset:16384
  v_mfma_f32_32x32x16_bf16 v[224:239], a[36:39], a[44:47], v[224:239]
  ds_read_b64_tr_b16 a[10:11], v16 offset:17408
  ds_read_b64_tr_b16 a[12:13], v17 offset:16384
  ds_read_b64_tr_b16 a[14:15], v17 offset:17408
  v_mfma_f32_32x32x16_bf16 v[240:255], a[40:43], a[44:47], v[240:255]
  ds_read_b128 a[20:23], v12 offset:47104
  ds_read_b128 a[24:27], v12 offset:49152
  v_mfma_f32_32x32x16_bf16 v[128:143], a[28:31], a[48:51], v[128:143]
  s_mov_b32 s60, 24576
  s_add_u32 m0, s62, 0
  v_mfma_f32_32x32x16_bf16 v[144:159], a[32:35], a[48:51], v[144:159]
  buffer_load_dwordx4 v18, s[28:31], s60 offen offset:0 nt lds
  v_mfma_f32_32x32x16_bf16 v[160:175], a[36:39], a[48:51], v[160:175]
  buffer_store_dwordx4 v[60:63], v25, s[40:43], s70 offen offset:2048 sc1
  v_mfma_f32_32x32x16_bf16 v[176:191], a[40:43], a[48:51], v[176:191]
  v_mfma_f32_32x32x16_bf16 v[64:79], a[28:31], a[52:55], v[64:79]
  v_mfma_f32_32x32x16_bf16 v[80:95], a[32:35], a[52:55], v[80:95]
  v_mfma_f32_32x32x16_bf16 v[96:111], a[36:39], a[52:55], v[96:111]
  v_mfma_f32_32x32x16_bf16 v[112:127], a[40:43], a[52:55], v[112:127]
  s_add_u32 m0, s62, 64
  s_waitcnt lgkmcnt(8)
  v_mfma_f32_32x32x16_bf16 v[192:207], a[0:3], a[16:19], v[192:207]
  buffer_load_dwordx4 v18, s[28:31], s60 offen offset:1024 nt lds
  ds_read_b128 a[44:47], v13 offset:45056
  ds_read_b64_tr_b16 a[28:29], v14 offset:20480
  ds_read_b64_tr_b16 a[30:31], v14 offset:21504
  s_waitcnt lgkmcnt(9)
  v_mfma_f32_32x32x16_bf16 v[208:223], a[4:7], a[16:19], v[208:223]
  ds_read_b64_tr_b16 a[32:33], v15 offset:20480
  ds_read_b64_tr_b16 a[34:35], v15 offset:21504
  ds_read_b64_tr_b16 a[36:37], v16 offset:20480
  s_waitcnt lgkmcnt(10)
  v_mfma_f32_32x32x16_bf16 v[224:239], a[8:11], a[16:19], v[224:239]
  ds_read_b64_tr_b16 a[38:39], v16 offset:21504
  ds_read_b64_tr_b16 a[40:41], v17 offset:20480
  ds_read_b64_tr_b16 a[42:43], v17 offset:21504
  s_waitcnt lgkmcnt(11)
  v_mfma_f32_32x32x16_bf16 v[240:255], a[12:15], a[16:19], v[240:255]
  ds_read_b128 a[48:51], v13 offset:47104
  ds_read_b128 a[52:55], v13 offset:49152
  s_waitcnt lgkmcnt(12)
  v_mfma_f32_32x32x16_bf16 v[128:143], a[0:3], a[20:23], v[128:143]
  v_mfma_f32_32x32x16_bf16 v[144:159], a[4:7], a[20:23], v[144:159]
  v_mfma_f32_32x32x16_bf16 v[160:175], a[8:11], a[20:23], v[160:175]
  s_add_u32 m0, s62, 128
  v_mfma_f32_32x32x16_bf16 v[176:191], a[12:15], a[20:23], v[176:191]
  buffer_load_dwordx4 v18, s[28:31], s60 offen offset:2048 nt lds
  s_waitcnt lgkmcnt(8)
  v_mfma_f32_32x32x16_bf16 v[192:207], a[28:31], a[44:47], v[192:207]
  s_waitcnt lgkmcnt(6)
  v_mfma_f32_32x32x16_bf16 v[208:223], a[32:35], a[44:47], v[208:223]
  s_waitcnt lgkmcnt(4)
  v_mfma_f32_32x32x16_bf16 v[224:239], a[36:39], a[44:47], v[224:239]
  s_waitcnt lgkmcnt(2)
  v_mfma_f32_32x32x16_bf16 v[240:255], a[40:43], a[44:47], v[240:255]
  s_waitcnt lgkmcnt(0)
  s_barrier
  v_mfma_f32_32x32x16_bf16 v[128:143], a[28:31], a[48:51], v[128:143]
  s_add_u32 m0, s62, 192
  v_mfma_f32_32x32x16_bf16 v[144:159], a[32:35], a[48:51], v[144:159]
  buffer_load_dwordx4 v18, s[28:31], s60 offen offset:3072 nt lds
  v_mfma_f32_32x32x16_bf16 v[160:175], a[36:39], a[48:51], v[160:175]
  v_mul_f32 v192, s55, v192
  v_mul_f32 v193, s55, v193
  v_cvt_pk_bf16_f32 v32, v192, v193
  v_mul_f32 v194, s55, v194
  v_mul_f32 v195, s55, v195
  v_cvt_pk_bf16_f32 v33, v194, v195
  v_mfma_f32_32x32x16_bf16 v[176:191], a[40:43], a[48:51], v[176:191]
  v_mul_f32 v196, s55, v196
  v_mul_f32 v197, s55, v197
  v_cvt_pk_bf16_f32 v34, v196, v197
  v_mul_f32 v198, s55, v198
  v_mul_f32 v199, s55, v199
  v_cvt_pk_bf16_f32 v35, v198, v199
  v_mfma_f32_32x32x16_bf16 v[64:79], a[0:3], a[24:27], v[64:79]
  v_mul_f32 v200, s55, v200
  v_mul_f32 v201, s55, v201
  v_cvt_pk_bf16_f32 v36, v200, v201
  v_mul_f32 v202, s55, v202
  v_mul_f32 v203, s55, v203
  v_cvt_pk_bf16_f32 v37, v202, v203
  v_mfma_f32_32x32x16_bf16 v[80:95], a[4:7], a[24:27], v[80:95]
  v_mul_f32 v204, s55, v204
  v_mul_f32 v205, s55, v205
  v_cvt_pk_bf16_f32 v38, v204, v205
  v_mul_f32 v206, s55, v206
  v_mul_f32 v207, s55, v207
  v_cvt_pk_bf16_f32 v39, v206, v207
  v_mfma_f32_32x32x16_bf16 v[96:111], a[8:11], a[24:27], v[96:111]
  v_mul_f32 v208, s55, v208
  v_mul_f32 v209, s55, v209
  v_cvt_pk_bf16_f32 v40, v208, v209
  v_mul_f32 v210, s55, v210
  v_mul_f32 v211, s55, v211
  v_cvt_pk_bf16_f32 v41, v210, v211
  v_mfma_f32_32x32x16_bf16 v[112:127], a[12:15], a[24:27], v[112:127]
  v_mul_f32 v212, s55, v212
  v_mul_f32 v213, s55, v213
  v_cvt_pk_bf16_f32 v42, v212, v213
  v_mul_f32 v214, s55, v214
  v_mul_f32 v215, s55, v215
  v_cvt_pk_bf16_f32 v43, v214, v215
  v_mfma_f32_32x32x16_bf16 v[64:79], a[28:31], a[52:55], v[64:79]
  v_mul_f32 v216, s55, v216
  v_mul_f32 v217, s55, v217
  v_cvt_pk_bf16_f32 v44, v216, v217
  v_mul_f32 v218, s55, v218
  v_mul_f32 v219, s55, v219
  v_cvt_pk_bf16_f32 v45, v218, v219
  v_mfma_f32_32x32x16_bf16 v[80:95], a[32:35], a[52:55], v[80:95]
  v_mul_f32 v220, s55, v220
  v_mul_f32 v221, s55, v221
  v_cvt_pk_bf16_f32 v46, v220, v221
  v_mul_f32 v222, s55, v222
  v_mul_f32 v223, s55, v223
  v_cvt_pk_bf16_f32 v47, v222, v223
  v_mfma_f32_32x32x16_bf16 v[96:111], a[36:39], a[52:55], v[96:111]
  v_mul_f32 v224, s55, v224
  v_mul_f32 v225, s55, v225
  v_cvt_pk_bf16_f32 v48, v224, v225
  v_mul_f32 v226, s55, v226
  v_mul_f32 v227, s55, v227
  v_cvt_pk_bf16_f32 v49, v226, v227
  v_mfma_f32_32x32x16_bf16 v[112:127], a[40:43], a[52:55], v[112:127]
  v_mul_f32 v228, s55, v228
  v_mul_f32 v229, s55, v229
  v_cvt_pk_bf16_f32 v50, v228, v229
  v_mul_f32 v230, s55, v230
  v_mul_f32 v231, s55, v231
  v_cvt_pk_bf16_f32 v51, v230, v231
  v_mul_f32 v232, s55, v232
  v_mul_f32 v233, s55, v233
  v_cvt_pk_bf16_f32 v52, v232, v233
  v_mul_f32 v234, s55, v234
  v_mul_f32 v235, s55, v235
  v_cvt_pk_bf16_f32 v53, v234, v235
  v_mul_f32 v236, s55, v236
  v_mul_f32 v237, s55, v237
  v_cvt_pk_bf16_f32 v54, v236, v237
  v_mul_f32 v238, s55, v238
  v_mul_f32 v239, s55, v239
  v_cvt_pk_bf16_f32 v55, v238, v239
  v_mul_f32 v240, s55, v240
  v_mul_f32 v241, s55, v241
  v_cvt_pk_bf16_f32 v56, v240, v241
  v_mul_f32 v242, s55, v242
  v_mul_f32 v243, s55, v243
  v_cvt_pk_bf16_f32 v57, v242, v243
  v_mul_f32 v244, s55, v244
  v_mul_f32 v245, s55, v245
  v_cvt_pk_bf16_f32 v58, v244, v245
  v_mul_f32 v246, s55, v246
  v_mul_f32 v247, s55, v247
  v_cvt_pk_bf16_f32 v59, v246, v247
  v_mul_f32 v248, s55, v248
  v_mul_f32 v249, s55, v249
  v_cvt_pk_bf16_f32 v60, v248, v249
  v_mul_f32 v250, s55, v250
  v_mul_f32 v251, s55, v251
  v_cvt_pk_bf16_f32 v61, v250, v251
  v_mul_f32 v252, s55, v252
  v_mul_f32 v253, s55, v253
  v_cvt_pk_bf16_f32 v62, v252, v253
  v_mul_f32 v254, s55, v254
  v_mul_f32 v255, s55, v255
  v_cvt_pk_bf16_f32 v63, v254, v255
  v_mfma_f32_32x32x16_bf16 v[192:207], a[192:195], v[32:35], 0
  v_mul_f32 v128, s55, v128
  v_mul_f32 v129, s55, v129
  v_cvt_pk_bf16_f32 v128, v128, v129
  v_mul_f32 v130, s55, v130
  v_mul_f32 v131, s55, v131
  v_cvt_pk_bf16_f32 v129, v130, v131
  v_mfma_f32_32x32x16_bf16 v[192:207], a[196:199], v[36:39], v[192:207]
  v_mul_f32 v132, s55, v132
  v_mul_f32 v133, s55, v133
  v_cvt_pk_bf16_f32 v130, v132, v133
  v_mul_f32 v134, s55, v134
  v_mul_f32 v135, s55, v135
  v_cvt_pk_bf16_f32 v131, v134, v135
  v_mfma_f32_32x32x16_bf16 v[192:207], a[200:203], v[40:43], v[192:207]
  v_mul_f32 v136, s55, v136
  v_mul_f32 v137, s55, v137
  v_cvt_pk_bf16_f32 v132, v136, v137
  v_mul_f32 v138, s55, v138
  v_mul_f32 v139, s55, v139
  v_cvt_pk_bf16_f32 v133, v138, v139
  v_mfma_f32_32x32x16_bf16 v[192:207], a[204:207], v[44:47], v[192:207]
  v_mul_f32 v140, s55, v140
  v_mul_f32 v141, s55, v141
  v_cvt_pk_bf16_f32 v134, v140, v141
  v_mul_f32 v142, s55, v142
  v_mul_f32 v143, s55, v143
  v_cvt_pk_bf16_f32 v135, v142, v143
  v_mfma_f32_32x32x16_bf16 v[192:207], a[208:211], v[48:51], v[192:207]
  v_mul_f32 v144, s55, v144
  v_mul_f32 v145, s55, v145
  v_cvt_pk_bf16_f32 v136, v144, v145
  v_mul_f32 v146, s55, v146
  v_mul_f32 v147, s55, v147
  v_cvt_pk_bf16_f32 v137, v146, v147
  v_mfma_f32_32x32x16_bf16 v[192:207], a[212:215], v[52:55], v[192:207]
  v_mul_f32 v148, s55, v148
  v_mul_f32 v149, s55, v149
  v_cvt_pk_bf16_f32 v138, v148, v149
  v_mul_f32 v150, s55, v150
  v_mul_f32 v151, s55, v151
  v_cvt_pk_bf16_f32 v139, v150, v151
  v_mfma_f32_32x32x16_bf16 v[192:207], a[216:219], v[56:59], v[192:207]
  v_mul_f32 v152, s55, v152
  v_mul_f32 v153, s55, v153
  v_cvt_pk_bf16_f32 v140, v152, v153
  v_mul_f32 v154, s55, v154
  v_mul_f32 v155, s55, v155
  v_cvt_pk_bf16_f32 v141, v154, v155
  v_mfma_f32_32x32x16_bf16 v[192:207], a[220:223], v[60:63], v[192:207]
  v_mul_f32 v156, s55, v156
  v_mul_f32 v157, s55, v157
  v_cvt_pk_bf16_f32 v142, v156, v157
  v_mul_f32 v158, s55, v158
  v_mul_f32 v159, s55, v159
  v_cvt_pk_bf16_f32 v143, v158, v159
  v_mul_f32 v160, s55, v160
  v_mul_f32 v161, s55, v161
  v_cvt_pk_bf16_f32 v144, v160, v161
  v_mul_f32 v162, s55, v162
  v_mul_f32 v163, s55, v163
  v_cvt_pk_bf16_f32 v145, v162, v163
  v_mul_f32 v164, s55, v164
  v_mul_f32 v165, s55, v165
  v_cvt_pk_bf16_f32 v146, v164, v165
  v_mul_f32 v166, s55, v166
  v_mul_f32 v167, s55, v167
  v_cvt_pk_bf16_f32 v147, v166, v167
  v_mul_f32 v168, s55, v168
  v_mul_f32 v169, s55, v169
  v_cvt_pk_bf16_f32 v148, v168, v169
  v_mul_f32 v170, s55, v170
  v_mul_f32 v171, s55, v171
  v_cvt_pk_bf16_f32 v149, v170, v171
  v_mul_f32 v172, s55, v172
  v_mul_f32 v173, s55, v173
  v_cvt_pk_bf16_f32 v150, v172, v173
  v_mul_f32 v174, s55, v174
  v_mul_f32 v175, s55, v175
  v_cvt_pk_bf16_f32 v151, v174, v175
  v_mul_f32 v176, s55, v176
  v_mul_f32 v177, s55, v177
  v_cvt_pk_bf16_f32 v152, v176, v177
  v_mul_f32 v178, s55, v178
  v_mul_f32 v179, s55, v179
  v_cvt_pk_bf16_f32 v153, v178, v179
  v_mul_f32 v180, s55, v180
  v_mul_f32 v181, s55, v181
  v_cvt_pk_bf16_f32 v154, v180, v181
  v_mul_f32 v182, s55, v182
  v_mul_f32 v183, s55, v183
  v_cvt_pk_bf16_f32 v155, v182, v183
  v_mul_f32 v184, s55, v184
  v_mul_f32 v185, s55, v185
  v_cvt_pk_bf16_f32 v156, v184, v185
  v_mul_f32 v186, s55, v186
  v_mul_f32 v187, s55, v187
  v_cvt_pk_bf16_f32 v157, v186, v187
  v_mul_f32 v188, s55, v188
  v_mul_f32 v189, s55, v189
  v_cvt_pk_bf16_f32 v158, v188, v189
  v_mul_f32 v190, s55, v190
  v_mul_f32 v191, s55, v191
  v_cvt_pk_bf16_f32 v159, v190, v191
  v_mfma_f32_32x32x16_bf16 v[208:223], a[192:195], v[128:131], 0
  s_mov_b32 s60, 28672
  s_add_u32 m0, s62, 4352
  v_mfma_f32_32x32x16_bf16 v[208:223], a[196:199], v[132:135], v[208:223]
  buffer_load_dwordx4 v18, s[28:31], s60 offen offset:0 nt lds
  v_max3_f32 v30, v192, v193, v194
  v_max3_f32 v29, v195, v196, v197
  v_max3_f32 v30, v30, v198, v199
  s_add_u32 m0, s62, 4416
  v_mfma_f32_32x32x16_bf16 v[208:223], a[200:203], v[136:139], v[208:223]
  buffer_load_dwordx4 v18, s[28:31], s60 offen offset:1024 nt lds
  v_max3_f32 v29, v29, v200, v201
  v_max3_f32 v30, v30, v202, v203
  v_max3_f32 v29, v29, v204, v205
  s_add_u32 m0, s62, 4480
  v_mfma_f32_32x32x16_bf16 v[208:223], a[204:207], v[140:143], v[208:223]
  buffer_load_dwordx4 v18, s[28:31], s60 offen offset:2048 nt lds
  v_max3_f32 v30, v30, v206, v207
  v_max_f32 v30, v30, v29
  v_mov_b32 v29, v30
  s_nop 1
  v_permlane32_swap_b32 v30, v29
  v_mfma_f32_32x32x16_bf16 v[208:223], a[208:211], v[144:147], v[208:223]
  v_max_f32 v30, v30, v29
  v_sub_f32 v160, 0, v30
  v_sub_f32 v161, 0, v30
  v_sub_f32 v162, 0, v30
  v_sub_f32 v163, 0, v30
  v_sub_f32 v164, 0, v30
  v_mfma_f32_32x32x16_bf16 v[208:223], a[212:215], v[148:151], v[208:223]
  v_sub_f32 v165, 0, v30
  v_sub_f32 v166, 0, v30
  v_sub_f32 v167, 0, v30
  v_sub_f32 v168, 0, v30
  v_sub_f32 v169, 0, v30
  v_sub_f32 v170, 0, v30
  v_mfma_f32_32x32x16_bf16 v[208:223], a[216:219], v[152:155], v[208:223]
  v_sub_f32 v171, 0, v30
  v_sub_f32 v172, 0, v30
  v_sub_f32 v173, 0, v30
  v_sub_f32 v174, 0, v30
  v_sub_f32 v175, 0, v30
  v_sub_f32 v224, v192, v30
  v_mfma_f32_32x32x16_bf16 v[208:223], a[220:223], v[156:159], v[208:223]
  v_sub_f32 v225, v193, v30
  v_sub_f32 v226, v194, v30
  v_sub_f32 v227, v195, v30
  v_sub_f32 v228, v196, v30
  v_sub_f32 v229, v197, v30
  v_sub_f32 v230, v198, v30
  v_sub_f32 v231, v199, v30
  v_sub_f32 v232, v200, v30
  v_sub_f32 v233, v201, v30
  v_sub_f32 v234, v202, v30
  v_sub_f32 v235, v203, v30
  v_sub_f32 v236, v204, v30
  v_sub_f32 v237, v205, v30
  v_sub_f32 v238, v206, v30
  v_sub_f32 v239, v207, v30
  v_exp_f32 v224, v224
  v_exp_f32 v225, v225
  v_exp_f32 v226, v226
  v_exp_f32 v227, v227
  v_exp_f32 v228, v228
  v_exp_f32 v229, v229
  v_exp_f32 v230, v230
  v_exp_f32 v231, v231
  v_exp_f32 v232, v232
  v_exp_f32 v233, v233
  v_exp_f32 v234, v234
  v_exp_f32 v235, v235
  v_exp_f32 v236, v236
  v_exp_f32 v237, v237
  v_exp_f32 v238, v238
  v_exp_f32 v239, v239
  v_add_f32 v28, v224, v225
  v_add_f32 v29, v226, v227
  v_add_f32 v28, v28, v228
  v_add_f32 v29, v29, v229
  v_add_f32 v28, v28, v230
  v_add_f32 v29, v29, v231
  v_add_f32 v28, v28, v232
  v_add_f32 v29, v29, v233
  v_add_f32 v28, v28, v234
  v_add_f32 v29, v29, v235
  v_add_f32 v28, v28, v236
  v_add_f32 v29, v29, v237
  v_add_f32 v28, v28, v238
  v_add_f32 v29, v29, v239
  v_cvt_pk_bf16_f32 v240, v224, v225
  v_cvt_pk_bf16_f32 v241, v226, v227
  v_cvt_pk_bf16_f32 v242, v228, v229
  v_cvt_pk_bf16_f32 v243, v230, v231
  v_cvt_pk_bf16_f32 v244, v232, v233
  v_cvt_pk_bf16_f32 v245, v234, v235
  v_cvt_pk_bf16_f32 v246, v236, v237
  v_cvt_pk_bf16_f32 v247, v238, v239
  v_add_f32 v28, v28, v29
  v_mov_b32 v25, v28
  v_mul_f32 v64, s55, v64
  v_mul_f32 v65, s55, v65
  v_cvt_pk_bf16_f32 v64, v64, v65
  v_mul_f32 v66, s55, v66
  v_mul_f32 v67, s55, v67
  v_cvt_pk_bf16_f32 v65, v66, v67
  v_mul_f32 v68, s55, v68
  v_mul_f32 v69, s55, v69
  v_cvt_pk_bf16_f32 v66, v68, v69
  v_mul_f32 v70, s55, v70
  v_mul_f32 v71, s55, v71
  v_cvt_pk_bf16_f32 v67, v70, v71
  v_mul_f32 v72, s55, v72
  v_mul_f32 v73, s55, v73
  v_cvt_pk_bf16_f32 v68, v72, v73
  v_mul_f32 v74, s55, v74
  v_mul_f32 v75, s55, v75
  v_cvt_pk_bf16_f32 v69, v74, v75
  v_mul_f32 v76, s55, v76
  v_mul_f32 v77, s55, v77
  v_cvt_pk_bf16_f32 v70, v76, v77
  v_mul_f32 v78, s55, v78
  v_mul_f32 v79, s55, v79
  v_cvt_pk_bf16_f32 v71, v78, v79
  v_mul_f32 v80, s55, v80
  v_mul_f32 v81, s55, v81
  v_cvt_pk_bf16_f32 v72, v80, v81
  v_mul_f32 v82, s55, v82
  v_mul_f32 v83, s55, v83
  v_cvt_pk_bf16_f32 v73, v82, v83
  v_mul_f32 v84, s55, v84
  v_mul_f32 v85, s55, v85
  v_cvt_pk_bf16_f32 v74, v84, v85
  v_mul_f32 v86, s55, v86
  v_mul_f32 v87, s55, v87
  v_cvt_pk_bf16_f32 v75, v86, v87
  v_mul_f32 v88, s55, v88
  v_mul_f32 v89, s55, v89
  v_cvt_pk_bf16_f32 v76, v88, v89
  v_mul_f32 v90, s55, v90
  v_mul_f32 v91, s55, v91
  v_cvt_pk_bf16_f32 v77, v90, v91
  v_mul_f32 v92, s55, v92
  v_mul_f32 v93, s55, v93
  v_cvt_pk_bf16_f32 v78, v92, v93
  v_mul_f32 v94, s55, v94
  v_mul_f32 v95, s55, v95
  v_cvt_pk_bf16_f32 v79, v94, v95
  v_mul_f32 v96, s55, v96
  v_mul_f32 v97, s55, v97
  v_cvt_pk_bf16_f32 v80, v96, v97
  v_mul_f32 v98, s55, v98
  v_mul_f32 v99, s55, v99
  v_cvt_pk_bf16_f32 v81, v98, v99
  v_mul_f32 v100, s55, v100
  v_mul_f32 v101, s55, v101
  v_cvt_pk_bf16_f32 v82, v100, v101
  v_mul_f32 v102, s55, v102
  v_mul_f32 v103, s55, v103
  v_cvt_pk_bf16_f32 v83, v102, v103
  v_mul_f32 v104, s55, v104
  v_mul_f32 v105, s55, v105
  v_cvt_pk_bf16_f32 v84, v104, v105
  v_mul_f32 v106, s55, v106
  v_mul_f32 v107, s55, v107
  v_cvt_pk_bf16_f32 v85, v106, v107
  v_mul_f32 v108, s55, v108
  v_mul_f32 v109, s55, v109
  v_cvt_pk_bf16_f32 v86, v108, v109
  v_mul_f32 v110, s55, v110
  v_mul_f32 v111, s55, v111
  v_cvt_pk_bf16_f32 v87, v110, v111
  v_mul_f32 v112, s55, v112
  v_mul_f32 v113, s55, v113
  v_cvt_pk_bf16_f32 v88, v112, v113
  v_mul_f32 v114, s55, v114
  v_mul_f32 v115, s55, v115
  v_cvt_pk_bf16_f32 v89, v114, v115
  v_mul_f32 v116, s55, v116
  v_mul_f32 v117, s55, v117
  v_cvt_pk_bf16_f32 v90, v116, v117
  v_mul_f32 v118, s55, v118
  v_mul_f32 v119, s55, v119
  v_cvt_pk_bf16_f32 v91, v118, v119
  v_mul_f32 v120, s55, v120
  v_mul_f32 v121, s55, v121
  v_cvt_pk_bf16_f32 v92, v120, v121
  v_mul_f32 v122, s55, v122
  v_mul_f32 v123, s55, v123
  v_cvt_pk_bf16_f32 v93, v122, v123
  v_mul_f32 v124, s55, v124
  v_mul_f32 v125, s55, v125
  v_cvt_pk_bf16_f32 v94, v124, v125
  v_mul_f32 v126, s55, v126
  v_mul_f32 v127, s55, v127
  v_cvt_pk_bf16_f32 v95, v126, v127
  v_mfma_f32_32x32x16_bf16 a[0:15], a[224:227], v[240:243], 0
  s_add_u32 m0, s62, 4544
  v_mfma_f32_32x32x16_bf16 a[16:31], a[228:231], v[240:243], 0
  buffer_load_dwordx4 v18, s[28:31], s60 offen offset:3072 nt lds
  v_max3_f32 v30, v208, v209, v210
  v_max3_f32 v29, v211, v212, v213
  v_max3_f32 v30, v30, v214, v215
  v_max3_f32 v29, v29, v216, v217
  v_mfma_f32_32x32x16_bf16 a[32:47], a[232:235], v[240:243], 0
  v_max3_f32 v30, v30, v218, v219
  v_max3_f32 v29, v29, v220, v221
  v_max3_f32 v30, v30, v222, v223
  v_max_f32 v30, v30, v29
  v_mov_b32 v29, v30
  s_nop 1
  v_permlane32_swap_b32 v30, v29
  v_mfma_f32_32x32x16_bf16 a[48:63], a[236:239], v[240:243], 0
  v_max_f32 v30, v30, v29
  v_sub_f32 v176, 0, v30
  v_sub_f32 v177, 0, v30
  v_sub_f32 v178, 0, v30
  v_sub_f32 v179, 0, v30
  v_sub_f32 v180, 0, v30
  v_mfma_f32_32x32x16_bf16 a[0:15], a[240:243], v[244:247], a[0:15]
  v_sub_f32 v181, 0, v30
  v_sub_f32 v182, 0, v30
  v_sub_f32 v183, 0, v30
  v_sub_f32 v184, 0, v30
  v_sub_f32 v185, 0, v30
  v_sub_f32 v186, 0, v30
  v_mfma_f32_32x32x16_bf16 a[16:31], a[244:247], v[244:247], a[16:31]
  v_sub_f32 v187, 0, v30
  v_sub_f32 v188, 0, v30
  v_sub_f32 v189, 0, v30
  v_sub_f32 v190, 0, v30
  v_sub_f32 v191, 0, v30
  v_sub_f32 v224, v208, v30
  v_mfma_f32_32x32x16_bf16 a[32:47], a[248:251], v[244:247], a[32:47]
  v_sub_f32 v225, v209, v30
  v_sub_f32 v226, v210, v30
  v_sub_f32 v227, v211, v30
  v_sub_f32 v228, v212, v30
  v_sub_f32 v229, v213, v30
  v_sub_f32 v230, v214, v30
  v_mfma_f32_32x32x16_bf16 a[48:63], a[252:255], v[244:247], a[48:63]
  v_sub_f32 v231, v215, v30
  v_sub_f32 v232, v216, v30
  v_sub_f32 v233, v217, v30
  v_sub_f32 v234, v218, v30
  s_mov_b32 s60, 32768
  s_add_u32 m0, s62, 104448
  s_waitcnt vmcnt(22)
  s_barrier
  v_mfma_f32_32x32x16_bf16 v[192:207], a[192:195], v[64:67], 0
  buffer_load_dwordx4 v18, s[28:31], s60 offen offset:0 nt lds
  ds_read_b128 a[192:195], v19 offset:34816
  v_sub_f32 v235, v219, v30
  v_sub_f32 v236, v220, v30
  v_sub_f32 v237, v221, v30
  v_mfma_f32_32x32x16_bf16 v[192:207], a[196:199], v[68:71], v[192:207]
  ds_read_b128 a[196:199], v20 offset:34816
  v_sub_f32 v238, v222, v30
  v_sub_f32 v239, v223, v30
  v_exp_f32 v224, v224
  v_mfma_f32_32x32x16_bf16 v[192:207], a[200:203], v[72:75], v[192:207]
  ds_read_b128 a[200:203], v19 offset:34880
  v_exp_f32 v225, v225
  v_exp_f32 v226, v226
  v_mfma_f32_32x32x16_bf16 v[192:207], a[204:207], v[76:79], v[192:207]
  ds_read_b128 a[204:207], v20 offset:34880
  v_exp_f32 v227, v227
  v_exp_f32 v228, v228
  v_mfma_f32_32x32x16_bf16 v[192:207], a[208:211], v[80:83], v[192:207]
  ds_read_b128 a[208:211], v19 offset:34944
  v_exp_f32 v229, v229
  v_exp_f32 v230, v230
  v_mfma_f32_32x32x16_bf16 v[192:207], a[212:215], v[84:87], v[192:207]
  ds_read_b128 a[212:215], v20 offset:34944
  v_exp_f32 v231, v231
  v_exp_f32 v232, v232
  s_add_u32 m0, s62, 104512
  v_mfma_f32_32x32x16_bf16 v[192:207], a[216:219], v[88:91], v[192:207]
  buffer_load_dwordx4 v18, s[28:31], s60 offen offset:1024 nt lds
  ds_read_b128 a[216:219], v19 offset:35008
  v_exp_f32 v233, v233
  v_mfma_f32_32x32x16_bf16 v[192:207], a[220:223], v[92:95], v[192:207]
  ds_read_b128 a[220:223], v20 offset:35008
  v_exp_f32 v234, v234
  v_exp_f32 v235, v235
  v_exp_f32 v236, v236
  v_exp_f32 v237, v237
  v_exp_f32 v238, v238
  v_exp_f32 v239, v239
  v_add_f32 v28, v224, v225
  v_add_f32 v29, v226, v227
  v_add_f32 v28, v28, v228
  v_add_f32 v29, v29, v229
  v_add_f32 v28, v28, v230
  v_add_f32 v29, v29, v231
  v_add_f32 v28, v28, v232
  v_add_f32 v29, v29, v233
  v_add_f32 v28, v28, v234
  v_add_f32 v29, v29, v235
  v_add_f32 v28, v28, v236
  v_add_f32 v29, v29, v237
  v_add_f32 v28, v28, v238
  v_add_f32 v29, v29, v239
  v_cvt_pk_bf16_f32 v248, v224, v225
  v_cvt_pk_bf16_f32 v249, v226, v227
  v_cvt_pk_bf16_f32 v250, v228, v229
  v_cvt_pk_bf16_f32 v251, v230, v231
  v_cvt_pk_bf16_f32 v252, v232, v233
  v_cvt_pk_bf16_f32 v253, v234, v235
  v_cvt_pk_bf16_f32 v254, v236, v237
  v_cvt_pk_bf16_f32 v255, v238, v239
  v_add_f32 v28, v28, v29
  v_mov_b32 v26, v28
  v_mfma_f32_32x32x16_bf16 a[64:79], a[224:227], v[248:251], 0
  v_mfma_f32_32x32x16_bf16 a[80:95], a[228:231], v[248:251], 0
  v_max3_f32 v30, v192, v193, v194
  v_max3_f32 v29, v195, v196, v197
  v_max3_f32 v30, v30, v198, v199
  v_max3_f32 v29, v29, v200, v201
  v_max3_f32 v30, v30, v202, v203
  v_max3_f32 v29, v29, v204, v205
  v_mfma_f32_32x32x16_bf16 a[96:111], a[232:235], v[248:251], 0
  v_max3_f32 v30, v30, v206, v207
  v_max_f32 v30, v30, v29
  v_mov_b32 v29, v30
  s_nop 1
  v_permlane32_swap_b32 v30, v29
  v_max_f32 v30, v30, v29
  v_sub_f32 v96, 0, v30
  v_mfma_f32_32x32x16_bf16 a[112:127], a[236:239], v[248:251], 0
  v_sub_f32 v97, 0, v30
  v_sub_f32 v98, 0, v30
  v_sub_f32 v99, 0, v30
  v_sub_f32 v100, 0, v30
  v_sub_f32 v101, 0, v30
  v_sub_f32 v102, 0, v30
  v_mfma_f32_32x32x16_bf16 a[64:79], a[240:243], v[252:255], a[64:79]
  v_sub_f32 v103, 0, v30
  v_sub_f32 v104, 0, v30
  v_sub_f32 v105, 0, v30
  v_sub_f32 v106, 0, v30
  v_sub_f32 v107, 0, v30
  s_add_u32 m0, s62, 104576
  v_mfma_f32_32x32x16_bf16 a[80:95], a[244:247], v[252:255], a[80:95]
  buffer_load_dwordx4 v18, s[28:31], s60 offen offset:2048 nt lds
  v_sub_f32 v108, 0, v30
  v_sub_f32 v109, 0, v30
  v_sub_f32 v110, 0, v30
  v_sub_f32 v111, 0, v30
  v_mfma_f32_32x32x16_bf16 a[96:111], a[248:251], v[252:255], a[96:111]
  v_sub_f32 v224, v192, v30
  v_sub_f32 v225, v193, v30
  v_sub_f32 v226, v194, v30
  v_sub_f32 v227, v195, v30
  v_sub_f32 v228, v196, v30
  v_sub_f32 v229, v197, v30
  v_mfma_f32_32x32x16_bf16 a[112:127], a[252:255], v[252:255], a[112:127]
  v_sub_f32 v230, v198, v30
  v_sub_f32 v231, v199, v30
  v_sub_f32 v232, v200, v30
  v_sub_f32 v233, v201, v30
  v_sub_f32 v234, v202, v30
  v_sub_f32 v235, v203, v30
  s_waitcnt lgkmcnt(7)
  v_mfma_f32_32x32x16_bf16 v[208:223], a[192:195], v[32:35], v[160:175]
  v_sub_f32 v236, v204, v30
  v_sub_f32 v237, v205, v30
  v_sub_f32 v238, v206, v30
  v_sub_f32 v239, v207, v30
  v_exp_f32 v224, v224
  s_waitcnt lgkmcnt(6)
  v_mfma_f32_32x32x16_bf16 v[208:223], a[196:199], v[36:39], v[208:223]
  v_exp_f32 v225, v225
  v_exp_f32 v226, v226
  v_exp_f32 v227, v227
  s_waitcnt lgkmcnt(5)
  v_mfma_f32_32x32x16_bf16 v[208:223], a[200:203], v[40:43], v[208:223]
  v_exp_f32 v228, v228
  v_exp_f32 v229, v229
  v_exp_f32 v230, v230
  s_waitcnt lgkmcnt(4)
  v_mfma_f32_32x32x16_bf16 v[208:223], a[204:207], v[44:47], v[208:223]
  v_exp_f32 v231, v231
  v_exp_f32 v232, v232
  s_add_u32 m0, s62, 104640
  s_waitcnt lgkmcnt(3)
  v_mfma_f32_32x32x16_bf16 v[208:223], a[208:211], v[48:51], v[208:223]
  buffer_load_dwordx4 v18, s[28:31], s60 offen offset:3072 nt lds
  v_exp_f32 v233, v233
  v_exp_f32 v234, v234
  s_waitcnt lgkmcnt(2)
  v_mfma_f32_32x32x16_bf16 v[208:223], a[212:215], v[52:55], v[208:223]
  v_exp_f32 v235, v235
  v_exp_f32 v236, v236
  v_exp_f32 v237, v237
  s_waitcnt lgkmcnt(1)
  v_mfma_f32_32x32x16_bf16 v[208:223], a[216:219], v[56:59], v[208:223]
  v_exp_f32 v238, v238
  v_exp_f32 v239, v239
  v_add_f32 v28, v224, v225
  v_add_f32 v29, v226, v227
  s_waitcnt lgkmcnt(0)
  v_mfma_f32_32x32x16_bf16 v[208:223], a[220:223], v[60:63], v[208:223]
  v_add_f32 v28, v28, v228
  v_add_f32 v29, v29, v229
  v_add_f32 v28, v28, v230
  v_add_f32 v29, v29, v231
  v_add_f32 v28, v28, v232
  v_add_f32 v29, v29, v233
  v_add_f32 v28, v28, v234
  v_add_f32 v29, v29, v235
  v_add_f32 v28, v28, v236
  v_add_f32 v29, v29, v237
  v_add_f32 v28, v28, v238
  v_add_f32 v29, v29, v239
  v_cvt_pk_bf16_f32 v240, v224, v225
  v_cvt_pk_bf16_f32 v241, v226, v227
  v_cvt_pk_bf16_f32 v242, v228, v229
  v_cvt_pk_bf16_f32 v243, v230, v231
  v_cvt_pk_bf16_f32 v244, v232, v233
  v_cvt_pk_bf16_f32 v245, v234, v235
  v_cvt_pk_bf16_f32 v246, v236, v237
  v_cvt_pk_bf16_f32 v247, v238, v239
  v_add_f32 v28, v28, v29
  v_mov_b32 v27, v28
  v_mfma_f32_32x32x16_bf16 a[128:143], a[224:227], v[240:243], 0
  ds_read_b64_tr_b16 a[224:225], v23 offset:34816
  ds_read_b64_tr_b16 a[226:227], v23 offset:35072
  v_mfma_f32_32x32x16_bf16 a[144:159], a[228:231], v[240:243], 0
  ds_read_b64_tr_b16 a[228:229], v23 offset:34880
  ds_read_b64_tr_b16 a[230:231], v23 offset:35136
  v_exp_f32 v224, v208
  v_exp_f32 v225, v209
  v_mfma_f32_32x32x16_bf16 a[160:175], a[232:235], v[240:243], 0
  ds_read_b64_tr_b16 a[232:233], v23 offset:34944
  ds_read_b64_tr_b16 a[234:235], v23 offset:35200
  v_exp_f32 v226, v210
  s_mov_b32 s60, 36864
  s_add_u32 m0, s62, 108800
  v_mfma_f32_32x32x16_bf16 a[176:191], a[236:239], v[240:243], 0
  buffer_load_dwordx4 v18, s[28:31], s60 offen offset:0 nt lds
  ds_read_b64_tr_b16 a[236:237], v23 offset:35008
  ds_read_b64_tr_b16 a[238:239], v23 offset:35264
  v_add_f32 v28, v224, v225
  v_cvt_pk_bf16_f32 v248, v224, v225
  v_mfma_f32_32x32x16_bf16 a[128:143], a[240:243], v[244:247], a[128:143]
  ds_read_b64_tr_b16 a[240:241], v23 offset:39168
  ds_read_b64_tr_b16 a[242:243], v23 offset:39424
  v_exp_f32 v227, v211
  v_exp_f32 v228, v212
  v_mfma_f32_32x32x16_bf16 a[144:159], a[244:247], v[244:247], a[144:159]
  ds_read_b64_tr_b16 a[244:245], v23 offset:39232
  ds_read_b64_tr_b16 a[246:247], v23 offset:39488
  v_add_f32 v29, v226, v227
  v_cvt_pk_bf16_f32 v249, v226, v227
  v_exp_f32 v229, v213
  v_mfma_f32_32x32x16_bf16 a[160:175], a[248:251], v[244:247], a[160:175]
  ds_read_b64_tr_b16 a[248:249], v23 offset:39296
  ds_read_b64_tr_b16 a[250:251], v23 offset:39552
  v_exp_f32 v230, v214
  v_add_f32 v28, v28, v228
  v_add_f32 v29, v29, v229
  v_mfma_f32_32x32x16_bf16 a[176:191], a[252:255], v[244:247], a[176:191]
  ds_read_b64_tr_b16 a[252:253], v23 offset:39360
  ds_read_b64_tr_b16 a[254:255], v23 offset:39616
  v_cvt_pk_bf16_f32 v250, v228, v229
  v_exp_f32 v231, v215
  v_mfma_f32_32x32x16_bf16 v[192:207], a[192:195], v[128:131], v[176:191]
  v_exp_f32 v232, v216
  v_add_f32 v28, v28, v230
  v_add_f32 v29, v29, v231
  v_cvt_pk_bf16_f32 v251, v230, v231
  v_mfma_f32_32x32x16_bf16 v[192:207], a[196:199], v[132:135], v[192:207]
  v_exp_f32 v233, v217
  v_exp_f32 v234, v218
  v_add_f32 v28, v28, v232
  s_add_u32 m0, s62, 108864
  v_mfma_f32_32x32x16_bf16 v[192:207], a[200:203], v[136:139], v[192:207]
  buffer_load_dwordx4 v18, s[28:31], s60 offen offset:1024 nt lds
  v_add_f32 v29, v29, v233
  v_cvt_pk_bf16_f32 v252, v232, v233
  v_exp_f32 v235, v219
  v_mfma_f32_32x32x16_bf16 v[192:207], a[204:207], v[140:143], v[192:207]
  v_exp_f32 v236, v220
  v_add_f32 v28, v28, v234
  v_add_f32 v29, v29, v235
  v_cvt_pk_bf16_f32 v253, v234, v235
  v_mfma_f32_32x32x16_bf16 v[192:207], a[208:211], v[144:147], v[192:207]
  v_exp_f32 v237, v221
  v_exp_f32 v238, v222
  v_add_f32 v28, v28, v236
  v_add_f32 v29, v29, v237
  v_mfma_f32_32x32x16_bf16 v[192:207], a[212:215], v[148:151], v[192:207]
  v_cvt_pk_bf16_f32 v254, v236, v237
  v_exp_f32 v239, v223
  v_add_f32 v28, v28, v238
  v_add_f32 v29, v29, v239
  v_cvt_pk_bf16_f32 v255, v238, v239
  v_mfma_f32_32x32x16_bf16 v[192:207], a[216:219], v[152:155], v[192:207]
  v_add_f32 v28, v28, v29
  v_cmp_nle_f32 vcc, v28, v31
  s_cbranch_vccnz L_tr3
L_bk3:
  v_add_f32 v25, v25, v28
  v_mfma_f32_32x32x16_bf16 v[192:207], a[220:223], v[156:159], v[192:207]
  s_waitcnt lgkmcnt(14)
  v_mfma_f32_32x32x16_bf16 a[0:15], a[224:227], v[248:251], a[0:15]
  s_add_u32 m0, s62, 108928
  s_waitcnt lgkmcnt(12)
  v_mfma_f32_32x32x16_bf16 a[16:31], a[228:231], v[248:251], a[16:31]
  buffer_load_dwordx4 v18, s[28:31], s60 offen offset:2048 nt lds
  v_exp_f32 v224, v192
  v_exp_f32 v225, v193
  s_waitcnt lgkmcnt(10)
  v_mfma_f32_32x32x16_bf16 a[32:47], a[232:235], v[248:251], a[32:47]
  v_exp_f32 v226, v194
  v_add_f32 v28, v224, v225
  v_cvt_pk_bf16_f32 v240, v224, v225
  v_exp_f32 v227, v195
  s_waitcnt lgkmcnt(8)
  v_mfma_f32_32x32x16_bf16 a[48:63], a[236:239], v[248:251], a[48:63]
  v_exp_f32 v228, v196
  v_add_f32 v29, v226, v227
  v_cvt_pk_bf16_f32 v241, v226, v227
  v_exp_f32 v229, v197
  s_waitcnt lgkmcnt(6)
  v_mfma_f32_32x32x16_bf16 a[0:15], a[240:243], v[252:255], a[0:15]
  v_exp_f32 v230, v198
  v_add_f32 v28, v28, v228
  v_add_f32 v29, v29, v229
  v_cvt_pk_bf16_f32 v242, v228, v229
  s_waitcnt lgkmcnt(4)
  v_mfma_f32_32x32x16_bf16 a[16:31], a[244:247], v[252:255], a[16:31]
  v_exp_f32 v231, v199
  v_exp_f32 v232, v200
  v_add_f32 v28, v28, v230
  v_add_f32 v29, v29, v231
  s_waitcnt lgkmcnt(2)
  v_mfma_f32_32x32x16_bf16 a[32:47], a[248:251], v[252:255], a[32:47]
  v_cvt_pk_bf16_f32 v243, v230, v231
  v_exp_f32 v233, v201
  v_exp_f32 v234, v202
  v_add_f32 v28, v28, v232
  s_waitcnt lgkmcnt(0)
  v_mfma_f32_32x32x16_bf16 a[48:63], a[252:255], v[252:255], a[48:63]
  v_add_f32 v29, v29, v233
  v_cvt_pk_bf16_f32 v244, v232, v233
  v_exp_f32 v235, v203
  s_add_u32 m0, s62, 108992
  s_waitcnt vmcnt(17)
  s_barrier
  v_mfma_f32_32x32x16_bf16 v[208:223], a[192:195], v[64:67], v[96:111]
  buffer_load_dwordx4 v18, s[28:31], s60 offen offset:3072 nt lds
  ds_read_b128 a[192:195], v21 offset:0
  v_exp_f32 v236, v204
  v_add_f32 v28, v28, v234
  v_mfma_f32_32x32x16_bf16 v[208:223], a[196:199], v[68:71], v[208:223]
  ds_read_b128 a[196:199], v22 offset:0
  v_add_f32 v29, v29, v235
  v_cvt_pk_bf16_f32 v245, v234, v235
  v_exp_f32 v237, v205
  v_lshlrev_b32 v2, 4, v1
  v_mfma_f32_32x32x16_bf16 v[208:223], a[200:203], v[72:75], v[208:223]
  ds_read_b128 a[200:203], v21 offset:64
  v_exp_f32 v238, v206
  v_add_f32 v28, v28, v236
  v_add_f32 v29, v29, v237
  v_cvt_pk_bf16_f32 v246, v236, v237
  v_mfma_f32_32x32x16_bf16 v[208:223], a[204:207], v[76:79], v[208:223]
  ds_read_b128 a[204:207], v22 offset:64
  v_exp_f32 v239, v207
  v_add_f32 v28, v28, v238
  v_add_f32 v29, v29, v239
  v_cvt_pk_bf16_f32 v247, v238, v239
  v_mfma_f32_32x32x16_bf16 v[208:223], a[208:211], v[80:83], v[208:223]
  ds_read_b128 a[208:211], v21 offset:128
  v_add_f32 v28, v28, v29
  v_cmp_nle_f32 vcc, v28, v31
  s_cbranch_vccnz L_tr4
L_bk4:
  v_add_f32 v26, v26, v28
  v_lshrrev_b32 v8, 2, v1
  v_mfma_f32_32x32x16_bf16 v[208:223], a[212:215], v[84:87], v[208:223]
  ds_read_b128 a[212:215], v22 offset:128
  v_lshlrev_b32 v8, 10, v8
  v_and_b32 v9, 3, v1
  v_lshl_add_u32 v3, v9, 4, v8
  v_lshrrev_b32 v8, 5, v1
  v_bfe_u32 v9, v1, 2, 2
  v_mfma_f32_32x32x16_bf16 v[208:223], a[216:219], v[88:91], v[208:223]
  ds_read_b128 a[216:219], v21 offset:192
  v_lshl_add_u32 v8, v8, 2, v9
  v_lshlrev_b32 v8, 6, v8
  v_bfe_u32 v9, v1, 4, 1
  s_mov_b32 s60, 40960
  s_add_u32 m0, s62, 34816
  v_mfma_f32_32x32x16_bf16 v[208:223], a[220:223], v[92:95], v[208:223]
  buffer_load_dwordx4 v18, s[28:31], s60 offen offset:0 nt lds
  ds_read_b128 a[220:223], v22 offset:192
  v_lshl_add_u32 v8, v9, 5, v8
  v_and_b32 v9, 1, v1
  v_lshl_add_u32 v8, v9, 4, v8
  v_mfma_f32_32x32x16_bf16 a[64:79], a[224:227], v[240:243], a[64:79]
  v_bfe_u32 v9, v1, 1, 1
  v_lshl_add_u32 v8, v9, 3, v8
  s_lshr_b32 s64, s3, 1
  s_mul_i32 s64, s64, 0x420
  v_xor_b32 v4, s64, v8
  v_add_u32 v5, 0x10000, v4
  v_mfma_f32_32x32x16_bf16 a[80:95], a[228:231], v[240:243], a[80:95]
  v_exp_f32 v224, v208
  v_exp_f32 v225, v209
  v_exp_f32 v226, v210
  v_mfma_f32_32x32x16_bf16 a[96:111], a[232:235], v[240:243], a[96:111]
  v_add_f32 v28, v224, v225
  v_cvt_pk_bf16_f32 v248, v224, v225
  v_exp_f32 v227, v211
  v_exp_f32 v228, v212
  v_mfma_f32_32x32x16_bf16 a[112:127], a[236:239], v[240:243], a[112:127]
  v_add_f32 v29, v226, v227
  v_cvt_pk_bf16_f32 v249, v226, v227
  v_exp_f32 v229, v213
  v_exp_f32 v230, v214
  v_mfma_f32_32x32x16_bf16 a[64:79], a[240:243], v[244:247], a[64:79]
  v_add_f32 v28, v28, v228
  v_add_f32 v29, v29, v229
  v_cvt_pk_bf16_f32 v250, v228, v229
  v_exp_f32 v231, v215
  v_add_u32 v6, 0x20000, v4
  v_mfma_f32_32x32x16_bf16 a[80:95], a[244:247], v[244:247], a[80:95]
  v_exp_f32 v232, v216
  v_add_f32 v28, v28, v230
  v_add_f32 v29, v29, v231
  v_cvt_pk_bf16_f32 v251, v230, v231
  s_add_u32 m0, s62, 34880
  v_mfma_f32_32x32x16_bf16 a[96:111], a[248:251], v[244:247], a[96:111]
  buffer_load_dwordx4 v18, s[28:31], s60 offen offset:1024 nt lds
  v_exp_f32 v233, v217
  v_exp_f32 v234, v218
  v_mfma_f32_32x32x16_bf16 a[112:127], a[252:255], v[244:247], a[112:127]
  v_add_f32 v28, v28, v232
  v_add_f32 v29, v29, v233
  v_cvt_pk_bf16_f32 v252, v232, v233
  v_exp_f32 v235, v219
  s_mul_i32 s64, s3, 6144
  s_waitcnt lgkmcnt(7)
  v_mfma_f32_32x32x16_bf16 v[192:207], a[192:195], v[32:35], v[160:175]
  v_exp_f32 v236, v220
  v_add_f32 v28, v28, v234
  v_add_f32 v29, v29, v235
  v_cvt_pk_bf16_f32 v253, v234, v235
  v_add_u32 v16, s64, v2
  s_waitcnt lgkmcnt(6)
  v_mfma_f32_32x32x16_bf16 v[192:207], a[196:199], v[36:39], v[192:207]
  v_exp_f32 v237, v221
  v_exp_f32 v238, v222
  v_add_f32 v28, v28, v236
  v_add_f32 v29, v29, v237
  s_waitcnt lgkmcnt(5)
  v_mfma_f32_32x32x16_bf16 v[192:207], a[200:203], v[40:43], v[192:207]
  v_cvt_pk_bf16_f32 v254, v236, v237
  v_exp_f32 v239, v223
  v_add_f32 v28, v28, v238
  v_add_f32 v29, v29, v239
  v_cvt_pk_bf16_f32 v255, v238, v239
  s_waitcnt lgkmcnt(4)
  v_mfma_f32_32x32x16_bf16 v[192:207], a[204:207], v[44:47], v[192:207]
  v_add_f32 v28, v28, v29
  v_cmp_nle_f32 vcc, v28, v31
  s_cbranch_vccnz L_tr5
L_bk5:
  v_add_f32 v27, v27, v28
  s_xor_b32 s64, s3, 2
  s_mul_i32 s64, s64, 6144
  s_waitcnt lgkmcnt(3)
  v_mfma_f32_32x32x16_bf16 v[192:207], a[208:211], v[48:51], v[192:207]
  v_add_u32 v17, s64, v2
  v_lshlrev_b32 v12, 4, v0
  v_mov_b32 v7, s72
  s_and_b32 s64, s3, 1
  s_lshl_b32 s65, s52, 1
  s_add_u32 m0, s62, 34944
  s_waitcnt lgkmcnt(2)
  v_mfma_f32_32x32x16_bf16 v[192:207], a[212:215], v[52:55], v[192:207]
  buffer_load_dwordx4 v18, s[28:31], s60 offen offset:2048 nt lds
  s_add_u32 s64, s64, s65
  s_mul_i32 s64, s64, 98304
  s_lshl_b32 s65, s54, 8
  s_add_u32 s64, s64, s65
  s_waitcnt lgkmcnt(1)
  v_mfma_f32_32x32x16_bf16 v[192:207], a[216:219], v[56:59], v[192:207]
  s_lshl_b32 s65, s53, 6
  s_add_u32 s64, s64, s65
  s_lshr_b32 s65, s3, 1
  s_lshl_b32 s65, s65, 5
  s_add_u32 s64, s64, s65
  s_waitcnt lgkmcnt(0)
  v_mfma_f32_32x32x16_bf16 v[192:207], a[220:223], v[60:63], v[192:207]
  s_add_u32 s20, s14, s64
  s_addc_u32 s21, s15, 0
  s_mov_b32 s22, 0x17c20
  s_mov_b32 s23, 0x20000
  v_mfma_f32_32x32x16_bf16 a[128:143], a[224:227], v[248:251], a[128:143]
  ds_read_b64_tr_b16 a[224:225], v24 offset:0
  ds_read_b64_tr_b16 a[226:227], v24 offset:256
  v_mfma_f32_32x32x16_bf16 a[144:159], a[228:231], v[248:251], a[144:159]
  ds_read_b64_tr_b16 a[228:229], v24 offset:64
  ds_read_b64_tr_b16 a[230:231], v24 offset:320
  v_exp_f32 v224, v192
  v_exp_f32 v225, v193
  v_mfma_f32_32x32x16_bf16 a[160:175], a[232:235], v[248:251], a[160:175]
  ds_read_b64_tr_b16 a[232:233], v24 offset:128
  ds_read_b64_tr_b16 a[234:235], v24 offset:384
  v_exp_f32 v226, v194
  v_add_f32 v28, v224, v225
  s_add_u32 m0, s62, 35008
  v_mfma_f32_32x32x16_bf16 a[176:191], a[236:239], v[248:251], a[176:191]
  buffer_load_dwordx4 v18, s[28:31], s60 offen offset:3072 nt lds
  ds_read_b64_tr_b16 a[236:237], v24 offset:192
  ds_read_b64_tr_b16 a[238:239], v24 offset:448
  v_cvt_pk_bf16_f32 v240, v224, v225
  v_mfma_f32_32x32x16_bf16 a[128:143], a[240:243], v[252:255], a[128:143]
  ds_read_b64_tr_b16 a[240:241], v24 offset:4352
  ds_read_b64_tr_b16 a[242:243], v24 offset:4608
  v_exp_f32 v227, v195
  v_exp_f32 v228, v196
  v_mfma_f32_32x32x16_bf16 a[144:159], a[244:247], v[252:255], a[144:159]
  ds_read_b64_tr_b16 a[244:245], v24 offset:4416
  ds_read_b64_tr_b16 a[246:247], v24 offset:4672
  v_add_f32 v29, v226, v227
  v_cvt_pk_bf16_f32 v241, v226, v227
  v_exp_f32 v229, v197
  v_mfma_f32_32x32x16_bf16 a[160:175], a[248:251], v[252:255], a[160:175]
  ds_read_b64_tr_b16 a[248:249], v24 offset:4480
  ds_read_b64_tr_b16 a[250:251], v24 offset:4736
  v_exp_f32 v230, v198
  v_add_f32 v28, v28, v228
  v_add_f32 v29, v29, v229
  v_mfma_f32_32x32x16_bf16 a[176:191], a[252:255], v[252:255], a[176:191]
  ds_read_b64_tr_b16 a[252:253], v24 offset:4544
  ds_read_b64_tr_b16 a[254:255], v24 offset:4800
  v_cvt_pk_bf16_f32 v242, v228, v229
  v_exp_f32 v231, v199
  v_mfma_f32_32x32x16_bf16 v[208:223], a[192:195], v[128:131], v[176:191]
  v_exp_f32 v232, v200
  v_add_f32 v28, v28, v230
  v_add_f32 v29, v29, v231
  v_cvt_pk_bf16_f32 v243, v230, v231
  v_mfma_f32_32x32x16_bf16 v[208:223], a[196:199], v[132:135], v[208:223]
  v_exp_f32 v233, v201
  v_exp_f32 v234, v202
  s_mov_b32 s60, 45056
  s_add_u32 m0, s62, 39168
  v_mfma_f32_32x32x16_bf16 v[208:223], a[200:203], v[136:139], v[208:223]
  buffer_load_dwordx4 v18, s[28:31], s60 offen offset:0 nt lds
  v_add_f32 v28, v28, v232
  v_add_f32 v29, v29, v233
  v_cvt_pk_bf16_f32 v244, v232, v233
  v_mfma_f32_32x32x16_bf16 v[208:223], a[204:207], v[140:143], v[208:223]
  v_exp_f32 v235, v203
  v_exp_f32 v236, v204
  v_add_f32 v28, v28, v234
  v_add_f32 v29, v29, v235
  v_mfma_f32_32x32x16_bf16 v[208:223], a[208:211], v[144:147], v[208:223]
  v_cvt_pk_bf16_f32 v245, v234, v235
  v_exp_f32 v237, v205
  v_exp_f32 v238, v206
  v_add_f32 v28, v28, v236
  v_mfma_f32_32x32x16_bf16 v[208:223], a[212:215], v[148:151], v[208:223]
  v_add_f32 v29, v29, v237
  v_cvt_pk_bf16_f32 v246, v236, v237
  v_exp_f32 v239, v207
  v_add_f32 v28, v28, v238
  v_add_f32 v29, v29, v239
  v_mfma_f32_32x32x16_bf16 v[208:223], a[216:219], v[152:155], v[208:223]
  v_cvt_pk_bf16_f32 v247, v238, v239
  v_add_f32 v28, v28, v29
  v_cmp_nle_f32 vcc, v28, v31
  s_cbranch_vccnz L_tr6
L_bk6:
  v_add_f32 v25, v25, v28
  v_mfma_f32_32x32x16_bf16 v[208:223], a[220:223], v[156:159], v[208:223]
  s_waitcnt lgkmcnt(14)
  v_mfma_f32_32x32x16_bf16 a[0:15], a[224:227], v[240:243], a[0:15]
  s_add_u32 m0, s62, 39232
  s_waitcnt lgkmcnt(12)
  v_mfma_f32_32x32x16_bf16 a[16:31], a[228:231], v[240:243], a[16:31]
  buffer_load_dwordx4 v18, s[28:31], s60 offen offset:1024 nt lds
  v_exp_f32 v224, v208
  v_exp_f32 v225, v209
  s_waitcnt lgkmcnt(10)
  v_mfma_f32_32x32x16_bf16 a[32:47], a[232:235], v[240:243], a[32:47]
  v_exp_f32 v226, v210
  v_add_f32 v28, v224, v225
  v_cvt_pk_bf16_f32 v248, v224, v225
  v_exp_f32 v227, v211
  s_waitcnt lgkmcnt(8)
  v_mfma_f32_32x32x16_bf16 a[48:63], a[236:239], v[240:243], a[48:63]
  v_exp_f32 v228, v212
  v_add_f32 v29, v226, v227
  v_cvt_pk_bf16_f32 v249, v226, v227
  v_exp_f32 v229, v213
  s_waitcnt lgkmcnt(6)
  v_mfma_f32_32x32x16_bf16 a[0:15], a[240:243], v[244:247], a[0:15]
  v_exp_f32 v230, v214
  v_add_f32 v28, v28, v228
  v_add_f32 v29, v29, v229
  v_cvt_pk_bf16_f32 v250, v228, v229
  s_waitcnt lgkmcnt(4)
  v_mfma_f32_32x32x16_bf16 a[16:31], a[244:247], v[244:247], a[16:31]
  v_exp_f32 v231, v215
  v_exp_f32 v232, v216
  v_add_f32 v28, v28, v230
  v_add_f32 v29, v29, v231
  s_waitcnt lgkmcnt(2)
  v_mfma_f32_32x32x16_bf16 a[32:47], a[248:251], v[244:247], a[32:47]
  v_cvt_pk_bf16_f32 v251, v230, v231
  v_exp_f32 v233, v217
  v_exp_f32 v234, v218
  v_add_f32 v28, v28, v232
  s_waitcnt lgkmcnt(0)
  v_mfma_f32_32x32x16_bf16 a[48:63], a[252:255], v[244:247], a[48:63]
  v_add_f32 v29, v29, v233
  v_cvt_pk_bf16_f32 v252, v232, v233
  v_exp_f32 v235, v219
  s_add_u32 m0, s62, 39296
  s_waitcnt vmcnt(14)
  s_barrier
  v_mfma_f32_32x32x16_bf16 v[192:207], a[192:195], v[64:67], v[96:111]
  buffer_load_dwordx4 v18, s[28:31], s60 offen offset:2048 nt lds
  ds_read_b128 a[192:195], v19 offset:0
  v_exp_f32 v236, v220
  v_add_f32 v28, v28, v234
  v_mfma_f32_32x32x16_bf16 v[192:207], a[196:199], v[68:71], v[192:207]
  ds_read_b128 a[196:199], v20 offset:0
  v_add_f32 v29, v29, v235
  v_cvt_pk_bf16_f32 v253, v234, v235
  v_exp_f32 v237, v221
  v_mfma_f32_32x32x16_bf16 v[192:207], a[200:203], v[72:75], v[192:207]
  ds_read_b128 a[200:203], v19 offset:64
  v_exp_f32 v238, v222
  v_add_f32 v28, v28, v236
  v_add_f32 v29, v29, v237
  v_cvt_pk_bf16_f32 v254, v236, v237
  v_mfma_f32_32x32x16_bf16 v[192:207], a[204:207], v[76:79], v[192:207]
  ds_read_b128 a[204:207], v20 offset:64
  v_exp_f32 v239, v223
  v_add_f32 v28, v28, v238
  v_add_f32 v29, v29, v239
  v_cvt_pk_bf16_f32 v255, v238, v239
  v_mfma_f32_32x32x16_bf16 v[192:207], a[208:211], v[80:83], v[192:207]
  ds_read_b128 a[208:211], v19 offset:128
  v_add_f32 v28, v28, v29
  v_cmp_nle_f32 vcc, v28, v31
  s_cbranch_vccnz L_tr7
L_bk7:
  v_add_f32 v26, v26, v28
  v_mfma_f32_32x32x16_bf16 v[192:207], a[212:215], v[84:87], v[192:207]
  ds_read_b128 a[212:215], v20 offset:128
  v_mfma_f32_32x32x16_bf16 v[192:207], a[216:219], v[88:91], v[192:207]
  ds_read_b128 a[216:219], v19 offset:192
  s_add_u32 m0, s62, 39360
  v_mfma_f32_32x32x16_bf16 v[192:207], a[220:223], v[92:95], v[192:207]
  buffer_load_dwordx4 v18, s[28:31], s60 offen offset:3072 nt lds
  ds_read_b128 a[220:223], v20 offset:192
  v_mfma_f32_32x32x16_bf16 a[64:79], a[224:227], v[248:251], a[64:79]
  v_mfma_f32_32x32x16_bf16 a[80:95], a[228:231], v[248:251], a[80:95]
  v_exp_f32 v224, v192
  v_exp_f32 v225, v193
  v_exp_f32 v226, v194
  v_mfma_f32_32x32x16_bf16 a[96:111], a[232:235], v[248:251], a[96:111]
  v_add_f32 v28, v224, v225
  v_cvt_pk_bf16_f32 v240, v224, v225
  v_exp_f32 v227, v195
  v_exp_f32 v228, v196
  v_mfma_f32_32x32x16_bf16 a[112:127], a[236:239], v[248:251], a[112:127]
  v_add_f32 v29, v226, v227
  v_cvt_pk_bf16_f32 v241, v226, v227
  v_exp_f32 v229, v197
  v_exp_f32 v230, v198
  v_mfma_f32_32x32x16_bf16 a[64:79], a[240:243], v[252:255], a[64:79]
  v_add_f32 v28, v28, v228
  v_add_f32 v29, v29, v229
  v_cvt_pk_bf16_f32 v242, v228, v229
  v_exp_f32 v231, v199
  v_mfma_f32_32x32x16_bf16 a[80:95], a[244:247], v[252:255], a[80:95]
  v_exp_f32 v232, v200
  v_add_f32 v28, v28, v230
  v_add_f32 v29, v29, v231
  s_mov_b32 s60, 49152
  s_add_u32 m0, s62, 69632
  v_mfma_f32_32x32x16_bf16 a[96:111], a[248:251], v[252:255], a[96:111]
  buffer_load_dwordx4 v18, s[28:31], s60 offen offset:0 nt lds
  v_cvt_pk_bf16_f32 v243, v230, v231
  v_exp_f32 v233, v201
  v_mfma_f32_32x32x16_bf16 a[112:127], a[252:255], v[252:255], a[112:127]
  v_exp_f32 v234, v202
  v_add_f32 v28, v28, v232
  v_add_f32 v29, v29, v233
  v_cvt_pk_bf16_f32 v244, v232, v233
  s_waitcnt lgkmcnt(7)
  v_mfma_f32_32x32x16_bf16 v[208:223], a[192:195], v[32:35], v[160:175]
  v_exp_f32 v235, v203
  v_exp_f32 v236, v204
  v_add_f32 v28, v28, v234
  v_add_f32 v29, v29, v235
  s_waitcnt lgkmcnt(6)
  v_mfma_f32_32x32x16_bf16 v[208:223], a[196:199], v[36:39], v[208:223]
  v_cvt_pk_bf16_f32 v245, v234, v235
  v_exp_f32 v237, v205
  v_exp_f32 v238, v206
  v_add_f32 v28, v28, v236
  s_waitcnt lgkmcnt(5)
  v_mfma_f32_32x32x16_bf16 v[208:223], a[200:203], v[40:43], v[208:223]
  v_add_f32 v29, v29, v237
  v_cvt_pk_bf16_f32 v246, v236, v237
  v_exp_f32 v239, v207
  v_add_f32 v28, v28, v238
  v_add_f32 v29, v29, v239
  s_waitcnt lgkmcnt(4)
  v_mfma_f32_32x32x16_bf16 v[208:223], a[204:207], v[44:47], v[208:223]
  v_cvt_pk_bf16_f32 v247, v238, v239
  v_add_f32 v28, v28, v29
  v_cmp_nle_f32 vcc, v28, v31
  s_cbranch_vccnz L_tr8
L_bk8:
  v_add_f32 v27, v27, v28
  s_waitcnt lgkmcnt(3)
  v_mfma_f32_32x32x16_bf16 v[208:223], a[208:211], v[48:51], v[208:223]
  s_add_u32 m0, s62, 69696
  s_waitcnt lgkmcnt(2)
  v_mfma_f32_32x32x16_bf16 v[208:223], a[212:215], v[52:55], v[208:223]
  buffer_load_dwordx4 v18, s[28:31], s60 offen offset:1024 nt lds
  s_waitcnt lgkmcnt(1)
  v_mfma_f32_32x32x16_bf16 v[208:223], a[216:219], v[56:59], v[208:223]
  s_waitcnt lgkmcnt(0)
  v_mfma_f32_32x32x16_bf16 v[208:223], a[220:223], v[60:63], v[208:223]
  v_mfma_f32_32x32x16_bf16 a[128:143], a[224:227], v[240:243], a[128:143]
  ds_read_b64_tr_b16 a[224:225], v23 offset:0
  ds_read_b64_tr_b16 a[226:227], v23 offset:256
  v_mfma_f32_32x32x16_bf16 a[144:159], a[228:231], v[240:243], a[144:159]
  ds_read_b64_tr_b16 a[228:229], v23 offset:64
  ds_read_b64_tr_b16 a[230:231], v23 offset:320
  v_exp_f32 v224, v208
  v_exp_f32 v225, v209
  v_mfma_f32_32x32x16_bf16 a[160:175], a[232:235], v[240:243], a[160:175]
  ds_read_b64_tr_b16 a[232:233], v23 offset:128
  ds_read_b64_tr_b16 a[234:235], v23 offset:384
  v_exp_f32 v226, v210
  v_add_f32 v28, v224, v225
  v_cvt_pk_bf16_f32 v248, v224, v225
  v_mfma_f32_32x32x16_bf16 a[176:191], a[236:239], v[240:243], a[176:191]
  ds_read_b64_tr_b16 a[236:237], v23 offset:192
  ds_read_b64_tr_b16 a[238:239], v23 offset:448
  v_exp_f32 v227, v211
  s_add_u32 m0, s62, 69760
  v_mfma_f32_32x32x16_bf16 a[128:143], a[240:243], v[244:247], a[128:143]
  buffer_load_dwordx4 v18, s[28:31], s60 offen offset:2048 nt lds
  ds_read_b64_tr_b16 a[240:241], v23 offset:4352
  ds_read_b64_tr_b16 a[242:243], v23 offset:4608
  v_exp_f32 v228, v212
  v_mfma_f32_32x32x16_bf16 a[144:159], a[244:247], v[244:247], a[144:159]
  ds_read_b64_tr_b16 a[244:245], v23 offset:4416
  ds_read_b64_tr_b16 a[246:247], v23 offset:4672
  v_add_f32 v29, v226, v227
  v_cvt_pk_bf16_f32 v249, v226, v227
  v_exp_f32 v229, v213
  v_mfma_f32_32x32x16_bf16 a[160:175], a[248:251], v[244:247], a[160:175]
  ds_read_b64_tr_b16 a[248:249], v23 offset:4480
  ds_read_b64_tr_b16 a[250:251], v23 offset:4736
  v_exp_f32 v230, v214
  v_add_f32 v28, v28, v228
  v_add_f32 v29, v29, v229
  v_mfma_f32_32x32x16_bf16 a[176:191], a[252:255], v[244:247], a[176:191]
  ds_read_b64_tr_b16 a[252:253], v23 offset:4544
  ds_read_b64_tr_b16 a[254:255], v23 offset:4800
  v_cvt_pk_bf16_f32 v250, v228, v229
  v_exp_f32 v231, v215
  v_mfma_f32_32x32x16_bf16 v[192:207], a[192:195], v[128:131], v[176:191]
  v_exp_f32 v232, v216
  v_add_f32 v28, v28, v230
  v_add_f32 v29, v29, v231
  v_cvt_pk_bf16_f32 v251, v230, v231
  v_mfma_f32_32x32x16_bf16 v[192:207], a[196:199], v[132:135], v[192:207]
  v_exp_f32 v233, v217
  v_exp_f32 v234, v218
  v_add_f32 v28, v28, v232
  v_add_f32 v29, v29, v233
  v_mfma_f32_32x32x16_bf16 v[192:207], a[200:203], v[136:139], v[192:207]
  v_cvt_pk_bf16_f32 v252, v232, v233
  v_exp_f32 v235, v219
  v_exp_f32 v236, v220
  s_add_u32 m0, s62, 69824
  v_mfma_f32_32x32x16_bf16 v[192:207], a[204:207], v[140:143], v[192:207]
  buffer_load_dwordx4 v18, s[28:31], s60 offen offset:3072 nt lds
  v_add_f32 v28, v28, v234
  v_add_f32 v29, v29, v235
  v_cvt_pk_bf16_f32 v253, v234, v235
  v_mfma_f32_32x32x16_bf16 v[192:207], a[208:211], v[144:147], v[192:207]
  v_exp_f32 v237, v221
  v_exp_f32 v238, v222
  v_add_f32 v28, v28, v236
  v_add_f32 v29, v29, v237
  v_mfma_f32_32x32x16_bf16 v[192:207], a[212:215], v[148:151], v[192:207]
  v_cvt_pk_bf16_f32 v254, v236, v237
  v_exp_f32 v239, v223
  v_add_f32 v28, v28, v238
  v_add_f32 v29, v29, v239
  v_cvt_pk_bf16_f32 v255, v238, v239
  v_mfma_f32_32x32x16_bf16 v[192:207], a[216:219], v[152:155], v[192:207]
  v_add_f32 v28, v28, v29
  v_cmp_nle_f32 vcc, v28, v31
  s_cbranch_vccnz L_tr9
L_bk9:
  v_add_f32 v25, v25, v28
  v_mfma_f32_32x32x16_bf16 v[192:207], a[220:223], v[156:159], v[192:207]
  s_waitcnt lgkmcnt(14)
  v_mfma_f32_32x32x16_bf16 a[0:15], a[224:227], v[248:251], a[0:15]
  s_waitcnt lgkmcnt(12)
  v_mfma_f32_32x32x16_bf16 a[16:31], a[228:231], v[248:251], a[16:31]
  v_exp_f32 v224, v192
  v_exp_f32 v225, v193
  s_mov_b32 s60, 53248
  s_add_u32 m0, s62, 73984
  s_waitcnt lgkmcnt(10)
  v_mfma_f32_32x32x16_bf16 a[32:47], a[232:235], v[248:251], a[32:47]
  buffer_load_dwordx4 v18, s[28:31], s60 offen offset:0 nt lds
  v_exp_f32 v226, v194
  v_add_f32 v28, v224, v225
  v_cvt_pk_bf16_f32 v240, v224, v225
  s_waitcnt lgkmcnt(8)
  v_mfma_f32_32x32x16_bf16 a[48:63], a[236:239], v[248:251], a[48:63]
  v_exp_f32 v227, v195
  v_exp_f32 v228, v196
  v_add_f32 v29, v226, v227
  v_cvt_pk_bf16_f32 v241, v226, v227
  s_waitcnt lgkmcnt(6)
  v_mfma_f32_32x32x16_bf16 a[0:15], a[240:243], v[252:255], a[0:15]
  v_exp_f32 v229, v197
  v_exp_f32 v230, v198
  v_add_f32 v28, v28, v228
  v_add_f32 v29, v29, v229
  s_waitcnt lgkmcnt(4)
  v_mfma_f32_32x32x16_bf16 a[16:31], a[244:247], v[252:255], a[16:31]
  v_cvt_pk_bf16_f32 v242, v228, v229
  v_exp_f32 v231, v199
  v_exp_f32 v232, v200
  v_add_f32 v28, v28, v230
  s_waitcnt lgkmcnt(2)
  v_mfma_f32_32x32x16_bf16 a[32:47], a[248:251], v[252:255], a[32:47]
  v_add_f32 v29, v29, v231
  v_cvt_pk_bf16_f32 v243, v230, v231
  v_exp_f32 v233, v201
  v_exp_f32 v234, v202
  s_waitcnt lgkmcnt(0)
  v_mfma_f32_32x32x16_bf16 a[48:63], a[252:255], v[252:255], a[48:63]
  v_add_f32 v28, v28, v232
  v_add_f32 v29, v29, v233
  v_cvt_pk_bf16_f32 v244, v232, v233
  s_add_u32 m0, s62, 74048
  s_waitcnt vmcnt(13)
  s_barrier
  v_mfma_f32_32x32x16_bf16 v[208:223], a[192:195], v[64:67], v[96:111]
  buffer_load_dwordx4 v18, s[28:31], s60 offen offset:1024 nt lds
  ds_read_b128 a[192:195], v21 offset:34816
  v_exp_f32 v235, v203
  v_mfma_f32_32x32x16_bf16 v[208:223], a[196:199], v[68:71], v[208:223]
  ds_read_b128 a[196:199], v22 offset:34816
  v_exp_f32 v236, v204
  v_add_f32 v28, v28, v234
  v_add_f32 v29, v29, v235
  v_cvt_pk_bf16_f32 v245, v234, v235
  v_mfma_f32_32x32x16_bf16 v[208:223], a[200:203], v[72:75], v[208:223]
  ds_read_b128 a[200:203], v21 offset:34880
  v_exp_f32 v237, v205
  v_exp_f32 v238, v206
  v_add_f32 v28, v28, v236
  v_mfma_f32_32x32x16_bf16 v[208:223], a[204:207], v[76:79], v[208:223]
  ds_read_b128 a[204:207], v22 offset:34880
  v_add_f32 v29, v29, v237
  v_cvt_pk_bf16_f32 v246, v236, v237
  v_exp_f32 v239, v207
  v_add_f32 v28, v28, v238
  v_mfma_f32_32x32x16_bf16 v[208:223], a[208:211], v[80:83], v[208:223]
  ds_read_b128 a[208:211], v21 offset:34944
  v_add_f32 v29, v29, v239
  v_cvt_pk_bf16_f32 v247, v238, v239
  v_add_f32 v28, v28, v29
  v_mfma_f32_32x32x16_bf16 v[208:223], a[212:215], v[84:87], v[208:223]
  ds_read_b128 a[212:215], v22 offset:34944
  v_cmp_nle_f32 vcc, v28, v31
  s_cbranch_vccnz L_tr10
L_bk10:
  v_add_f32 v26, v26, v28
  v_mfma_f32_32x32x16_bf16 v[208:223], a[216:219], v[88:91], v[208:223]
  ds_read_b128 a[216:219], v21 offset:35008
  s_add_u32 m0, s62, 74112
  v_mfma_f32_32x32x16_bf16 v[208:223], a[220:223], v[92:95], v[208:223]
  buffer_load_dwordx4 v18, s[28:31], s60 offen offset:2048 nt lds
  ds_read_b128 a[220:223], v22 offset:35008
  v_mfma_f32_32x32x16_bf16 a[64:79], a[224:227], v[240:243], a[64:79]
  v_mfma_f32_32x32x16_bf16 a[80:95], a[228:231], v[240:243], a[80:95]
  buffer_atomic_add v7, v12, s[48:51], s76 offen sc1
  v_exp_f32 v224, v208
  v_exp_f32 v225, v209
  v_mfma_f32_32x32x16_bf16 a[96:111], a[232:235], v[240:243], a[96:111]
  v_exp_f32 v226, v210
  v_add_f32 v28, v224, v225
  v_cvt_pk_bf16_f32 v248, v224, v225
  v_exp_f32 v227, v211
  v_mfma_f32_32x32x16_bf16 a[112:127], a[236:239], v[240:243], a[112:127]
  v_exp_f32 v228, v212
  v_add_f32 v29, v226, v227
  v_cvt_pk_bf16_f32 v249, v226, v227
  v_exp_f32 v229, v213
  v_mfma_f32_32x32x16_bf16 a[64:79], a[240:243], v[244:247], a[64:79]
  v_exp_f32 v230, v214
  v_add_f32 v28, v28, v228
  v_add_f32 v29, v29, v229
  v_cvt_pk_bf16_f32 v250, v228, v229
  v_mfma_f32_32x32x16_bf16 a[80:95], a[244:247], v[244:247], a[80:95]
  v_exp_f32 v231, v215
  v_exp_f32 v232, v216
  v_add_f32 v28, v28, v230
  s_add_u32 m0, s62, 74176
  v_mfma_f32_32x32x16_bf16 a[96:111], a[248:251], v[244:247], a[96:111]
  buffer_load_dwordx4 v18, s[28:31], s60 offen offset:3072 nt lds
  v_add_f32 v29, v29, v231
  v_cvt_pk_bf16_f32 v251, v230, v231
  v_exp_f32 v233, v217
  v_mfma_f32_32x32x16_bf16 a[112:127], a[252:255], v[244:247], a[112:127]
  v_exp_f32 v234, v218
  v_add_f32 v28, v28, v232
  v_add_f32 v29, v29, v233
  v_cvt_pk_bf16_f32 v252, v232, v233
  s_waitcnt lgkmcnt(7)
  v_mfma_f32_32x32x16_bf16 v[192:207], a[192:195], v[32:35], v[160:175]
  v_exp_f32 v235, v219
  v_exp_f32 v236, v220
  v_add_f32 v28, v28, v234
  v_add_f32 v29, v29, v235
  s_waitcnt lgkmcnt(6)
  v_mfma_f32_32x32x16_bf16 v[192:207], a[196:199], v[36:39], v[192:207]
  v_cvt_pk_bf16_f32 v253, v234, v235
  v_exp_f32 v237, v221
  v_exp_f32 v238, v222
  v_add_f32 v28, v28, v236
  s_waitcnt lgkmcnt(5)
  v_mfma_f32_32x32x16_bf16 v[192:207], a[200:203], v[40:43], v[192:207]
  v_add_f32 v29, v29, v237
  v_cvt_pk_bf16_f32 v254, v236, v237
  v_exp_f32 v239, v223
  v_add_f32 v28, v28, v238
  v_add_f32 v29, v29, v239
  s_waitcnt lgkmcnt(4)
  v_mfma_f32_32x32x16_bf16 v[192:207], a[204:207], v[44:47], v[192:207]
  v_cvt_pk_bf16_f32 v255, v238, v239
  v_add_f32 v28, v28, v29
  v_cmp_nle_f32 vcc, v28, v31
  s_cbranch_vccnz L_tr11
L_bk11:
  v_add_f32 v27, v27, v28
  s_waitcnt lgkmcnt(3)
  v_mfma_f32_32x32x16_bf16 v[192:207], a[208:211], v[48:51], v[192:207]
  s_mov_b32 s60, 57344
  s_add_u32 m0, s62, 0
  s_waitcnt lgkmcnt(2)
  v_mfma_f32_32x32x16_bf16 v[192:207], a[212:215], v[52:55], v[192:207]
  buffer_load_dwordx4 v18, s[28:31], s60 offen offset:0 nt lds
  s_waitcnt lgkmcnt(1)
  v_mfma_f32_32x32x16_bf16 v[192:207], a[216:219], v[56:59], v[192:207]
  s_waitcnt lgkmcnt(0)
  v_mfma_f32_32x32x16_bf16 v[192:207], a[220:223], v[60:63], v[192:207]
  v_mfma_f32_32x32x16_bf16 a[128:143], a[224:227], v[248:251], a[128:143]
  ds_read_b64_tr_b16 a[224:225], v24 offset:34816
  ds_read_b64_tr_b16 a[226:227], v24 offset:35072
  v_mfma_f32_32x32x16_bf16 a[144:159], a[228:231], v[248:251], a[144:159]
  ds_read_b64_tr_b16 a[228:229], v24 offset:34880
  ds_read_b64_tr_b16 a[230:231], v24 offset:35136
  v_exp_f32 v224, v192
  v_exp_f32 v225, v193
  v_mfma_f32_32x32x16_bf16 a[160:175], a[232:235], v[248:251], a[160:175]
  ds_read_b64_tr_b16 a[232:233], v24 offset:34944
  ds_read_b64_tr_b16 a[234:235], v24 offset:35200
  v_exp_f32 v226, v194
  v_add_f32 v28, v224, v225
  v_cvt_pk_bf16_f32 v240, v224, v225
  v_mfma_f32_32x32x16_bf16 a[176:191], a[236:239], v[248:251], a[176:191]
  ds_read_b64_tr_b16 a[236:237], v24 offset:35008
  ds_read_b64_tr_b16 a[238:239], v24 offset:35264
  v_exp_f32 v227, v195
  s_add_u32 m0, s62, 64
  v_mfma_f32_32x32x16_bf16 a[128:143], a[240:243], v[252:255], a[128:143]
  buffer_load_dwordx4 v18, s[28:31], s60 offen offset:1024 nt lds
  ds_read_b64_tr_b16 a[240:241], v24 offset:39168
  ds_read_b64_tr_b16 a[242:243], v24 offset:39424
  v_exp_f32 v228, v196
  v_mfma_f32_32x32x16_bf16 a[144:159], a[244:247], v[252:255], a[144:159]
  ds_read_b64_tr_b16 a[244:245], v24 offset:39232
  ds_read_b64_tr_b16 a[246:247], v24 offset:39488
  v_add_f32 v29, v226, v227
  v_cvt_pk_bf16_f32 v241, v226, v227
  v_exp_f32 v229, v197
  v_mfma_f32_32x32x16_bf16 a[160:175], a[248:251], v[252:255], a[160:175]
  ds_read_b64_tr_b16 a[248:249], v24 offset:39296
  ds_read_b64_tr_b16 a[250:251], v24 offset:39552
  v_exp_f32 v230, v198
  v_add_f32 v28, v28, v228
  v_add_f32 v29, v29, v229
  v_mfma_f32_32x32x16_bf16 a[176:191], a[252:255], v[252:255], a[176:191]
  ds_read_b64_tr_b16 a[252:253], v24 offset:39360
  ds_read_b64_tr_b16 a[254:255], v24 offset:39616
  v_cvt_pk_bf16_f32 v242, v228, v229
  v_exp_f32 v231, v199
  v_mfma_f32_32x32x16_bf16 v[208:223], a[192:195], v[128:131], v[176:191]
  v_exp_f32 v232, v200
  v_add_f32 v28, v28, v230
  v_add_f32 v29, v29, v231
  v_cvt_pk_bf16_f32 v243, v230, v231
  v_mfma_f32_32x32x16_bf16 v[208:223], a[196:199], v[132:135], v[208:223]
  v_exp_f32 v233, v201
  v_exp_f32 v234, v202
  v_add_f32 v28, v28, v232
  v_add_f32 v29, v29, v233
  v_mfma_f32_32x32x16_bf16 v[208:223], a[200:203], v[136:139], v[208:223]
  v_cvt_pk_bf16_f32 v244, v232, v233
  v_exp_f32 v235, v203
  v_exp_f32 v236, v204
  s_add_u32 m0, s62, 128
  v_mfma_f32_32x32x16_bf16 v[208:223], a[204:207], v[140:143], v[208:223]
  buffer_load_dwordx4 v18, s[28:31], s60 offen offset:2048 nt lds
  v_add_f32 v28, v28, v234
  v_add_f32 v29, v29, v235
  v_cvt_pk_bf16_f32 v245, v234, v235
  v_mfma_f32_32x32x16_bf16 v[208:223], a[208:211], v[144:147], v[208:223]
  v_exp_f32 v237, v205
  v_exp_f32 v238, v206
  v_add_f32 v28, v28, v236
  v_add_f32 v29, v29, v237
  v_mfma_f32_32x32x16_bf16 v[208:223], a[212:215], v[148:151], v[208:223]
  v_cvt_pk_bf16_f32 v246, v236, v237
  v_exp_f32 v239, v207
  v_add_f32 v28, v28, v238
  v_add_f32 v29, v29, v239
  v_cvt_pk_bf16_f32 v247, v238, v239
  v_mfma_f32_32x32x16_bf16 v[208:223], a[216:219], v[152:155], v[208:223]
  v_add_f32 v28, v28, v29
  v_cmp_nle_f32 vcc, v28, v31
  s_cbranch_vccnz L_tr12
L_bk12:
  v_add_f32 v25, v25, v28
  v_mfma_f32_32x32x16_bf16 v[208:223], a[220:223], v[156:159], v[208:223]
  s_waitcnt lgkmcnt(14)
  v_mfma_f32_32x32x16_bf16 a[0:15], a[224:227], v[240:243], a[0:15]
  s_waitcnt lgkmcnt(12)
  v_mfma_f32_32x32x16_bf16 a[16:31], a[228:231], v[240:243], a[16:31]
  v_exp_f32 v224, v208
  v_exp_f32 v225, v209
  s_add_u32 m0, s62, 192
  s_waitcnt lgkmcnt(10)
  v_mfma_f32_32x32x16_bf16 a[32:47], a[232:235], v[240:243], a[32:47]
  buffer_load_dwordx4 v18, s[28:31], s60 offen offset:3072 nt lds
  v_exp_f32 v226, v210
  v_add_f32 v28, v224, v225
  v_cvt_pk_bf16_f32 v248, v224, v225
  s_waitcnt lgkmcnt(8)
  v_mfma_f32_32x32x16_bf16 a[48:63], a[236:239], v[240:243], a[48:63]
  v_exp_f32 v227, v211
  v_exp_f32 v228, v212
  v_add_f32 v29, v226, v227
  v_cvt_pk_bf16_f32 v249, v226, v227
  s_waitcnt lgkmcnt(6)
  v_mfma_f32_32x32x16_bf16 a[0:15], a[240:243], v[244:247], a[0:15]
  v_exp_f32 v229, v213
  v_exp_f32 v230, v214
  v_add_f32 v28, v28, v228
  v_add_f32 v29, v29, v229
  s_waitcnt lgkmcnt(4)
  v_mfma_f32_32x32x16_bf16 a[16:31], a[244:247], v[244:247], a[16:31]
  v_cvt_pk_bf16_f32 v250, v228, v229
  v_exp_f32 v231, v215
  v_exp_f32 v232, v216
  v_add_f32 v28, v28, v230
  s_waitcnt lgkmcnt(2)
  v_mfma_f32_32x32x16_bf16 a[32:47], a[248:251], v[244:247], a[32:47]
  v_add_f32 v29, v29, v231
  v_cvt_pk_bf16_f32 v251, v230, v231
  v_exp_f32 v233, v217
  v_exp_f32 v234, v218
  s_waitcnt lgkmcnt(0)
  v_mfma_f32_32x32x16_bf16 a[48:63], a[252:255], v[244:247], a[48:63]
  v_add_f32 v28, v28, v232
  v_add_f32 v29, v29, v233
  v_cvt_pk_bf16_f32 v252, v232, v233
  v_exp_f32 v235, v219
  s_waitcnt vmcnt(13)
  s_barrier
  v_mfma_f32_32x32x16_bf16 v[192:207], a[192:195], v[64:67], v[96:111]
  ds_read_b128 a[192:195], v19 offset:34816
  v_exp_f32 v236, v220
  v_add_f32 v28, v28, v234
  s_mov_b32 s60, 61440
  s_add_u32 m0, s62, 4352
  v_mfma_f32_32x32x16_bf16 v[192:207], a[196:199], v[68:71], v[192:207]
  buffer_load_dwordx4 v18, s[28:31], s60 offen offset:0 nt lds
  ds_read_b128 a[196:199], v20 offset:34816
  v_add_f32 v29, v29, v235
  v_cvt_pk_bf16_f32 v253, v234, v235
  v_mfma_f32_32x32x16_bf16 v[192:207], a[200:203], v[72:75], v[192:207]
  ds_read_b128 a[200:203], v19 offset:34880
  v_exp_f32 v237, v221
  v_exp_f32 v238, v222
  v_add_f32 v28, v28, v236
  v_mfma_f32_32x32x16_bf16 v[192:207], a[204:207], v[76:79], v[192:207]
  ds_read_b128 a[204:207], v20 offset:34880
  v_add_f32 v29, v29, v237
  v_cvt_pk_bf16_f32 v254, v236, v237
  v_exp_f32 v239, v223
  v_add_f32 v28, v28, v238
  v_mfma_f32_32x32x16_bf16 v[192:207], a[208:211], v[80:83], v[192:207]
  ds_read_b128 a[208:211], v19 offset:34944
  v_add_f32 v29, v29, v239
  v_cvt_pk_bf16_f32 v255, v238, v239
  v_add_f32 v28, v28, v29
  v_mfma_f32_32x32x16_bf16 v[192:207], a[212:215], v[84:87], v[192:207]
  ds_read_b128 a[212:215], v20 offset:34944
  v_cmp_nle_f32 vcc, v28, v31
  s_cbranch_vccnz L_tr13
L_bk13:
  v_add_f32 v26, v26, v28
  v_mfma_f32_32x32x16_bf16 v[192:207], a[216:219], v[88:91], v[192:207]
  ds_read_b128 a[216:219], v19 offset:35008
  v_mfma_f32_32x32x16_bf16 v[192:207], a[220:223], v[92:95], v[192:207]
  ds_read_b128 a[220:223], v20 offset:35008
  s_add_u32 m0, s62, 4416
  v_mfma_f32_32x32x16_bf16 a[64:79], a[224:227], v[248:251], a[64:79]
  buffer_load_dwordx4 v18, s[28:31], s60 offen offset:1024 nt lds
  v_mfma_f32_32x32x16_bf16 a[80:95], a[228:231], v[248:251], a[80:95]
  v_exp_f32 v224, v192
  v_exp_f32 v225, v193
  v_exp_f32 v226, v194
  v_mfma_f32_32x32x16_bf16 a[96:111], a[232:235], v[248:251], a[96:111]
  v_add_f32 v28, v224, v225
  v_cvt_pk_bf16_f32 v240, v224, v225
  v_exp_f32 v227, v195
  v_exp_f32 v228, v196
  v_mfma_f32_32x32x16_bf16 a[112:127], a[236:239], v[248:251], a[112:127]
  v_add_f32 v29, v226, v227
  v_cvt_pk_bf16_f32 v241, v226, v227
  v_exp_f32 v229, v197
  v_exp_f32 v230, v198
  v_mfma_f32_32x32x16_bf16 a[64:79], a[240:243], v[252:255], a[64:79]
  v_add_f32 v28, v28, v228
  v_add_f32 v29, v29, v229
  v_cvt_pk_bf16_f32 v242, v228, v229
  v_exp_f32 v231, v199
  v_mfma_f32_32x32x16_bf16 a[80:95], a[244:247], v[252:255], a[80:95]
  v_exp_f32 v232, v200
  v_add_f32 v28, v28, v230
  v_add_f32 v29, v29, v231
  v_cvt_pk_bf16_f32 v243, v230, v231
  v_mfma_f32_32x32x16_bf16 a[96:111], a[248:251], v[252:255], a[96:111]
  v_exp_f32 v233, v201
  v_exp_f32 v234, v202
  v_add_f32 v28, v28, v232
  s_add_u32 m0, s62, 4480
  v_mfma_f32_32x32x16_bf16 a[112:127], a[252:255], v[252:255], a[112:127]
  buffer_load_dwordx4 v18, s[28:31], s60 offen offset:2048 nt lds
  v_add_f32 v29, v29, v233
  v_cvt_pk_bf16_f32 v244, v232, v233
  v_exp_f32 v235, v203
  s_waitcnt lgkmcnt(7)
  v_mfma_f32_32x32x16_bf16 v[208:223], a[192:195], v[32:35], v[160:175]
  v_exp_f32 v236, v204
  v_add_f32 v28, v28, v234
  v_add_f32 v29, v29, v235
  v_cvt_pk_bf16_f32 v245, v234, v235
  s_waitcnt lgkmcnt(6)
  v_mfma_f32_32x32x16_bf16 v[208:223], a[196:199], v[36:39], v[208:223]
  v_exp_f32 v237, v205
  v_exp_f32 v238, v206
  v_add_f32 v28, v28, v236
  v_add_f32 v29, v29, v237
  s_waitcnt lgkmcnt(5)
  v_mfma_f32_32x32x16_bf16 v[208:223], a[200:203], v[40:43], v[208:223]
  v_cvt_pk_bf16_f32 v246, v236, v237
  v_exp_f32 v239, v207
  v_add_f32 v28, v28, v238
  v_add_f32 v29, v29, v239
  v_cvt_pk_bf16_f32 v247, v238, v239
  s_waitcnt lgkmcnt(4)
  v_mfma_f32_32x32x16_bf16 v[208:223], a[204:207], v[44:47], v[208:223]
  v_add_f32 v28, v28, v29
  v_cmp_nle_f32 vcc, v28, v31
  s_cbranch_vccnz L_tr14
L_bk14:
  v_add_f32 v27, v27, v28
  s_waitcnt lgkmcnt(3)
  v_mfma_f32_32x32x16_bf16 v[208:223], a[208:211], v[48:51], v[208:223]
  s_add_u32 m0, s62, 4544
  s_waitcnt lgkmcnt(2)
  v_mfma_f32_32x32x16_bf16 v[208:223], a[212:215], v[52:55], v[208:223]
  buffer_load_dwordx4 v18, s[28:31], s60 offen offset:3072 nt lds
  s_waitcnt lgkmcnt(1)
  v_mfma_f32_32x32x16_bf16 v[208:223], a[216:219], v[56:59], v[208:223]
  s_waitcnt lgkmcnt(0)
  v_mfma_f32_32x32x16_bf16 v[208:223], a[220:223], v[60:63], v[208:223]
  v_mfma_f32_32x32x16_bf16 a[128:143], a[224:227], v[240:243], a[128:143]
  ds_read_b64_tr_b16 a[224:225], v23 offset:34816
  ds_read_b64_tr_b16 a[226:227], v23 offset:35072
  v_mfma_f32_32x32x16_bf16 a[144:159], a[228:231], v[240:243], a[144:159]
  ds_read_b64_tr_b16 a[228:229], v23 offset:34880
  ds_read_b64_tr_b16 a[230:231], v23 offset:35136
  v_exp_f32 v224, v208
  v_exp_f32 v225, v209
  v_mfma_f32_32x32x16_bf16 a[160:175], a[232:235], v[240:243], a[160:175]
  ds_read_b64_tr_b16 a[232:233], v23 offset:34944
  ds_read_b64_tr_b16 a[234:235], v23 offset:35200
  v_exp_f32 v226, v210
  v_add_f32 v28, v224, v225
  v_cvt_pk_bf16_f32 v248, v224, v225
  v_mfma_f32_32x32x16_bf16 a[176:191], a[236:239], v[240:243], a[176:191]
  ds_read_b64_tr_b16 a[236:237], v23 offset:35008
  ds_read_b64_tr_b16 a[238:239], v23 offset:35264
  v_exp_f32 v227, v211
  s_mov_b32 s60, 65536
  s_add_u32 m0, s62, 104448
  v_mfma_f32_32x32x16_bf16 a[128:143], a[240:243], v[244:247], a[128:143]
  buffer_load_dwordx4 v18, s[28:31], s60 offen offset:0 nt lds
  ds_read_b64_tr_b16 a[240:241], v23 offset:39168
  ds_read_b64_tr_b16 a[242:243], v23 offset:39424
  v_exp_f32 v228, v212
  v_mfma_f32_32x32x16_bf16 a[144:159], a[244:247], v[244:247], a[144:159]
  ds_read_b64_tr_b16 a[244:245], v23 offset:39232
  ds_read_b64_tr_b16 a[246:247], v23 offset:39488
  v_add_f32 v29, v226, v227
  v_cvt_pk_bf16_f32 v249, v226, v227
  v_exp_f32 v229, v213
  v_mfma_f32_32x32x16_bf16 a[160:175], a[248:251], v[244:247], a[160:175]
  ds_read_b64_tr_b16 a[248:249], v23 offset:39296
  ds_read_b64_tr_b16 a[250:251], v23 offset:39552
  v_exp_f32 v230, v214
  v_add_f32 v28, v28, v228
  v_add_f32 v29, v29, v229
  v_mfma_f32_32x32x16_bf16 a[176:191], a[252:255], v[244:247], a[176:191]
  ds_read_b64_tr_b16 a[252:253], v23 offset:39360
  ds_read_b64_tr_b16 a[254:255], v23 offset:39616
  v_cvt_pk_bf16_f32 v250, v228, v229
  v_exp_f32 v231, v215
  v_mfma_f32_32x32x16_bf16 v[192:207], a[192:195], v[128:131], v[176:191]
  v_exp_f32 v232, v216
  v_add_f32 v28, v28, v230
  v_add_f32 v29, v29, v231
  v_cvt_pk_bf16_f32 v251, v230, v231
  v_mfma_f32_32x32x16_bf16 v[192:207], a[196:199], v[132:135], v[192:207]
  v_exp_f32 v233, v217
  v_exp_f32 v234, v218
  v_add_f32 v28, v28, v232
  v_add_f32 v29, v29, v233
  v_mfma_f32_32x32x16_bf16 v[192:207], a[200:203], v[136:139], v[192:207]
  v_cvt_pk_bf16_f32 v252, v232, v233
  v_exp_f32 v235, v219
  v_exp_f32 v236, v220
  s_add_u32 m0, s62, 104512
  v_mfma_f32_32x32x16_bf16 v[192:207], a[204:207], v[140:143], v[192:207]
  buffer_load_dwordx4 v18, s[28:31], s60 offen offset:1024 nt lds
  v_add_f32 v28, v28, v234
  v_add_f32 v29, v29, v235
  v_cvt_pk_bf16_f32 v253, v234, v235
  v_mfma_f32_32x32x16_bf16 v[192:207], a[208:211], v[144:147], v[192:207]
  v_exp_f32 v237, v221
  v_exp_f32 v238, v222
  v_add_f32 v28, v28, v236
  v_add_f32 v29, v29, v237
  v_mfma_f32_32x32x16_bf16 v[192:207], a[212:215], v[148:151], v[192:207]
  v_cvt_pk_bf16_f32 v254, v236, v237
  v_exp_f32 v239, v223
  v_add_f32 v28, v28, v238
  v_add_f32 v29, v29, v239
  v_cvt_pk_bf16_f32 v255, v238, v239
  v_mfma_f32_32x32x16_bf16 v[192:207], a[216:219], v[152:155], v[192:207]
  v_add_f32 v28, v28, v29
  v_cmp_nle_f32 vcc, v28, v31
  s_cbranch_vccnz L_tr15
L_bk15:
  v_add_f32 v25, v25, v28
  v_mfma_f32_32x32x16_bf16 v[192:207], a[220:223], v[156:159], v[192:207]
  s_waitcnt lgkmcnt(14)
  v_mfma_f32_32x32x16_bf16 a[0:15], a[224:227], v[248:251], a[0:15]
  s_waitcnt lgkmcnt(12)
  v_mfma_f32_32x32x16_bf16 a[16:31], a[228:231], v[248:251], a[16:31]
  v_exp_f32 v224, v192
  v_exp_f32 v225, v193
  s_add_u32 m0, s62, 104576
  s_waitcnt lgkmcnt(10)
  v_mfma_f32_32x32x16_bf16 a[32:47], a[232:235], v[248:251], a[32:47]
  buffer_load_dwordx4 v18, s[28:31], s60 offen offset:2048 nt lds
  v_exp_f32 v226, v194
  v_add_f32 v28, v224, v225
  v_cvt_pk_bf16_f32 v240, v224, v225
  s_waitcnt lgkmcnt(8)
  v_mfma_f32_32x32x16_bf16 a[48:63], a[236:239], v[248:251], a[48:63]
  v_exp_f32 v227, v195
  v_exp_f32 v228, v196
  v_add_f32 v29, v226, v227
  v_cvt_pk_bf16_f32 v241, v226, v227
  s_waitcnt lgkmcnt(6)
  v_mfma_f32_32x32x16_bf16 a[0:15], a[240:243], v[252:255], a[0:15]
  v_exp_f32 v229, v197
  v_exp_f32 v230, v198
  v_add_f32 v28, v28, v228
  v_add_f32 v29, v29, v229
  s_waitcnt lgkmcnt(4)
  v_mfma_f32_32x32x16_bf16 a[16:31], a[244:247], v[252:255], a[16:31]
  v_cvt_pk_bf16_f32 v242, v228, v229
  v_exp_f32 v231, v199
  v_exp_f32 v232, v200
  v_add_f32 v28, v28, v230
  s_waitcnt lgkmcnt(2)
  v_mfma_f32_32x32x16_bf16 a[32:47], a[248:251], v[252:255], a[32:47]
  v_add_f32 v29, v29, v231
  v_cvt_pk_bf16_f32 v243, v230, v231
  v_exp_f32 v233, v201
  v_exp_f32 v234, v202
  s_waitcnt lgkmcnt(0)
  v_mfma_f32_32x32x16_bf16 a[48:63], a[252:255], v[252:255], a[48:63]
  v_add_f32 v28, v28, v232
  v_add_f32 v29, v29, v233
  v_cvt_pk_bf16_f32 v244, v232, v233
  v_exp_f32 v235, v203
  s_waitcnt vmcnt(11)
  s_barrier
  v_mfma_f32_32x32x16_bf16 v[208:223], a[192:195], v[64:67], v[96:111]
  ds_read_b128 a[192:195], v21 offset:0
  v_exp_f32 v236, v204
  v_add_f32 v28, v28, v234
  v_add_f32 v29, v29, v235
  s_add_u32 m0, s62, 104640
  v_mfma_f32_32x32x16_bf16 v[208:223], a[196:199], v[68:71], v[208:223]
  buffer_load_dwordx4 v18, s[28:31], s60 offen offset:3072 nt lds
  ds_read_b128 a[196:199], v22 offset:0
  v_cvt_pk_bf16_f32 v245, v234, v235
  v_exp_f32 v237, v205
  v_mfma_f32_32x32x16_bf16 v[208:223], a[200:203], v[72:75], v[208:223]
  ds_read_b128 a[200:203], v21 offset:64
  v_exp_f32 v238, v206
  v_add_f32 v28, v28, v236
  v_add_f32 v29, v29, v237
  v_cvt_pk_bf16_f32 v246, v236, v237
  v_mfma_f32_32x32x16_bf16 v[208:223], a[204:207], v[76:79], v[208:223]
  ds_read_b128 a[204:207], v22 offset:64
  v_exp_f32 v239, v207
  v_add_f32 v28, v28, v238
  v_add_f32 v29, v29, v239
  v_cvt_pk_bf16_f32 v247, v238, v239
  v_mfma_f32_32x32x16_bf16 v[208:223], a[208:211], v[80:83], v[208:223]
  ds_read_b128 a[208:211], v21 offset:128
  v_add_f32 v28, v28, v29
  v_cmp_nle_f32 vcc, v28, v31
  s_cbranch_vccnz L_tr16
L_bk16:
  v_add_f32 v26, v26, v28
  v_mfma_f32_32x32x16_bf16 v[208:223], a[212:215], v[84:87], v[208:223]
  ds_read_b128 a[212:215], v22 offset:128
  v_mfma_f32_32x32x16_bf16 v[208:223], a[216:219], v[88:91], v[208:223]
  ds_read_b128 a[216:219], v21 offset:192
  v_mfma_f32_32x32x16_bf16 v[208:223], a[220:223], v[92:95], v[208:223]
  ds_read_b128 a[220:223], v22 offset:192
  s_mov_b32 s60, 69632
  s_add_u32 m0, s62, 108800
  v_mfma_f32_32x32x16_bf16 a[64:79], a[224:227], v[240:243], a[64:79]
  buffer_load_dwordx4 v18, s[28:31], s60 offen offset:0 nt lds
  v_mfma_f32_32x32x16_bf16 a[80:95], a[228:231], v[240:243], a[80:95]
  v_exp_f32 v224, v208
  v_exp_f32 v225, v209
  v_exp_f32 v226, v210
  v_mfma_f32_32x32x16_bf16 a[96:111], a[232:235], v[240:243], a[96:111]
  v_add_f32 v28, v224, v225
  v_cvt_pk_bf16_f32 v248, v224, v225
  v_exp_f32 v227, v211
  v_exp_f32 v228, v212
  v_mfma_f32_32x32x16_bf16 a[112:127], a[236:239], v[240:243], a[112:127]
  v_add_f32 v29, v226, v227
  v_cvt_pk_bf16_f32 v249, v226, v227
  v_exp_f32 v229, v213
  v_exp_f32 v230, v214
  v_mfma_f32_32x32x16_bf16 a[64:79], a[240:243], v[244:247], a[64:79]
  v_add_f32 v28, v28, v228
  v_add_f32 v29, v29, v229
  v_cvt_pk_bf16_f32 v250, v228, v229
  v_exp_f32 v231, v215
  v_mfma_f32_32x32x16_bf16 a[80:95], a[244:247], v[244:247], a[80:95]
  v_exp_f32 v232, v216
  v_add_f32 v28, v28, v230
  v_add_f32 v29, v29, v231
  v_cvt_pk_bf16_f32 v251, v230, v231
  v_mfma_f32_32x32x16_bf16 a[96:111], a[248:251], v[244:247], a[96:111]
  v_exp_f32 v233, v217
  v_exp_f32 v234, v218
  v_add_f32 v28, v28, v232
  s_add_u32 m0, s62, 108864
  v_mfma_f32_32x32x16_bf16 a[112:127], a[252:255], v[244:247], a[112:127]
  buffer_load_dwordx4 v18, s[28:31], s60 offen offset:1024 nt lds
  v_add_f32 v29, v29, v233
  v_cvt_pk_bf16_f32 v252, v232, v233
  v_exp_f32 v235, v219
  s_waitcnt lgkmcnt(7)
  v_mfma_f32_32x32x16_bf16 v[192:207], a[192:195], v[32:35], v[160:175]
  v_exp_f32 v236, v220
  v_add_f32 v28, v28, v234
  v_add_f32 v29, v29, v235
  v_cvt_pk_bf16_f32 v253, v234, v235
  s_waitcnt lgkmcnt(6)
  v_mfma_f32_32x32x16_bf16 v[192:207], a[196:199], v[36:39], v[192:207]
  v_exp_f32 v237, v221
  v_exp_f32 v238, v222
  v_add_f32 v28, v28, v236
  v_add_f32 v29, v29, v237
  s_waitcnt lgkmcnt(5)
  v_mfma_f32_32x32x16_bf16 v[192:207], a[200:203], v[40:43], v[192:207]
  v_cvt_pk_bf16_f32 v254, v236, v237
  v_exp_f32 v239, v223
  v_add_f32 v28, v28, v238
  v_add_f32 v29, v29, v239
  v_cvt_pk_bf16_f32 v255, v238, v239
  s_waitcnt lgkmcnt(4)
  v_mfma_f32_32x32x16_bf16 v[192:207], a[204:207], v[44:47], v[192:207]
  v_add_f32 v28, v28, v29
  v_cmp_nle_f32 vcc, v28, v31
  s_cbranch_vccnz L_tr17
L_bk17:
  v_add_f32 v27, v27, v28
  s_waitcnt lgkmcnt(3)
  v_mfma_f32_32x32x16_bf16 v[192:207], a[208:211], v[48:51], v[192:207]
  s_waitcnt lgkmcnt(2)
  v_mfma_f32_32x32x16_bf16 v[192:207], a[212:215], v[52:55], v[192:207]
  s_add_u32 m0, s62, 108928
  s_waitcnt lgkmcnt(1)
  v_mfma_f32_32x32x16_bf16 v[192:207], a[216:219], v[56:59], v[192:207]
  buffer_load_dwordx4 v18, s[28:31], s60 offen offset:2048 nt lds
  s_waitcnt lgkmcnt(0)
  v_mfma_f32_32x32x16_bf16 v[192:207], a[220:223], v[60:63], v[192:207]
  v_mfma_f32_32x32x16_bf16 a[128:143], a[224:227], v[248:251], a[128:143]
  ds_read_b64_tr_b16 a[224:225], v24 offset:0
  ds_read_b64_tr_b16 a[226:227], v24 offset:256
  v_mfma_f32_32x32x16_bf16 a[144:159], a[228:231], v[248:251], a[144:159]
  ds_read_b64_tr_b16 a[228:229], v24 offset:64
  ds_read_b64_tr_b16 a[230:231], v24 offset:320
  v_exp_f32 v224, v192
  v_exp_f32 v225, v193
  v_mfma_f32_32x32x16_bf16 a[160:175], a[232:235], v[248:251], a[160:175]
  ds_read_b64_tr_b16 a[232:233], v24 offset:128
  ds_read_b64_tr_b16 a[234:235], v24 offset:384
  v_exp_f32 v226, v194
  v_add_f32 v28, v224, v225
  v_cvt_pk_bf16_f32 v240, v224, v225
  v_mfma_f32_32x32x16_bf16 a[176:191], a[236:239], v[248:251], a[176:191]
  ds_read_b64_tr_b16 a[236:237], v24 offset:192
  ds_read_b64_tr_b16 a[238:239], v24 offset:448
  v_exp_f32 v227, v195
  v_exp_f32 v228, v196
  v_mfma_f32_32x32x16_bf16 a[128:143], a[240:243], v[252:255], a[128:143]
  ds_read_b64_tr_b16 a[240:241], v24 offset:4352
  ds_read_b64_tr_b16 a[242:243], v24 offset:4608
  v_add_f32 v29, v226, v227
  v_cvt_pk_bf16_f32 v241, v226, v227
  s_add_u32 m0, s62, 108992
  v_mfma_f32_32x32x16_bf16 a[144:159], a[244:247], v[252:255], a[144:159]
  buffer_load_dwordx4 v18, s[28:31], s60 offen offset:3072 nt lds
  ds_read_b64_tr_b16 a[244:245], v24 offset:4416
  ds_read_b64_tr_b16 a[246:247], v24 offset:4672
  v_exp_f32 v229, v197
  v_mfma_f32_32x32x16_bf16 a[160:175], a[248:251], v[252:255], a[160:175]
  ds_read_b64_tr_b16 a[248:249], v24 offset:4480
  ds_read_b64_tr_b16 a[250:251], v24 offset:4736
  v_exp_f32 v230, v198
  v_add_f32 v28, v28, v228
  v_add_f32 v29, v29, v229
  v_mfma_f32_32x32x16_bf16 a[176:191], a[252:255], v[252:255], a[176:191]
  ds_read_b64_tr_b16 a[252:253], v24 offset:4544
  ds_read_b64_tr_b16 a[254:255], v24 offset:4800
  v_cvt_pk_bf16_f32 v242, v228, v229
  v_exp_f32 v231, v199
  v_mfma_f32_32x32x16_bf16 v[208:223], a[192:195], v[128:131], v[176:191]
  v_exp_f32 v232, v200
  v_add_f32 v28, v28, v230
  v_add_f32 v29, v29, v231
  v_cvt_pk_bf16_f32 v243, v230, v231
  v_mfma_f32_32x32x16_bf16 v[208:223], a[196:199], v[132:135], v[208:223]
  v_exp_f32 v233, v201
  v_exp_f32 v234, v202
  v_add_f32 v28, v28, v232
  v_add_f32 v29, v29, v233
  v_mfma_f32_32x32x16_bf16 v[208:223], a[200:203], v[136:139], v[208:223]
  v_cvt_pk_bf16_f32 v244, v232, v233
  v_exp_f32 v235, v203
  v_exp_f32 v236, v204
  v_add_f32 v28, v28, v234
  v_mfma_f32_32x32x16_bf16 v[208:223], a[204:207], v[140:143], v[208:223]
  v_add_f32 v29, v29, v235
  v_cvt_pk_bf16_f32 v245, v234, v235
  v_exp_f32 v237, v205
  s_mov_b32 s60, 73728
  s_add_u32 m0, s62, 34816
  v_mfma_f32_32x32x16_bf16 v[208:223], a[208:211], v[144:147], v[208:223]
  buffer_load_dwordx4 v18, s[28:31], s60 offen offset:0 nt lds
  v_exp_f32 v238, v206
  v_add_f32 v28, v28, v236
  v_add_f32 v29, v29, v237
  v_mfma_f32_32x32x16_bf16 v[208:223], a[212:215], v[148:151], v[208:223]
  v_cvt_pk_bf16_f32 v246, v236, v237
  v_exp_f32 v239, v207
  v_add_f32 v28, v28, v238
  v_add_f32 v29, v29, v239
  v_cvt_pk_bf16_f32 v247, v238, v239
  v_mfma_f32_32x32x16_bf16 v[208:223], a[216:219], v[152:155], v[208:223]
  v_add_f32 v28, v28, v29
  v_cmp_nle_f32 vcc, v28, v31
  s_cbranch_vccnz L_tr18
L_bk18:
  v_add_f32 v25, v25, v28
  v_mfma_f32_32x32x16_bf16 v[208:223], a[220:223], v[156:159], v[208:223]
  s_waitcnt lgkmcnt(14)
  v_mfma_f32_32x32x16_bf16 a[0:15], a[224:227], v[240:243], a[0:15]
  s_waitcnt lgkmcnt(12)
  v_mfma_f32_32x32x16_bf16 a[16:31], a[228:231], v[240:243], a[16:31]
  v_exp_f32 v224, v208
  v_exp_f32 v225, v209
  s_add_u32 m0, s62, 34880
  s_waitcnt lgkmcnt(10)
  v_mfma_f32_32x32x16_bf16 a[32:47], a[232:235], v[240:243], a[32:47]
  buffer_load_dwordx4 v18, s[28:31], s60 offen offset:1024 nt lds
  v_exp_f32 v226, v210
  v_add_f32 v28, v224, v225
  v_cvt_pk_bf16_f32 v248, v224, v225
  s_waitcnt lgkmcnt(8)
  v_mfma_f32_32x32x16_bf16 a[48:63], a[236:239], v[240:243], a[48:63]
  v_exp_f32 v227, v211
  v_exp_f32 v228, v212
  v_add_f32 v29, v226, v227
  v_cvt_pk_bf16_f32 v249, v226, v227
  s_waitcnt lgkmcnt(6)
  v_mfma_f32_32x32x16_bf16 a[0:15], a[240:243], v[244:247], a[0:15]
  v_exp_f32 v229, v213
  v_exp_f32 v230, v214
  v_add_f32 v28, v28, v228
  v_add_f32 v29, v29, v229
  s_waitcnt lgkmcnt(4)
  v_mfma_f32_32x32x16_bf16 a[16:31], a[244:247], v[244:247], a[16:31]
  v_cvt_pk_bf16_f32 v250, v228, v229
  v_exp_f32 v231, v215
  v_exp_f32 v232, v216
  v_add_f32 v28, v28, v230
  s_waitcnt lgkmcnt(2)
  v_mfma_f32_32x32x16_bf16 a[32:47], a[248:251], v[244:247], a[32:47]
  v_add_f32 v29, v29, v231
  v_cvt_pk_bf16_f32 v251, v230, v231
  v_exp_f32 v233, v217
  v_exp_f32 v234, v218
  s_waitcnt lgkmcnt(0)
  v_mfma_f32_32x32x16_bf16 a[48:63], a[252:255], v[244:247], a[48:63]
  v_add_f32 v28, v28, v232
  v_add_f32 v29, v29, v233
  v_cvt_pk_bf16_f32 v252, v232, v233
  v_exp_f32 v235, v219
  s_waitcnt vmcnt(10)
  s_barrier
  v_mfma_f32_32x32x16_bf16 v[192:207], a[192:195], v[64:67], v[96:111]
  ds_read_b128 a[192:195], v19 offset:0
  v_exp_f32 v236, v220
  v_add_f32 v28, v28, v234
  v_add_f32 v29, v29, v235
  s_add_u32 m0, s62, 34944
  v_mfma_f32_32x32x16_bf16 v[192:207], a[196:199], v[68:71], v[192:207]
  buffer_load_dwordx4 v18, s[28:31], s60 offen offset:2048 nt lds
  ds_read_b128 a[196:199], v20 offset:0
  v_cvt_pk_bf16_f32 v253, v234, v235
  v_exp_f32 v237, v221
  v_mfma_f32_32x32x16_bf16 v[192:207], a[200:203], v[72:75], v[192:207]
  ds_read_b128 a[200:203], v19 offset:64
  v_exp_f32 v238, v222
  v_add_f32 v28, v28, v236
  v_add_f32 v29, v29, v237
  v_cvt_pk_bf16_f32 v254, v236, v237
  v_mfma_f32_32x32x16_bf16 v[192:207], a[204:207], v[76:79], v[192:207]
  ds_read_b128 a[204:207], v20 offset:64
  v_exp_f32 v239, v223
  v_add_f32 v28, v28, v238
  v_add_f32 v29, v29, v239
  v_cvt_pk_bf16_f32 v255, v238, v239
  v_mfma_f32_32x32x16_bf16 v[192:207], a[208:211], v[80:83], v[192:207]
  ds_read_b128 a[208:211], v19 offset:128
  v_add_f32 v28, v28, v29
  v_cmp_nle_f32 vcc, v28, v31
  s_cbranch_vccnz L_tr19
L_bk19:
  v_add_f32 v26, v26, v28
  v_mfma_f32_32x32x16_bf16 v[192:207], a[212:215], v[84:87], v[192:207]
  ds_read_b128 a[212:215], v20 offset:128
  v_mfma_f32_32x32x16_bf16 v[192:207], a[216:219], v[88:91], v[192:207]
  ds_read_b128 a[216:219], v19 offset:192
  v_mfma_f32_32x32x16_bf16 v[192:207], a[220:223], v[92:95], v[192:207]
  ds_read_b128 a[220:223], v20 offset:192
  s_add_u32 m0, s62, 35008
  v_mfma_f32_32x32x16_bf16 a[64:79], a[224:227], v[248:251], a[64:79]
  buffer_load_dwordx4 v18, s[28:31], s60 offen offset:3072 nt lds
  v_mfma_f32_32x32x16_bf16 a[80:95], a[228:231], v[248:251], a[80:95]
  v_exp_f32 v224, v192
  v_exp_f32 v225, v193
  v_exp_f32 v226, v194
  v_mfma_f32_32x32x16_bf16 a[96:111], a[232:235], v[248:251], a[96:111]
  v_add_f32 v28, v224, v225
  v_cvt_pk_bf16_f32 v240, v224, v225
  v_exp_f32 v227, v195
  v_exp_f32 v228, v196
  v_mfma_f32_32x32x16_bf16 a[112:127], a[236:239], v[248:251], a[112:127]
  v_add_f32 v29, v226, v227
  v_cvt_pk_bf16_f32 v241, v226, v227
  v_exp_f32 v229, v197
  v_exp_f32 v230, v198
  v_mfma_f32_32x32x16_bf16 a[64:79], a[240:243], v[252:255], a[64:79]
  v_add_f32 v28, v28, v228
  v_add_f32 v29, v29, v229
  v_cvt_pk_bf16_f32 v242, v228, v229
  v_exp_f32 v231, v199
  v_mfma_f32_32x32x16_bf16 a[80:95], a[244:247], v[252:255], a[80:95]
  v_exp_f32 v232, v200
  v_add_f32 v28, v28, v230
  v_add_f32 v29, v29, v231
  v_cvt_pk_bf16_f32 v243, v230, v231
  v_mfma_f32_32x32x16_bf16 a[96:111], a[248:251], v[252:255], a[96:111]
  v_exp_f32 v233, v201
  v_exp_f32 v234, v202
  s_mov_b32 s60, 77824
  s_add_u32 m0, s62, 39168
  v_mfma_f32_32x32x16_bf16 a[112:127], a[252:255], v[252:255], a[112:127]
  buffer_load_dwordx4 v18, s[28:31], s60 offen offset:0 nt lds
  v_add_f32 v28, v28, v232
  v_add_f32 v29, v29, v233
  v_cvt_pk_bf16_f32 v244, v232, v233
  s_waitcnt lgkmcnt(7)
  v_mfma_f32_32x32x16_bf16 v[208:223], a[192:195], v[32:35], v[160:175]
  v_exp_f32 v235, v203
  v_exp_f32 v236, v204
  v_add_f32 v28, v28, v234
  v_add_f32 v29, v29, v235
  s_waitcnt lgkmcnt(6)
  v_mfma_f32_32x32x16_bf16 v[208:223], a[196:199], v[36:39], v[208:223]
  v_cvt_pk_bf16_f32 v245, v234, v235
  v_exp_f32 v237, v205
  v_exp_f32 v238, v206
  v_add_f32 v28, v28, v236
  s_waitcnt lgkmcnt(5)
  v_mfma_f32_32x32x16_bf16 v[208:223], a[200:203], v[40:43], v[208:223]
  v_add_f32 v29, v29, v237
  v_cvt_pk_bf16_f32 v246, v236, v237
  v_exp_f32 v239, v207
  v_add_f32 v28, v28, v238
  v_add_f32 v29, v29, v239
  s_waitcnt lgkmcnt(4)
  v_mfma_f32_32x32x16_bf16 v[208:223], a[204:207], v[44:47], v[208:223]
  v_cvt_pk_bf16_f32 v247, v238, v239
  v_add_f32 v28, v28, v29
  v_cmp_nle_f32 vcc, v28, v31
  s_cbranch_vccnz L_tr20
L_bk20:
  v_add_f32 v27, v27, v28
  s_waitcnt lgkmcnt(3)
  v_mfma_f32_32x32x16_bf16 v[208:223], a[208:211], v[48:51], v[208:223]
  s_waitcnt lgkmcnt(2)
  v_mfma_f32_32x32x16_bf16 v[208:223], a[212:215], v[52:55], v[208:223]
  s_add_u32 m0, s62, 39232
  s_waitcnt lgkmcnt(1)
  v_mfma_f32_32x32x16_bf16 v[208:223], a[216:219], v[56:59], v[208:223]
  buffer_load_dwordx4 v18, s[28:31], s60 offen offset:1024 nt lds
  s_waitcnt lgkmcnt(0)
  v_mfma_f32_32x32x16_bf16 v[208:223], a[220:223], v[60:63], v[208:223]
  v_mfma_f32_32x32x16_bf16 a[128:143], a[224:227], v[240:243], a[128:143]
  ds_read_b64_tr_b16 a[224:225], v23 offset:0
  ds_read_b64_tr_b16 a[226:227], v23 offset:256
  v_mfma_f32_32x32x16_bf16 a[144:159], a[228:231], v[240:243], a[144:159]
  ds_read_b64_tr_b16 a[228:229], v23 offset:64
  ds_read_b64_tr_b16 a[230:231], v23 offset:320
  v_exp_f32 v224, v208
  v_exp_f32 v225, v209
  v_mfma_f32_32x32x16_bf16 a[160:175], a[232:235], v[240:243], a[160:175]
  ds_read_b64_tr_b16 a[232:233], v23 offset:128
  ds_read_b64_tr_b16 a[234:235], v23 offset:384
  v_exp_f32 v226, v210
  v_add_f32 v28, v224, v225
  v_cvt_pk_bf16_f32 v248, v224, v225
  v_mfma_f32_32x32x16_bf16 a[176:191], a[236:239], v[240:243], a[176:191]
  ds_read_b64_tr_b16 a[236:237], v23 offset:192
  ds_read_b64_tr_b16 a[238:239], v23 offset:448
  v_exp_f32 v227, v211
  v_exp_f32 v228, v212
  v_mfma_f32_32x32x16_bf16 a[128:143], a[240:243], v[244:247], a[128:143]
  ds_read_b64_tr_b16 a[240:241], v23 offset:4352
  ds_read_b64_tr_b16 a[242:243], v23 offset:4608
  v_add_f32 v29, v226, v227
  v_cvt_pk_bf16_f32 v249, v226, v227
  s_add_u32 m0, s62, 39296
  v_mfma_f32_32x32x16_bf16 a[144:159], a[244:247], v[244:247], a[144:159]
  buffer_load_dwordx4 v18, s[28:31], s60 offen offset:2048 nt lds
  ds_read_b64_tr_b16 a[244:245], v23 offset:4416
  ds_read_b64_tr_b16 a[246:247], v23 offset:4672
  v_exp_f32 v229, v213
  v_mfma_f32_32x32x16_bf16 a[160:175], a[248:251], v[244:247], a[160:175]
  ds_read_b64_tr_b16 a[248:249], v23 offset:4480
  ds_read_b64_tr_b16 a[250:251], v23 offset:4736
  v_exp_f32 v230, v214
  v_add_f32 v28, v28, v228
  v_add_f32 v29, v29, v229
  v_mfma_f32_32x32x16_bf16 a[176:191], a[252:255], v[244:247], a[176:191]
  ds_read_b64_tr_b16 a[252:253], v23 offset:4544
  ds_read_b64_tr_b16 a[254:255], v23 offset:4800
  v_cvt_pk_bf16_f32 v250, v228, v229
  v_exp_f32 v231, v215
  v_mfma_f32_32x32x16_bf16 v[192:207], a[192:195], v[128:131], v[176:191]
  v_exp_f32 v232, v216
  v_add_f32 v28, v28, v230
  v_add_f32 v29, v29, v231
  v_cvt_pk_bf16_f32 v251, v230, v231
  v_mfma_f32_32x32x16_bf16 v[192:207], a[196:199], v[132:135], v[192:207]
  v_exp_f32 v233, v217
  v_exp_f32 v234, v218
  v_add_f32 v28, v28, v232
  v_add_f32 v29, v29, v233
  v_mfma_f32_32x32x16_bf16 v[192:207], a[200:203], v[136:139], v[192:207]
  v_cvt_pk_bf16_f32 v252, v232, v233
  v_exp_f32 v235, v219
  v_exp_f32 v236, v220
  v_add_f32 v28, v28, v234
  v_mfma_f32_32x32x16_bf16 v[192:207], a[204:207], v[140:143], v[192:207]
  v_add_f32 v29, v29, v235
  v_cvt_pk_bf16_f32 v253, v234, v235
  v_exp_f32 v237, v221
  s_add_u32 m0, s62, 39360
  v_mfma_f32_32x32x16_bf16 v[192:207], a[208:211], v[144:147], v[192:207]
  buffer_load_dwordx4 v18, s[28:31], s60 offen offset:3072 nt lds
  v_exp_f32 v238, v222
  v_add_f32 v28, v28, v236
  v_add_f32 v29, v29, v237
  v_mfma_f32_32x32x16_bf16 v[192:207], a[212:215], v[148:151], v[192:207]
  v_cvt_pk_bf16_f32 v254, v236, v237
  v_exp_f32 v239, v223
  v_add_f32 v28, v28, v238
  v_add_f32 v29, v29, v239
  v_cvt_pk_bf16_f32 v255, v238, v239
  v_mfma_f32_32x32x16_bf16 v[192:207], a[216:219], v[152:155], v[192:207]
  v_add_f32 v28, v28, v29
  v_cmp_nle_f32 vcc, v28, v31
  s_cbranch_vccnz L_tr21
L_bk21:
  v_add_f32 v25, v25, v28
  v_mfma_f32_32x32x16_bf16 v[192:207], a[220:223], v[156:159], v[192:207]
  s_waitcnt lgkmcnt(14)
  v_mfma_f32_32x32x16_bf16 a[0:15], a[224:227], v[248:251], a[0:15]
  s_waitcnt lgkmcnt(12)
  v_mfma_f32_32x32x16_bf16 a[16:31], a[228:231], v[248:251], a[16:31]
  v_exp_f32 v224, v192
  v_exp_f32 v225, v193
  v_exp_f32 v226, v194
  s_waitcnt lgkmcnt(10)
  v_mfma_f32_32x32x16_bf16 a[32:47], a[232:235], v[248:251], a[32:47]
  v_add_f32 v28, v224, v225
  v_cvt_pk_bf16_f32 v240, v224, v225
  v_exp_f32 v227, v195
  s_mov_b32 s60, 81920
  s_add_u32 m0, s62, 69632
  s_waitcnt lgkmcnt(8)
  v_mfma_f32_32x32x16_bf16 a[48:63], a[236:239], v[248:251], a[48:63]
  buffer_load_dwordx4 v18, s[28:31], s60 offen offset:0 nt lds
  v_exp_f32 v228, v196
  v_add_f32 v29, v226, v227
  v_cvt_pk_bf16_f32 v241, v226, v227
  s_waitcnt lgkmcnt(6)
  v_mfma_f32_32x32x16_bf16 a[0:15], a[240:243], v[252:255], a[0:15]
  v_exp_f32 v229, v197
  v_exp_f32 v230, v198
  v_add_f32 v28, v28, v228
  v_add_f32 v29, v29, v229
  s_waitcnt lgkmcnt(4)
  v_mfma_f32_32x32x16_bf16 a[16:31], a[244:247], v[252:255], a[16:31]
  v_cvt_pk_bf16_f32 v242, v228, v229
  v_exp_f32 v231, v199
  v_exp_f32 v232, v200
  v_add_f32 v28, v28, v230
  s_waitcnt lgkmcnt(2)
  v_mfma_f32_32x32x16_bf16 a[32:47], a[248:251], v[252:255], a[32:47]
  v_add_f32 v29, v29, v231
  v_cvt_pk_bf16_f32 v243, v230, v231
  v_exp_f32 v233, v201
  v_exp_f32 v234, v202
  s_waitcnt lgkmcnt(0)
  v_mfma_f32_32x32x16_bf16 a[48:63], a[252:255], v[252:255], a[48:63]
  v_add_f32 v28, v28, v232
  v_add_f32 v29, v29, v233
  v_cvt_pk_bf16_f32 v244, v232, v233
  v_exp_f32 v235, v203
  s_waitcnt vmcnt(9)
  s_barrier
  v_mfma_f32_32x32x16_bf16 v[208:223], a[192:195], v[64:67], v[96:111]
  ds_read_b128 a[192:195], v21 offset:34816
  v_exp_f32 v236, v204
  v_add_f32 v28, v28, v234
  v_add_f32 v29, v29, v235
  v_cvt_pk_bf16_f32 v245, v234, v235
  v_mfma_f32_32x32x16_bf16 v[208:223], a[196:199], v[68:71], v[208:223]
  ds_read_b128 a[196:199], v22 offset:34816
  v_exp_f32 v237, v205
  v_exp_f32 v238, v206
  s_add_u32 m0, s62, 69696
  v_mfma_f32_32x32x16_bf16 v[208:223], a[200:203], v[72:75], v[208:223]
  buffer_load_dwordx4 v18, s[28:31], s60 offen offset:1024 nt lds
  ds_read_b128 a[200:203], v21 offset:34880
  v_add_f32 v28, v28, v236
  v_add_f32 v29, v29, v237
  v_cvt_pk_bf16_f32 v246, v236, v237
  v_mfma_f32_32x32x16_bf16 v[208:223], a[204:207], v[76:79], v[208:223]
  ds_read_b128 a[204:207], v22 offset:34880
  v_exp_f32 v239, v207
  v_add_f32 v28, v28, v238
  v_add_f32 v29, v29, v239
  v_cvt_pk_bf16_f32 v247, v238, v239
  v_mfma_f32_32x32x16_bf16 v[208:223], a[208:211], v[80:83], v[208:223]
  ds_read_b128 a[208:211], v21 offset:34944
  v_add_f32 v28, v28, v29
  v_cmp_nle_f32 vcc, v28, v31
  s_cbranch_vccnz L_tr22
L_bk22:
  v_add_f32 v26, v26, v28
  v_mfma_f32_32x32x16_bf16 v[208:223], a[212:215], v[84:87], v[208:223]
  ds_read_b128 a[212:215], v22 offset:34944
  v_mfma_f32_32x32x16_bf16 v[208:223], a[216:219], v[88:91], v[208:223]
  ds_read_b128 a[216:219], v21 offset:35008
  v_mfma_f32_32x32x16_bf16 v[208:223], a[220:223], v[92:95], v[208:223]
  ds_read_b128 a[220:223], v22 offset:35008
  v_mfma_f32_32x32x16_bf16 a[64:79], a[224:227], v[240:243], a[64:79]
  s_add_u32 m0, s62, 69760
  v_mfma_f32_32x32x16_bf16 a[80:95], a[228:231], v[240:243], a[80:95]
  buffer_load_dwordx4 v18, s[28:31], s60 offen offset:2048 nt lds
  v_exp_f32 v224, v208
  v_exp_f32 v225, v209
  v_mfma_f32_32x32x16_bf16 a[96:111], a[232:235], v[240:243], a[96:111]
  v_exp_f32 v226, v210
  v_add_f32 v28, v224, v225
  v_cvt_pk_bf16_f32 v248, v224, v225
  v_exp_f32 v227, v211
  v_mfma_f32_32x32x16_bf16 a[112:127], a[236:239], v[240:243], a[112:127]
  v_exp_f32 v228, v212
  v_add_f32 v29, v226, v227
  v_cvt_pk_bf16_f32 v249, v226, v227
  v_exp_f32 v229, v213
  v_mfma_f32_32x32x16_bf16 a[64:79], a[240:243], v[244:247], a[64:79]
  v_exp_f32 v230, v214
  v_add_f32 v28, v28, v228
  v_add_f32 v29, v29, v229
  v_cvt_pk_bf16_f32 v250, v228, v229
  v_mfma_f32_32x32x16_bf16 a[80:95], a[244:247], v[244:247], a[80:95]
  v_exp_f32 v231, v215
  v_exp_f32 v232, v216
  v_add_f32 v28, v28, v230
  v_add_f32 v29, v29, v231
  v_mfma_f32_32x32x16_bf16 a[96:111], a[248:251], v[244:247], a[96:111]
  v_cvt_pk_bf16_f32 v251, v230, v231
  v_exp_f32 v233, v217
  v_exp_f32 v234, v218
  s_add_u32 m0, s62, 69824
  v_mfma_f32_32x32x16_bf16 a[112:127], a[252:255], v[244:247], a[112:127]
  buffer_load_dwordx4 v18, s[28:31], s60 offen offset:3072 nt lds
  v_add_f32 v28, v28, v232
  v_add_f32 v29, v29, v233
  v_cvt_pk_bf16_f32 v252, v232, v233
  s_waitcnt lgkmcnt(7)
  v_mfma_f32_32x32x16_bf16 v[192:207], a[192:195], v[32:35], v[160:175]
  v_exp_f32 v235, v219
  v_exp_f32 v236, v220
  v_add_f32 v28, v28, v234
  v_add_f32 v29, v29, v235
  s_waitcnt lgkmcnt(6)
  v_mfma_f32_32x32x16_bf16 v[192:207], a[196:199], v[36:39], v[192:207]
  v_cvt_pk_bf16_f32 v253, v234, v235
  v_exp_f32 v237, v221
  v_exp_f32 v238, v222
  v_add_f32 v28, v28, v236
  s_waitcnt lgkmcnt(5)
  v_mfma_f32_32x32x16_bf16 v[192:207], a[200:203], v[40:43], v[192:207]
  v_add_f32 v29, v29, v237
  v_cvt_pk_bf16_f32 v254, v236, v237
  v_exp_f32 v239, v223
  v_add_f32 v28, v28, v238
  v_add_f32 v29, v29, v239
  s_waitcnt lgkmcnt(4)
  v_mfma_f32_32x32x16_bf16 v[192:207], a[204:207], v[44:47], v[192:207]
  v_cvt_pk_bf16_f32 v255, v238, v239
  v_add_f32 v28, v28, v29
  v_cmp_nle_f32 vcc, v28, v31
  s_cbranch_vccnz L_tr23
L_bk23:
  v_add_f32 v27, v27, v28
  s_waitcnt lgkmcnt(3)
  v_mfma_f32_32x32x16_bf16 v[192:207], a[208:211], v[48:51], v[192:207]
  s_waitcnt lgkmcnt(2)
  v_mfma_f32_32x32x16_bf16 v[192:207], a[212:215], v[52:55], v[192:207]
  s_mov_b32 s60, 86016
  s_add_u32 m0, s62, 73984
  s_waitcnt lgkmcnt(1)
  v_mfma_f32_32x32x16_bf16 v[192:207], a[216:219], v[56:59], v[192:207]
  buffer_load_dwordx4 v18, s[28:31], s60 offen offset:0 nt lds
  s_waitcnt lgkmcnt(0)
  v_mfma_f32_32x32x16_bf16 v[192:207], a[220:223], v[60:63], v[192:207]
  v_mfma_f32_32x32x16_bf16 a[128:143], a[224:227], v[248:251], a[128:143]
  ds_read_b64_tr_b16 a[224:225], v24 offset:34816
  ds_read_b64_tr_b16 a[226:227], v24 offset:35072
  v_mfma_f32_32x32x16_bf16 a[144:159], a[228:231], v[248:251], a[144:159]
  ds_read_b64_tr_b16 a[228:229], v24 offset:34880
  ds_read_b64_tr_b16 a[230:231], v24 offset:35136
  v_exp_f32 v224, v192
  v_exp_f32 v225, v193
  v_mfma_f32_32x32x16_bf16 a[160:175], a[232:235], v[248:251], a[160:175]
  ds_read_b64_tr_b16 a[232:233], v24 offset:34944
  ds_read_b64_tr_b16 a[234:235], v24 offset:35200
  v_exp_f32 v226, v194
  v_add_f32 v28, v224, v225
  v_cvt_pk_bf16_f32 v240, v224, v225
  v_mfma_f32_32x32x16_bf16 a[176:191], a[236:239], v[248:251], a[176:191]
  ds_read_b64_tr_b16 a[236:237], v24 offset:35008
  ds_read_b64_tr_b16 a[238:239], v24 offset:35264
  v_exp_f32 v227, v195
  v_exp_f32 v228, v196
  v_mfma_f32_32x32x16_bf16 a[128:143], a[240:243], v[252:255], a[128:143]
  ds_read_b64_tr_b16 a[240:241], v24 offset:39168
  ds_read_b64_tr_b16 a[242:243], v24 offset:39424
  v_add_f32 v29, v226, v227
  v_cvt_pk_bf16_f32 v241, v226, v227
  s_add_u32 m0, s62, 74048
  v_mfma_f32_32x32x16_bf16 a[144:159], a[244:247], v[252:255], a[144:159]
  buffer_load_dwordx4 v18, s[28:31], s60 offen offset:1024 nt lds
  ds_read_b64_tr_b16 a[244:245], v24 offset:39232
  ds_read_b64_tr_b16 a[246:247], v24 offset:39488
  v_exp_f32 v229, v197
  v_mfma_f32_32x32x16_bf16 a[160:175], a[248:251], v[252:255], a[160:175]
  ds_read_b64_tr_b16 a[248:249], v24 offset:39296
  ds_read_b64_tr_b16 a[250:251], v24 offset:39552
  v_exp_f32 v230, v198
  v_add_f32 v28, v28, v228
  v_add_f32 v29, v29, v229
  v_mfma_f32_32x32x16_bf16 a[176:191], a[252:255], v[252:255], a[176:191]
  ds_read_b64_tr_b16 a[252:253], v24 offset:39360
  ds_read_b64_tr_b16 a[254:255], v24 offset:39616
  v_cvt_pk_bf16_f32 v242, v228, v229
  v_exp_f32 v231, v199
  v_mfma_f32_32x32x16_bf16 v[208:223], a[192:195], v[128:131], v[176:191]
  v_exp_f32 v232, v200
  v_add_f32 v28, v28, v230
  v_add_f32 v29, v29, v231
  v_cvt_pk_bf16_f32 v243, v230, v231
  v_mfma_f32_32x32x16_bf16 v[208:223], a[196:199], v[132:135], v[208:223]
  v_exp_f32 v233, v201
  v_exp_f32 v234, v202
  v_add_f32 v28, v28, v232
  v_add_f32 v29, v29, v233
  v_mfma_f32_32x32x16_bf16 v[208:223], a[200:203], v[136:139], v[208:223]
  v_cvt_pk_bf16_f32 v244, v232, v233
  v_exp_f32 v235, v203
  v_exp_f32 v236, v204
  v_add_f32 v28, v28, v234
  v_mfma_f32_32x32x16_bf16 v[208:223], a[204:207], v[140:143], v[208:223]
  v_add_f32 v29, v29, v235
  v_cvt_pk_bf16_f32 v245, v234, v235
  v_exp_f32 v237, v205
  s_add_u32 m0, s62, 74112
  v_mfma_f32_32x32x16_bf16 v[208:223], a[208:211], v[144:147], v[208:223]
  buffer_load_dwordx4 v18, s[28:31], s60 offen offset:2048 nt lds
  v_exp_f32 v238, v206
  v_add_f32 v28, v28, v236
  v_add_f32 v29, v29, v237
  v_mfma_f32_32x32x16_bf16 v[208:223], a[212:215], v[148:151], v[208:223]
  v_cvt_pk_bf16_f32 v246, v236, v237
  v_exp_f32 v239, v207
  v_add_f32 v28, v28, v238
  v_add_f32 v29, v29, v239
  v_cvt_pk_bf16_f32 v247, v238, v239
  v_mfma_f32_32x32x16_bf16 v[208:223], a[216:219], v[152:155], v[208:223]
  v_add_f32 v28, v28, v29
  v_cmp_nle_f32 vcc, v28, v31
  s_cbranch_vccnz L_tr24
L_bk24:
  v_add_f32 v25, v25, v28
  v_mfma_f32_32x32x16_bf16 v[208:223], a[220:223], v[156:159], v[208:223]
  s_waitcnt lgkmcnt(14)
  v_mfma_f32_32x32x16_bf16 a[0:15], a[224:227], v[240:243], a[0:15]
  s_waitcnt lgkmcnt(12)
  v_mfma_f32_32x32x16_bf16 a[16:31], a[228:231], v[240:243], a[16:31]
  v_exp_f32 v224, v208
  v_exp_f32 v225, v209
  v_exp_f32 v226, v210
  s_waitcnt lgkmcnt(10)
  v_mfma_f32_32x32x16_bf16 a[32:47], a[232:235], v[240:243], a[32:47]
  v_add_f32 v28, v224, v225
  v_cvt_pk_bf16_f32 v248, v224, v225
  v_exp_f32 v227, v211
  s_add_u32 m0, s62, 74176
  s_waitcnt lgkmcnt(8)
  v_mfma_f32_32x32x16_bf16 a[48:63], a[236:239], v[240:243], a[48:63]
  buffer_load_dwordx4 v18, s[28:31], s60 offen offset:3072 nt lds
  v_exp_f32 v228, v212
  v_add_f32 v29, v226, v227
  v_cvt_pk_bf16_f32 v249, v226, v227
  s_waitcnt lgkmcnt(6)
  v_mfma_f32_32x32x16_bf16 a[0:15], a[240:243], v[244:247], a[0:15]
  v_exp_f32 v229, v213
  v_exp_f32 v230, v214
  v_add_f32 v28, v28, v228
  v_add_f32 v29, v29, v229
  s_waitcnt lgkmcnt(4)
  v_mfma_f32_32x32x16_bf16 a[16:31], a[244:247], v[244:247], a[16:31]
  v_cvt_pk_bf16_f32 v250, v228, v229
  v_exp_f32 v231, v215
  v_exp_f32 v232, v216
  v_add_f32 v28, v28, v230
  s_waitcnt lgkmcnt(2)
  v_mfma_f32_32x32x16_bf16 a[32:47], a[248:251], v[244:247], a[32:47]
  v_add_f32 v29, v29, v231
  v_cvt_pk_bf16_f32 v251, v230, v231
  v_exp_f32 v233, v217
  v_exp_f32 v234, v218
  s_waitcnt lgkmcnt(0)
  v_mfma_f32_32x32x16_bf16 a[48:63], a[252:255], v[244:247], a[48:63]
  v_add_f32 v28, v28, v232
  v_add_f32 v29, v29, v233
  v_cvt_pk_bf16_f32 v252, v232, v233
  v_exp_f32 v235, v219
  s_waitcnt vmcnt(8)
  s_barrier
  v_mfma_f32_32x32x16_bf16 v[192:207], a[192:195], v[64:67], v[96:111]
  ds_read_b128 a[192:195], v19 offset:34816
  v_exp_f32 v236, v220
  v_add_f32 v28, v28, v234
  v_add_f32 v29, v29, v235
  v_cvt_pk_bf16_f32 v253, v234, v235
  v_mfma_f32_32x32x16_bf16 v[192:207], a[196:199], v[68:71], v[192:207]
  ds_read_b128 a[196:199], v20 offset:34816
  v_exp_f32 v237, v221
  s_mov_b32 s60, 90112
  s_add_u32 m0, s62, 0
  v_mfma_f32_32x32x16_bf16 v[192:207], a[200:203], v[72:75], v[192:207]
  buffer_load_dwordx4 v18, s[28:31], s60 offen offset:0 nt lds
  ds_read_b128 a[200:203], v19 offset:34880
  v_exp_f32 v238, v222
  v_add_f32 v28, v28, v236
  v_mfma_f32_32x32x16_bf16 v[192:207], a[204:207], v[76:79], v[192:207]
  ds_read_b128 a[204:207], v20 offset:34880
  v_add_f32 v29, v29, v237
  v_cvt_pk_bf16_f32 v254, v236, v237
  v_exp_f32 v239, v223
  v_add_f32 v28, v28, v238
  v_mfma_f32_32x32x16_bf16 v[192:207], a[208:211], v[80:83], v[192:207]
  ds_read_b128 a[208:211], v19 offset:34944
  v_add_f32 v29, v29, v239
  v_cvt_pk_bf16_f32 v255, v238, v239
  v_add_f32 v28, v28, v29
  v_mfma_f32_32x32x16_bf16 v[192:207], a[212:215], v[84:87], v[192:207]
  ds_read_b128 a[212:215], v20 offset:34944
  v_cmp_nle_f32 vcc, v28, v31
  s_cbranch_vccnz L_tr25
L_bk25:
  v_add_f32 v26, v26, v28
  v_mfma_f32_32x32x16_bf16 v[192:207], a[216:219], v[88:91], v[192:207]
  ds_read_b128 a[216:219], v19 offset:35008
  v_mfma_f32_32x32x16_bf16 v[192:207], a[220:223], v[92:95], v[192:207]
  ds_read_b128 a[220:223], v20 offset:35008
  v_mfma_f32_32x32x16_bf16 a[64:79], a[224:227], v[248:251], a[64:79]
  s_add_u32 m0, s62, 64
  v_mfma_f32_32x32x16_bf16 a[80:95], a[228:231], v[248:251], a[80:95]
  buffer_load_dwordx4 v18, s[28:31], s60 offen offset:1024 nt lds
  v_exp_f32 v224, v192
  v_exp_f32 v225, v193
  v_mfma_f32_32x32x16_bf16 a[96:111], a[232:235], v[248:251], a[96:111]
  v_exp_f32 v226, v194
  v_add_f32 v28, v224, v225
  v_cvt_pk_bf16_f32 v240, v224, v225
  v_exp_f32 v227, v195
  v_mfma_f32_32x32x16_bf16 a[112:127], a[236:239], v[248:251], a[112:127]
  v_exp_f32 v228, v196
  v_add_f32 v29, v226, v227
  v_cvt_pk_bf16_f32 v241, v226, v227
  v_exp_f32 v229, v197
  v_mfma_f32_32x32x16_bf16 a[64:79], a[240:243], v[252:255], a[64:79]
  v_exp_f32 v230, v198
  v_add_f32 v28, v28, v228
  v_add_f32 v29, v29, v229
  v_cvt_pk_bf16_f32 v242, v228, v229
  v_mfma_f32_32x32x16_bf16 a[80:95], a[244:247], v[252:255], a[80:95]
  v_exp_f32 v231, v199
  v_exp_f32 v232, v200
  v_add_f32 v28, v28, v230
  v_add_f32 v29, v29, v231
  v_mfma_f32_32x32x16_bf16 a[96:111], a[248:251], v[252:255], a[96:111]
  v_cvt_pk_bf16_f32 v243, v230, v231
  v_exp_f32 v233, v201
  v_exp_f32 v234, v202
  v_add_f32 v28, v28, v232
  v_mfma_f32_32x32x16_bf16 a[112:127], a[252:255], v[252:255], a[112:127]
  v_add_f32 v29, v29, v233
  v_cvt_pk_bf16_f32 v244, v232, v233
  v_exp_f32 v235, v203
  s_add_u32 m0, s62, 128
  s_waitcnt lgkmcnt(7)
  v_mfma_f32_32x32x16_bf16 v[208:223], a[192:195], v[32:35], v[160:175]
  buffer_load_dwordx4 v18, s[28:31], s60 offen offset:2048 nt lds
  v_exp_f32 v236, v204
  v_add_f32 v28, v28, v234
  v_add_f32 v29, v29, v235
  s_waitcnt lgkmcnt(6)
  v_mfma_f32_32x32x16_bf16 v[208:223], a[196:199], v[36:39], v[208:223]
  v_cvt_pk_bf16_f32 v245, v234, v235
  v_exp_f32 v237, v205
  v_exp_f32 v238, v206
  v_add_f32 v28, v28, v236
  s_waitcnt lgkmcnt(5)
  v_mfma_f32_32x32x16_bf16 v[208:223], a[200:203], v[40:43], v[208:223]
  v_add_f32 v29, v29, v237
  v_cvt_pk_bf16_f32 v246, v236, v237
  v_exp_f32 v239, v207
  v_add_f32 v28, v28, v238
  v_add_f32 v29, v29, v239
  s_waitcnt lgkmcnt(4)
  v_mfma_f32_32x32x16_bf16 v[208:223], a[204:207], v[44:47], v[208:223]
  v_cvt_pk_bf16_f32 v247, v238, v239
  v_add_f32 v28, v28, v29
  v_cmp_nle_f32 vcc, v28, v31
  s_cbranch_vccnz L_tr26
L_bk26:
  v_add_f32 v27, v27, v28
  s_waitcnt lgkmcnt(3)
  v_mfma_f32_32x32x16_bf16 v[208:223], a[208:211], v[48:51], v[208:223]
  s_waitcnt lgkmcnt(2)
  v_mfma_f32_32x32x16_bf16 v[208:223], a[212:215], v[52:55], v[208:223]
  s_waitcnt lgkmcnt(1)
  v_mfma_f32_32x32x16_bf16 v[208:223], a[216:219], v[56:59], v[208:223]
  s_add_u32 m0, s62, 192
  s_waitcnt lgkmcnt(0)
  v_mfma_f32_32x32x16_bf16 v[208:223], a[220:223], v[60:63], v[208:223]
  buffer_load_dwordx4 v18, s[28:31], s60 offen offset:3072 nt lds
  v_mfma_f32_32x32x16_bf16 a[128:143], a[224:227], v[240:243], a[128:143]
  ds_read_b64_tr_b16 a[224:225], v23 offset:34816
  ds_read_b64_tr_b16 a[226:227], v23 offset:35072
  v_mfma_f32_32x32x16_bf16 a[144:159], a[228:231], v[240:243], a[144:159]
  ds_read_b64_tr_b16 a[228:229], v23 offset:34880
  ds_read_b64_tr_b16 a[230:231], v23 offset:35136
  v_exp_f32 v224, v208
  v_exp_f32 v225, v209
  v_mfma_f32_32x32x16_bf16 a[160:175], a[232:235], v[240:243], a[160:175]
  ds_read_b64_tr_b16 a[232:233], v23 offset:34944
  ds_read_b64_tr_b16 a[234:235], v23 offset:35200
  v_exp_f32 v226, v210
  v_add_f32 v28, v224, v225
  v_cvt_pk_bf16_f32 v248, v224, v225
  v_mfma_f32_32x32x16_bf16 a[176:191], a[236:239], v[240:243], a[176:191]
  ds_read_b64_tr_b16 a[236:237], v23 offset:35008
  ds_read_b64_tr_b16 a[238:239], v23 offset:35264
  v_exp_f32 v227, v211
  v_exp_f32 v228, v212
  v_mfma_f32_32x32x16_bf16 a[128:143], a[240:243], v[244:247], a[128:143]
  ds_read_b64_tr_b16 a[240:241], v23 offset:39168
  ds_read_b64_tr_b16 a[242:243], v23 offset:39424
  v_add_f32 v29, v226, v227
  v_cvt_pk_bf16_f32 v249, v226, v227
  v_exp_f32 v229, v213
  v_mfma_f32_32x32x16_bf16 a[144:159], a[244:247], v[244:247], a[144:159]
  ds_read_b64_tr_b16 a[244:245], v23 offset:39232
  ds_read_b64_tr_b16 a[246:247], v23 offset:39488
  v_exp_f32 v230, v214
  s_mov_b32 s60, 94208
  s_add_u32 m0, s62, 4352
  v_mfma_f32_32x32x16_bf16 a[160:175], a[248:251], v[244:247], a[160:175]
  buffer_load_dwordx4 v18, s[28:31], s60 offen offset:0 nt lds
  ds_read_b64_tr_b16 a[248:249], v23 offset:39296
  ds_read_b64_tr_b16 a[250:251], v23 offset:39552
  v_add_f32 v28, v28, v228
  v_add_f32 v29, v29, v229
  v_mfma_f32_32x32x16_bf16 a[176:191], a[252:255], v[244:247], a[176:191]
  ds_read_b64_tr_b16 a[252:253], v23 offset:39360
  ds_read_b64_tr_b16 a[254:255], v23 offset:39616
  v_cvt_pk_bf16_f32 v250, v228, v229
  v_exp_f32 v231, v215
  v_mfma_f32_32x32x16_bf16 v[192:207], a[192:195], v[128:131], v[176:191]
  v_exp_f32 v232, v216
  v_add_f32 v28, v28, v230
  v_add_f32 v29, v29, v231
  v_cvt_pk_bf16_f32 v251, v230, v231
  v_mfma_f32_32x32x16_bf16 v[192:207], a[196:199], v[132:135], v[192:207]
  v_exp_f32 v233, v217
  v_exp_f32 v234, v218
  v_add_f32 v28, v28, v232
  v_add_f32 v29, v29, v233
  v_mfma_f32_32x32x16_bf16 v[192:207], a[200:203], v[136:139], v[192:207]
  v_cvt_pk_bf16_f32 v252, v232, v233
  v_exp_f32 v235, v219
  v_exp_f32 v236, v220
  v_add_f32 v28, v28, v234
  v_mfma_f32_32x32x16_bf16 v[192:207], a[204:207], v[140:143], v[192:207]
  v_add_f32 v29, v29, v235
  v_cvt_pk_bf16_f32 v253, v234, v235
  v_exp_f32 v237, v221
  s_add_u32 m0, s62, 4416
  v_mfma_f32_32x32x16_bf16 v[192:207], a[208:211], v[144:147], v[192:207]
  buffer_load_dwordx4 v18, s[28:31], s60 offen offset:1024 nt lds
  v_exp_f32 v238, v222
  v_add_f32 v28, v28, v236
  v_add_f32 v29, v29, v237
  v_mfma_f32_32x32x16_bf16 v[192:207], a[212:215], v[148:151], v[192:207]
  v_cvt_pk_bf16_f32 v254, v236, v237
  v_exp_f32 v239, v223
  v_add_f32 v28, v28, v238
  v_add_f32 v29, v29, v239
  v_cvt_pk_bf16_f32 v255, v238, v239
  v_mfma_f32_32x32x16_bf16 v[192:207], a[216:219], v[152:155], v[192:207]
  v_add_f32 v28, v28, v29
  v_cmp_nle_f32 vcc, v28, v31
  s_cbranch_vccnz L_tr27
L_bk27:
  v_add_f32 v25, v25, v28
  v_mfma_f32_32x32x16_bf16 v[192:207], a[220:223], v[156:159], v[192:207]
  s_waitcnt lgkmcnt(14)
  v_mfma_f32_32x32x16_bf16 a[0:15], a[224:227], v[248:251], a[0:15]
  s_waitcnt lgkmcnt(12)
  v_mfma_f32_32x32x16_bf16 a[16:31], a[228:231], v[248:251], a[16:31]
  v_exp_f32 v224, v192
  v_exp_f32 v225, v193
  v_exp_f32 v226, v194
  s_waitcnt lgkmcnt(10)
  v_mfma_f32_32x32x16_bf16 a[32:47], a[232:235], v[248:251], a[32:47]
  v_add_f32 v28, v224, v225
  v_cvt_pk_bf16_f32 v240, v224, v225
  v_exp_f32 v227, v195
  s_add_u32 m0, s62, 4480
  s_waitcnt lgkmcnt(8)
  v_mfma_f32_32x32x16_bf16 a[48:63], a[236:239], v[248:251], a[48:63]
  buffer_load_dwordx4 v18, s[28:31], s60 offen offset:2048 nt lds
  v_exp_f32 v228, v196
  v_add_f32 v29, v226, v227
  v_cvt_pk_bf16_f32 v241, v226, v227
  s_waitcnt lgkmcnt(6)
  v_mfma_f32_32x32x16_bf16 a[0:15], a[240:243], v[252:255], a[0:15]
  v_exp_f32 v229, v197
  v_exp_f32 v230, v198
  v_add_f32 v28, v28, v228
  v_add_f32 v29, v29, v229
  s_waitcnt lgkmcnt(4)
  v_mfma_f32_32x32x16_bf16 a[16:31], a[244:247], v[252:255], a[16:31]
  v_cvt_pk_bf16_f32 v242, v228, v229
  v_exp_f32 v231, v199
  v_exp_f32 v232, v200
  v_add_f32 v28, v28, v230
  s_waitcnt lgkmcnt(2)
  v_mfma_f32_32x32x16_bf16 a[32:47], a[248:251], v[252:255], a[32:47]
  v_add_f32 v29, v29, v231
  v_cvt_pk_bf16_f32 v243, v230, v231
  v_exp_f32 v233, v201
  v_exp_f32 v234, v202
  s_waitcnt lgkmcnt(0)
  v_mfma_f32_32x32x16_bf16 a[48:63], a[252:255], v[252:255], a[48:63]
  v_add_f32 v28, v28, v232
  v_add_f32 v29, v29, v233
  v_cvt_pk_bf16_f32 v244, v232, v233
  v_exp_f32 v235, v203
  s_waitcnt vmcnt(7)
  s_barrier
  v_mfma_f32_32x32x16_bf16 v[208:223], a[192:195], v[64:67], v[96:111]
  ds_read_b128 a[192:195], v21 offset:0
  v_exp_f32 v236, v204
  v_add_f32 v28, v28, v234
  v_add_f32 v29, v29, v235
  v_cvt_pk_bf16_f32 v245, v234, v235
  v_mfma_f32_32x32x16_bf16 v[208:223], a[196:199], v[68:71], v[208:223]
  ds_read_b128 a[196:199], v22 offset:0
  v_exp_f32 v237, v205
  v_exp_f32 v238, v206
  s_add_u32 m0, s62, 4544
  v_mfma_f32_32x32x16_bf16 v[208:223], a[200:203], v[72:75], v[208:223]
  buffer_load_dwordx4 v18, s[28:31], s60 offen offset:3072 nt lds
  ds_read_b128 a[200:203], v21 offset:64
  v_add_f32 v28, v28, v236
  v_add_f32 v29, v29, v237
  v_cvt_pk_bf16_f32 v246, v236, v237
  v_mfma_f32_32x32x16_bf16 v[208:223], a[204:207], v[76:79], v[208:223]
  ds_read_b128 a[204:207], v22 offset:64
  v_exp_f32 v239, v207
  v_add_f32 v28, v28, v238
  v_add_f32 v29, v29, v239
  v_cvt_pk_bf16_f32 v247, v238, v239
  v_mfma_f32_32x32x16_bf16 v[208:223], a[208:211], v[80:83], v[208:223]
  ds_read_b128 a[208:211], v21 offset:128
  v_add_f32 v28, v28, v29
  v_cmp_nle_f32 vcc, v28, v31
  s_cbranch_vccnz L_tr28
L_bk28:
  v_add_f32 v26, v26, v28
  v_mfma_f32_32x32x16_bf16 v[208:223], a[212:215], v[84:87], v[208:223]
  ds_read_b128 a[212:215], v22 offset:128
  v_mfma_f32_32x32x16_bf16 v[208:223], a[216:219], v[88:91], v[208:223]
  ds_read_b128 a[216:219], v21 offset:192
  v_mfma_f32_32x32x16_bf16 v[208:223], a[220:223], v[92:95], v[208:223]
  ds_read_b128 a[220:223], v22 offset:192
  v_mfma_f32_32x32x16_bf16 a[64:79], a[224:227], v[240:243], a[64:79]
  s_mov_b32 s60, 98304
  s_add_u32 m0, s62, 104448
  v_mfma_f32_32x32x16_bf16 a[80:95], a[228:231], v[240:243], a[80:95]
  buffer_load_dwordx4 v18, s[28:31], s60 offen offset:0 nt lds
  v_exp_f32 v224, v208
  v_mov_b32 v12, s3
  v_lshlrev_b32 v12, 4, v12
  v_mfma_f32_32x32x16_bf16 a[96:111], a[232:235], v[240:243], a[96:111]
  buffer_load_dwordx4 v[8:11], v12, s[48:51], 0 offen sc1
  v_exp_f32 v225, v209
  v_exp_f32 v226, v210
  v_mfma_f32_32x32x16_bf16 a[112:127], a[236:239], v[240:243], a[112:127]
  v_add_f32 v28, v224, v225
  v_cvt_pk_bf16_f32 v248, v224, v225
  v_exp_f32 v227, v211
  v_exp_f32 v228, v212
  v_mfma_f32_32x32x16_bf16 a[64:79], a[240:243], v[244:247], a[64:79]
  v_add_f32 v29, v226, v227
  v_cvt_pk_bf16_f32 v249, v226, v227
  v_exp_f32 v229, v213
  v_exp_f32 v230, v214
  v_mfma_f32_32x32x16_bf16 a[80:95], a[244:247], v[244:247], a[80:95]
  v_add_f32 v28, v28, v228
  v_add_f32 v29, v29, v229
  v_cvt_pk_bf16_f32 v250, v228, v229
  v_exp_f32 v231, v215
  v_mfma_f32_32x32x16_bf16 a[96:111], a[248:251], v[244:247], a[96:111]
  v_exp_f32 v232, v216
  v_add_f32 v28, v28, v230
  v_add_f32 v29, v29, v231
  v_cvt_pk_bf16_f32 v251, v230, v231
  v_mfma_f32_32x32x16_bf16 a[112:127], a[252:255], v[244:247], a[112:127]
  v_exp_f32 v233, v217
  v_exp_f32 v234, v218
  v_add_f32 v28, v28, v232
  s_add_u32 m0, s62, 104512
  s_waitcnt lgkmcnt(7)
  v_mfma_f32_32x32x16_bf16 v[192:207], a[192:195], v[32:35], v[160:175]
  buffer_load_dwordx4 v18, s[28:31], s60 offen offset:1024 nt lds
  v_add_f32 v29, v29, v233
  v_cvt_pk_bf16_f32 v252, v232, v233
  v_exp_f32 v235, v219
  s_waitcnt lgkmcnt(6)
  v_mfma_f32_32x32x16_bf16 v[192:207], a[196:199], v[36:39], v[192:207]
  v_exp_f32 v236, v220
  v_add_f32 v28, v28, v234
  v_add_f32 v29, v29, v235
  v_cvt_pk_bf16_f32 v253, v234, v235
  s_waitcnt lgkmcnt(5)
  v_mfma_f32_32x32x16_bf16 v[192:207], a[200:203], v[40:43], v[192:207]
  v_exp_f32 v237, v221
  v_exp_f32 v238, v222
  v_add_f32 v28, v28, v236
  v_add_f32 v29, v29, v237
  s_waitcnt lgkmcnt(4)
  v_mfma_f32_32x32x16_bf16 v[192:207], a[204:207], v[44:47], v[192:207]
  v_cvt_pk_bf16_f32 v254, v236, v237
  v_exp_f32 v239, v223
  v_add_f32 v28, v28, v238
  v_add_f32 v29, v29, v239
  v_cvt_pk_bf16_f32 v255, v238, v239
  s_waitcnt lgkmcnt(3)
  v_mfma_f32_32x32x16_bf16 v[192:207], a[208:211], v[48:51], v[192:207]
  v_add_f32 v28, v28, v29
  v_cmp_nle_f32 vcc, v28, v31
  s_cbranch_vccnz L_tr29
L_bk29:
  v_add_f32 v27, v27, v28
  s_waitcnt lgkmcnt(2)
  v_mfma_f32_32x32x16_bf16 v[192:207], a[212:215], v[52:55], v[192:207]
  s_waitcnt lgkmcnt(1)
  v_mfma_f32_32x32x16_bf16 v[192:207], a[216:219], v[56:59], v[192:207]
  s_add_u32 m0, s62, 104576
  s_waitcnt lgkmcnt(0)
  v_mfma_f32_32x32x16_bf16 v[192:207], a[220:223], v[60:63], v[192:207]
  buffer_load_dwordx4 v18, s[28:31], s60 offen offset:2048 nt lds
  v_mfma_f32_32x32x16_bf16 a[128:143], a[224:227], v[248:251], a[128:143]
  ds_read_b64_tr_b16 a[224:225], v24 offset:0
  ds_read_b64_tr_b16 a[226:227], v24 offset:256
  v_mfma_f32_32x32x16_bf16 a[144:159], a[228:231], v[248:251], a[144:159]
  ds_read_b64_tr_b16 a[228:229], v24 offset:64
  ds_read_b64_tr_b16 a[230:231], v24 offset:320
  v_exp_f32 v224, v192
  v_exp_f32 v225, v193
  v_mfma_f32_32x32x16_bf16 a[160:175], a[232:235], v[248:251], a[160:175]
  ds_read_b64_tr_b16 a[232:233], v24 offset:128
  ds_read_b64_tr_b16 a[234:235], v24 offset:384
  v_exp_f32 v226, v194
  v_add_f32 v28, v224, v225
  v_cvt_pk_bf16_f32 v240, v224, v225
  v_mfma_f32_32x32x16_bf16 a[176:191], a[236:239], v[248:251], a[176:191]
  ds_read_b64_tr_b16 a[236:237], v24 offset:192
  ds_read_b64_tr_b16 a[238:239], v24 offset:448
  v_exp_f32 v227, v195
  v_exp_f32 v228, v196
  v_mfma_f32_32x32x16_bf16 a[128:143], a[240:243], v[252:255], a[128:143]
  ds_read_b64_tr_b16 a[240:241], v24 offset:4352
  ds_read_b64_tr_b16 a[242:243], v24 offset:4608
  v_add_f32 v29, v226, v227
  v_cvt_pk_bf16_f32 v241, v226, v227
  v_exp_f32 v229, v197
  v_mfma_f32_32x32x16_bf16 a[144:159], a[244:247], v[252:255], a[144:159]
  ds_read_b64_tr_b16 a[244:245], v24 offset:4416
  ds_read_b64_tr_b16 a[246:247], v24 offset:4672
  v_exp_f32 v230, v198
  v_add_f32 v28, v28, v228
  s_add_u32 m0, s62, 104640
  v_mfma_f32_32x32x16_bf16 a[160:175], a[248:251], v[252:255], a[160:175]
  buffer_load_dwordx4 v18, s[28:31], s60 offen offset:3072 nt lds
  ds_read_b64_tr_b16 a[248:249], v24 offset:4480
  ds_read_b64_tr_b16 a[250:251], v24 offset:4736
  v_add_f32 v29, v29, v229
  v_cvt_pk_bf16_f32 v242, v228, v229
  v_mfma_f32_32x32x16_bf16 a[176:191], a[252:255], v[252:255], a[176:191]
  ds_read_b64_tr_b16 a[252:253], v24 offset:4544
  ds_read_b64_tr_b16 a[254:255], v24 offset:4800
  v_exp_f32 v231, v199
  v_exp_f32 v232, v200
  v_mfma_f32_32x32x16_bf16 v[208:223], a[192:195], v[128:131], v[176:191]
  v_add_f32 v28, v28, v230
  v_add_f32 v29, v29, v231
  v_cvt_pk_bf16_f32 v243, v230, v231
  v_exp_f32 v233, v201
  v_mfma_f32_32x32x16_bf16 v[208:223], a[196:199], v[132:135], v[208:223]
  v_exp_f32 v234, v202
  v_add_f32 v28, v28, v232
  v_add_f32 v29, v29, v233
  v_cvt_pk_bf16_f32 v244, v232, v233
  v_mfma_f32_32x32x16_bf16 v[208:223], a[200:203], v[136:139], v[208:223]
  v_exp_f32 v235, v203
  v_exp_f32 v236, v204
  v_add_f32 v28, v28, v234
  v_add_f32 v29, v29, v235
  v_mfma_f32_32x32x16_bf16 v[208:223], a[204:207], v[140:143], v[208:223]
  v_cvt_pk_bf16_f32 v245, v234, v235
  v_exp_f32 v237, v205
  v_exp_f32 v238, v206
  v_add_f32 v28, v28, v236
  v_mfma_f32_32x32x16_bf16 v[208:223], a[208:211], v[144:147], v[208:223]
  v_add_f32 v29, v29, v237
  v_cvt_pk_bf16_f32 v246, v236, v237
  v_exp_f32 v239, v207
  s_mov_b32 s60, 102400
  s_add_u32 m0, s62, 108800
  v_mfma_f32_32x32x16_bf16 v[208:223], a[212:215], v[148:151], v[208:223]
  buffer_load_dwordx4 v18, s[28:31], s60 offen offset:0 nt lds
  v_add_f32 v28, v28, v238
  v_add_f32 v29, v29, v239
  v_cvt_pk_bf16_f32 v247, v238, v239
  v_add_f32 v28, v28, v29
  v_mfma_f32_32x32x16_bf16 v[208:223], a[216:219], v[152:155], v[208:223]
  v_cmp_nle_f32 vcc, v28, v31
  s_cbranch_vccnz L_tr30
L_bk30:
  v_add_f32 v25, v25, v28
  v_mfma_f32_32x32x16_bf16 v[208:223], a[220:223], v[156:159], v[208:223]
  s_waitcnt lgkmcnt(14)
  v_mfma_f32_32x32x16_bf16 a[0:15], a[224:227], v[240:243], a[0:15]
  s_waitcnt lgkmcnt(12)
  v_mfma_f32_32x32x16_bf16 a[16:31], a[228:231], v[240:243], a[16:31]
  v_exp_f32 v224, v208
  v_exp_f32 v225, v209
  v_exp_f32 v226, v210
  s_waitcnt lgkmcnt(10)
  v_mfma_f32_32x32x16_bf16 a[32:47], a[232:235], v[240:243], a[32:47]
  v_add_f32 v28, v224, v225
  v_cvt_pk_bf16_f32 v248, v224, v225
  v_exp_f32 v227, v211
  v_exp_f32 v228, v212
  s_waitcnt lgkmcnt(8)
  v_mfma_f32_32x32x16_bf16 a[48:63], a[236:239], v[240:243], a[48:63]
  v_add_f32 v29, v226, v227
  v_cvt_pk_bf16_f32 v249, v226, v227
  v_exp_f32 v229, v213
  s_add_u32 m0, s62, 108864
  s_waitcnt lgkmcnt(6)
  v_mfma_f32_32x32x16_bf16 a[0:15], a[240:243], v[244:247], a[0:15]
  buffer_load_dwordx4 v18, s[28:31], s60 offen offset:1024 nt lds
  v_exp_f32 v230, v214
  v_add_f32 v28, v28, v228
  v_add_f32 v29, v29, v229
  s_waitcnt lgkmcnt(4)
  v_mfma_f32_32x32x16_bf16 a[16:31], a[244:247], v[244:247], a[16:31]
  v_cvt_pk_bf16_f32 v250, v228, v229
  v_exp_f32 v231, v215
  v_exp_f32 v232, v216
  v_add_f32 v28, v28, v230
  s_waitcnt lgkmcnt(2)
  v_mfma_f32_32x32x16_bf16 a[32:47], a[248:251], v[244:247], a[32:47]
  v_add_f32 v29, v29, v231
  v_cvt_pk_bf16_f32 v251, v230, v231
  v_exp_f32 v233, v217
  v_exp_f32 v234, v218
  s_waitcnt lgkmcnt(0)
  v_mfma_f32_32x32x16_bf16 a[48:63], a[252:255], v[244:247], a[48:63]
  v_add_f32 v28, v28, v232
  v_add_f32 v29, v29, v233
  v_cvt_pk_bf16_f32 v252, v232, v233
  s_add_u32 s58, s4, 0
  s_add_u32 m0, s63, 139264
  s_waitcnt vmcnt(7)
  s_barrier
  v_mfma_f32_32x32x16_bf16 v[192:207], a[192:195], v[64:67], v[96:111]
  buffer_load_dwordx4 v3, s[36:39], s58 offen  lds
  ds_read_b128 a[192:195], v19 offset:0
  v_exp_f32 v235, v219
  v_mfma_f32_32x32x16_bf16 v[192:207], a[196:199], v[68:71], v[192:207]
  ds_read_b128 a[196:199], v20 offset:0
  v_exp_f32 v236, v220
  v_add_f32 v28, v28, v234
  v_add_f32 v29, v29, v235
  v_cvt_pk_bf16_f32 v253, v234, v235
  v_mfma_f32_32x32x16_bf16 v[192:207], a[200:203], v[72:75], v[192:207]
  ds_read_b128 a[200:203], v19 offset:64
  v_exp_f32 v237, v221
  v_exp_f32 v238, v222
  s_add_u32 m0, s62, 108928
  v_mfma_f32_32x32x16_bf16 v[192:207], a[204:207], v[76:79], v[192:207]
  buffer_load_dwordx4 v18, s[28:31], s60 offen offset:2048 nt lds
  ds_read_b128 a[204:207], v20 offset:64
  v_add_f32 v28, v28, v236
  s_add_u32 s58, s5, 0
  s_add_u32 m0, s63, 143360
  v_mfma_f32_32x32x16_bf16 v[192:207], a[208:211], v[80:83], v[192:207]
  buffer_load_dwordx4 v3, s[36:39], s58 offen  lds
  ds_read_b128 a[208:211], v19 offset:128
  v_add_f32 v29, v29, v237
  v_cvt_pk_bf16_f32 v254, v236, v237
  v_mfma_f32_32x32x16_bf16 v[192:207], a[212:215], v[84:87], v[192:207]
  ds_read_b128 a[212:215], v20 offset:128
  v_exp_f32 v239, v223
  v_add_f32 v28, v28, v238
  v_add_f32 v29, v29, v239
  v_cvt_pk_bf16_f32 v255, v238, v239
  v_mfma_f32_32x32x16_bf16 v[192:207], a[216:219], v[88:91], v[192:207]
  ds_read_b128 a[216:219], v19 offset:192
  v_add_f32 v28, v28, v29
  s_add_u32 s58, s4, 16384
  s_add_u32 m0, s63, 147456
  v_mfma_f32_32x32x16_bf16 v[192:207], a[220:223], v[92:95], v[192:207]
  buffer_load_dwordx4 v3, s[36:39], s58 offen  lds
  ds_read_b128 a[220:223], v20 offset:192
  v_cmp_nle_f32 vcc, v28, v31
  s_cbranch_vccnz L_tr31
L_bk31:
  v_add_f32 v26, v26, v28
  v_mfma_f32_32x32x16_bf16 a[64:79], a[224:227], v[248:251], a[64:79]
  s_add_u32 m0, s62, 108992
  v_mfma_f32_32x32x16_bf16 a[80:95], a[228:231], v[248:251], a[80:95]
  buffer_load_dwordx4 v18, s[28:31], s60 offen offset:3072 nt lds
  v_exp_f32 v224, v192
  s_add_u32 s58, s5, 16384
  s_add_u32 m0, s63, 151552
  v_mfma_f32_32x32x16_bf16 a[96:111], a[232:235], v[248:251], a[96:111]
  buffer_load_dwordx4 v3, s[36:39], s58 offen  lds
  v_exp_f32 v225, v193
  v_exp_f32 v226, v194
  v_mfma_f32_32x32x16_bf16 a[112:127], a[236:239], v[248:251], a[112:127]
  v_add_f32 v28, v224, v225
  v_cvt_pk_bf16_f32 v240, v224, v225
  v_exp_f32 v227, v195
  v_exp_f32 v228, v196
  v_mfma_f32_32x32x16_bf16 a[64:79], a[240:243], v[252:255], a[64:79]
  v_add_f32 v29, v226, v227
  v_cvt_pk_bf16_f32 v241, v226, v227
  v_exp_f32 v229, v197
  s_add_u32 s58, s4, 32768
  s_add_u32 m0, s63, 155648
  v_mfma_f32_32x32x16_bf16 a[80:95], a[244:247], v[252:255], a[80:95]
  buffer_load_dwordx4 v3, s[36:39], s58 offen  lds
  v_exp_f32 v230, v198
  v_add_f32 v28, v28, v228
  v_add_f32 v29, v29, v229
  v_mfma_f32_32x32x16_bf16 a[96:111], a[248:251], v[252:255], a[96:111]
  v_cvt_pk_bf16_f32 v242, v228, v229
  v_exp_f32 v231, v199
  v_exp_f32 v232, v200
  v_add_f32 v28, v28, v230
  v_mfma_f32_32x32x16_bf16 a[112:127], a[252:255], v[252:255], a[112:127]
  v_add_f32 v29, v29, v231
  v_cvt_pk_bf16_f32 v243, v230, v231
  v_exp_f32 v233, v201
  s_mov_b32 s60, 106496
  s_add_u32 m0, s62, 34816
  s_waitcnt lgkmcnt(7)
  v_mfma_f32_32x32x16_bf16 v[208:223], a[192:195], v[32:35], v[160:175]
  buffer_load_dwordx4 v18, s[28:31], s60 offen offset:0 nt lds
  v_exp_f32 v234, v202
  s_add_u32 s58, s5, 32768
  s_add_u32 m0, s63, 159744
  s_waitcnt lgkmcnt(6)
  v_mfma_f32_32x32x16_bf16 v[208:223], a[196:199], v[36:39], v[208:223]
  buffer_load_dwordx4 v3, s[36:39], s58 offen  lds
  v_add_f32 v28, v28, v232
  v_add_f32 v29, v29, v233
  v_cvt_pk_bf16_f32 v244, v232, v233
  s_waitcnt lgkmcnt(5)
  v_mfma_f32_32x32x16_bf16 v[208:223], a[200:203], v[40:43], v[208:223]
  v_exp_f32 v235, v203
  v_exp_f32 v236, v204
  v_add_f32 v28, v28, v234
  v_add_f32 v29, v29, v235
  s_waitcnt lgkmcnt(4)
  v_mfma_f32_32x32x16_bf16 v[208:223], a[204:207], v[44:47], v[208:223]
  v_cvt_pk_bf16_f32 v245, v234, v235
  v_exp_f32 v237, v205
  v_exp_f32 v238, v206
  v_add_f32 v28, v28, v236
  s_waitcnt lgkmcnt(3)
  v_mfma_f32_32x32x16_bf16 v[208:223], a[208:211], v[48:51], v[208:223]
  v_add_f32 v29, v29, v237
  v_cvt_pk_bf16_f32 v246, v236, v237
  v_exp_f32 v239, v207
  v_add_f32 v28, v28, v238
  v_add_f32 v29, v29, v239
  s_waitcnt lgkmcnt(2)
  v_mfma_f32_32x32x16_bf16 v[208:223], a[212:215], v[52:55], v[208:223]
  v_cvt_pk_bf16_f32 v247, v238, v239
  v_add_f32 v28, v28, v29
  v_cmp_nle_f32 vcc, v28, v31
  s_cbranch_vccnz L_tr32
L_bk32:
  v_add_f32 v27, v27, v28
  s_waitcnt lgkmcnt(1)
  v_mfma_f32_32x32x16_bf16 v[208:223], a[216:219], v[56:59], v[208:223]
  s_add_u32 m0, s62, 34880
  s_waitcnt lgkmcnt(0)
  v_mfma_f32_32x32x16_bf16 v[208:223], a[220:223], v[60:63], v[208:223]
  buffer_load_dwordx4 v18, s[28:31], s60 offen offset:1024 nt lds
  v_mfma_f32_32x32x16_bf16 a[128:143], a[224:227], v[240:243], a[128:143]
  ds_read_b64_tr_b16 a[224:225], v23 offset:0
  ds_read_b64_tr_b16 a[226:227], v23 offset:256
  v_mfma_f32_32x32x16_bf16 a[144:159], a[228:231], v[240:243], a[144:159]
  ds_read_b64_tr_b16 a[228:229], v23 offset:64
  ds_read_b64_tr_b16 a[230:231], v23 offset:320
  v_exp_f32 v224, v208
  v_exp_f32 v225, v209
  v_mfma_f32_32x32x16_bf16 a[160:175], a[232:235], v[240:243], a[160:175]
  ds_read_b64_tr_b16 a[232:233], v23 offset:128
  ds_read_b64_tr_b16 a[234:235], v23 offset:384
  v_exp_f32 v226, v210
  v_add_f32 v28, v224, v225
  v_cvt_pk_bf16_f32 v248, v224, v225
  v_mfma_f32_32x32x16_bf16 a[176:191], a[236:239], v[240:243], a[176:191]
  ds_read_b64_tr_b16 a[236:237], v23 offset:192
  ds_read_b64_tr_b16 a[238:239], v23 offset:448
  v_exp_f32 v227, v211
  v_exp_f32 v228, v212
  v_mfma_f32_32x32x16_bf16 a[128:143], a[240:243], v[244:247], a[128:143]
  ds_read_b64_tr_b16 a[240:241], v23 offset:4352
  ds_read_b64_tr_b16 a[242:243], v23 offset:4608
  v_add_f32 v29, v226, v227
  v_cvt_pk_bf16_f32 v249, v226, v227
  v_exp_f32 v229, v213
  v_mfma_f32_32x32x16_bf16 a[144:159], a[244:247], v[244:247], a[144:159]
  ds_read_b64_tr_b16 a[244:245], v23 offset:4416
  ds_read_b64_tr_b16 a[246:247], v23 offset:4672
  v_exp_f32 v230, v214
  v_add_f32 v28, v28, v228
  s_add_u32 m0, s62, 34944
  v_mfma_f32_32x32x16_bf16 a[160:175], a[248:251], v[244:247], a[160:175]
  buffer_load_dwordx4 v18, s[28:31], s60 offen offset:2048 nt lds
  ds_read_b64_tr_b16 a[248:249], v23 offset:4480
  ds_read_b64_tr_b16 a[250:251], v23 offset:4736
  v_add_f32 v29, v29, v229
  v_cvt_pk_bf16_f32 v250, v228, v229
  v_mfma_f32_32x32x16_bf16 a[176:191], a[252:255], v[244:247], a[176:191]
  ds_read_b64_tr_b16 a[252:253], v23 offset:4544
  ds_read_b64_tr_b16 a[254:255], v23 offset:4800
  v_exp_f32 v231, v215
  v_exp_f32 v232, v216
  v_mfma_f32_32x32x16_bf16 v[192:207], a[192:195], v[128:131], v[176:191]
  v_add_f32 v28, v28, v230
  v_add_f32 v29, v29, v231
  v_cvt_pk_bf16_f32 v251, v230, v231
  v_exp_f32 v233, v217
  v_mfma_f32_32x32x16_bf16 v[192:207], a[196:199], v[132:135], v[192:207]
  v_exp_f32 v234, v218
  v_add_f32 v28, v28, v232
  v_add_f32 v29, v29, v233
  v_cvt_pk_bf16_f32 v252, v232, v233
  v_mfma_f32_32x32x16_bf16 v[192:207], a[200:203], v[136:139], v[192:207]
  v_exp_f32 v235, v219
  v_exp_f32 v236, v220
  v_add_f32 v28, v28, v234
  v_add_f32 v29, v29, v235
  v_mfma_f32_32x32x16_bf16 v[192:207], a[204:207], v[140:143], v[192:207]
  v_cvt_pk_bf16_f32 v253, v234, v235
  v_exp_f32 v237, v221
  v_exp_f32 v238, v222
  v_add_f32 v28, v28, v236
  v_mfma_f32_32x32x16_bf16 v[192:207], a[208:211], v[144:147], v[192:207]
  v_add_f32 v29, v29, v237
  v_cvt_pk_bf16_f32 v254, v236, v237
  v_exp_f32 v239, v223
  v_add_f32 v28, v28, v238
  s_add_u32 m0, s62, 35008
  v_mfma_f32_32x32x16_bf16 v[192:207], a[212:215], v[148:151], v[192:207]
  buffer_load_dwordx4 v18, s[28:31], s60 offen offset:3072 nt lds
  v_add_f32 v29, v29, v239
  v_cvt_pk_bf16_f32 v255, v238, v239
  v_add_f32 v28, v28, v29
  v_mfma_f32_32x32x16_bf16 v[192:207], a[216:219], v[152:155], v[192:207]
  v_cmp_nle_f32 vcc, v28, v31
  s_cbranch_vccnz L_tr33
L_bk33:
  v_add_f32 v25, v25, v28
  v_mfma_f32_32x32x16_bf16 v[192:207], a[220:223], v[156:159], v[192:207]
  s_waitcnt lgkmcnt(14)
  v_mfma_f32_32x32x16_bf16 a[0:15], a[224:227], v[248:251], a[0:15]
  s_waitcnt lgkmcnt(12)
  v_mfma_f32_32x32x16_bf16 a[16:31], a[228:231], v[248:251], a[16:31]
  v_exp_f32 v224, v192
  v_exp_f32 v225, v193
  v_exp_f32 v226, v194
  s_waitcnt lgkmcnt(10)
  v_mfma_f32_32x32x16_bf16 a[32:47], a[232:235], v[248:251], a[32:47]
  v_add_f32 v28, v224, v225
  v_cvt_pk_bf16_f32 v240, v224, v225
  v_exp_f32 v227, v195
  v_exp_f32 v228, v196
  s_waitcnt lgkmcnt(8)
  v_mfma_f32_32x32x16_bf16 a[48:63], a[236:239], v[248:251], a[48:63]
  v_add_f32 v29, v226, v227
  v_cvt_pk_bf16_f32 v241, v226, v227
  v_exp_f32 v229, v197
  s_mov_b32 s60, 110592
  s_add_u32 m0, s62, 39168
  s_waitcnt lgkmcnt(6)
  v_mfma_f32_32x32x16_bf16 a[0:15], a[240:243], v[252:255], a[0:15]
  buffer_load_dwordx4 v18, s[28:31], s60 offen offset:0 nt lds
  v_exp_f32 v230, v198
  v_add_f32 v28, v28, v228
  v_add_f32 v29, v29, v229
  s_waitcnt lgkmcnt(4)
  v_mfma_f32_32x32x16_bf16 a[16:31], a[244:247], v[252:255], a[16:31]
  v_cvt_pk_bf16_f32 v242, v228, v229
  v_exp_f32 v231, v199
  v_exp_f32 v232, v200
  v_add_f32 v28, v28, v230
  s_waitcnt lgkmcnt(2)
  v_mfma_f32_32x32x16_bf16 a[32:47], a[248:251], v[252:255], a[32:47]
  v_add_f32 v29, v29, v231
  v_cvt_pk_bf16_f32 v243, v230, v231
  v_exp_f32 v233, v201
  v_exp_f32 v234, v202
  s_waitcnt lgkmcnt(0)
  v_mfma_f32_32x32x16_bf16 a[48:63], a[252:255], v[252:255], a[48:63]
  v_add_f32 v28, v28, v232
  v_add_f32 v29, v29, v233
  v_cvt_pk_bf16_f32 v244, v232, v233
  v_exp_f32 v235, v203
  s_waitcnt vmcnt(8)
  s_barrier
  v_mfma_f32_32x32x16_bf16 v[208:223], a[192:195], v[64:67], v[96:111]
  ds_read_b128 a[192:195], v21 offset:34816
  v_exp_f32 v236, v204
  v_add_f32 v28, v28, v234
  v_add_f32 v29, v29, v235
  v_cvt_pk_bf16_f32 v245, v234, v235
  v_mfma_f32_32x32x16_bf16 v[208:223], a[196:199], v[68:71], v[208:223]
  ds_read_b128 a[196:199], v22 offset:34816
  v_exp_f32 v237, v205
  v_exp_f32 v238, v206
  v_add_f32 v28, v28, v236
  v_mfma_f32_32x32x16_bf16 v[208:223], a[200:203], v[72:75], v[208:223]
  ds_read_b128 a[200:203], v21 offset:34880
  v_add_f32 v29, v29, v237
  v_cvt_pk_bf16_f32 v246, v236, v237
  v_exp_f32 v239, v207
  s_add_u32 m0, s62, 39232
  v_mfma_f32_32x32x16_bf16 v[208:223], a[204:207], v[76:79], v[208:223]
  buffer_load_dwordx4 v18, s[28:31], s60 offen offset:1024 nt lds
  ds_read_b128 a[204:207], v22 offset:34880
  v_add_f32 v28, v28, v238
  v_add_f32 v29, v29, v239
  v_cvt_pk_bf16_f32 v247, v238, v239
  v_mfma_f32_32x32x16_bf16 v[208:223], a[208:211], v[80:83], v[208:223]
  ds_read_b128 a[208:211], v21 offset:34944
  v_add_f32 v28, v28, v29
  v_cmp_nle_f32 vcc, v28, v31
  s_cbranch_vccnz L_tr34
L_bk34:
  v_add_f32 v26, v26, v28
  v_mfma_f32_32x32x16_bf16 v[208:223], a[212:215], v[84:87], v[208:223]
  ds_read_b128 a[212:215], v22 offset:34944
  v_mfma_f32_32x32x16_bf16 v[208:223], a[216:219], v[88:91], v[208:223]
  ds_read_b128 a[216:219], v21 offset:35008
  v_mfma_f32_32x32x16_bf16 v[208:223], a[220:223], v[92:95], v[208:223]
  ds_read_b128 a[220:223], v22 offset:35008
  v_mfma_f32_32x32x16_bf16 a[64:79], a[224:227], v[240:243], a[64:79]
  v_mfma_f32_32x32x16_bf16 a[80:95], a[228:231], v[240:243], a[80:95]
  v_exp_f32 v224, v208
  v_exp_f32 v225, v209
  s_add_u32 m0, s62, 39296
  v_mfma_f32_32x32x16_bf16 a[96:111], a[232:235], v[240:243], a[96:111]
  buffer_load_dwordx4 v18, s[28:31], s60 offen offset:2048 nt lds
  v_exp_f32 v226, v210
  v_add_f32 v28, v224, v225
  v_cvt_pk_bf16_f32 v248, v224, v225
  v_mfma_f32_32x32x16_bf16 a[112:127], a[236:239], v[240:243], a[112:127]
  v_exp_f32 v227, v211
  v_exp_f32 v228, v212
  v_add_f32 v29, v226, v227
  v_cvt_pk_bf16_f32 v249, v226, v227
  v_mfma_f32_32x32x16_bf16 a[64:79], a[240:243], v[244:247], a[64:79]
  v_exp_f32 v229, v213
  v_exp_f32 v230, v214
  v_add_f32 v28, v28, v228
  v_add_f32 v29, v29, v229
  v_mfma_f32_32x32x16_bf16 a[80:95], a[244:247], v[244:247], a[80:95]
  v_cvt_pk_bf16_f32 v250, v228, v229
  v_exp_f32 v231, v215
  v_exp_f32 v232, v216
  v_add_f32 v28, v28, v230
  v_mfma_f32_32x32x16_bf16 a[96:111], a[248:251], v[244:247], a[96:111]
  v_add_f32 v29, v29, v231
  v_cvt_pk_bf16_f32 v251, v230, v231
  v_exp_f32 v233, v217
  v_exp_f32 v234, v218
  v_mfma_f32_32x32x16_bf16 a[112:127], a[252:255], v[244:247], a[112:127]
  v_add_f32 v28, v28, v232
  v_add_f32 v29, v29, v233
  v_cvt_pk_bf16_f32 v252, v232, v233
  v_exp_f32 v235, v219
  s_waitcnt lgkmcnt(7)
  v_mfma_f32_32x32x16_bf16 v[192:207], a[192:195], v[32:35], v[160:175]
  v_exp_f32 v236, v220
  v_add_f32 v28, v28, v234
  v_add_f32 v29, v29, v235
  v_cvt_pk_bf16_f32 v253, v234, v235
  s_add_u32 m0, s62, 39360
  s_waitcnt lgkmcnt(6)
  v_mfma_f32_32x32x16_bf16 v[192:207], a[196:199], v[36:39], v[192:207]
  buffer_load_dwordx4 v18, s[28:31], s60 offen offset:3072 nt lds
  v_exp_f32 v237, v221
  v_exp_f32 v238, v222
  s_waitcnt lgkmcnt(5)
  v_mfma_f32_32x32x16_bf16 v[192:207], a[200:203], v[40:43], v[192:207]
  v_add_f32 v28, v28, v236
  v_add_f32 v29, v29, v237
  v_cvt_pk_bf16_f32 v254, v236, v237
  v_exp_f32 v239, v223
  v_add_f32 v28, v28, v238
  s_waitcnt lgkmcnt(4)
  v_mfma_f32_32x32x16_bf16 v[192:207], a[204:207], v[44:47], v[192:207]
  v_add_f32 v29, v29, v239
  v_cvt_pk_bf16_f32 v255, v238, v239
  v_add_f32 v28, v28, v29
  v_cmp_nle_f32 vcc, v28, v31
  s_cbranch_vccnz L_tr35
L_bk35:
  v_add_f32 v27, v27, v28
  s_waitcnt lgkmcnt(3)
  v_mfma_f32_32x32x16_bf16 v[192:207], a[208:211], v[48:51], v[192:207]
  s_waitcnt lgkmcnt(2)
  v_mfma_f32_32x32x16_bf16 v[192:207], a[212:215], v[52:55], v[192:207]
  s_waitcnt lgkmcnt(1)
  v_mfma_f32_32x32x16_bf16 v[192:207], a[216:219], v[56:59], v[192:207]
  s_cmp_eq_u32 s3, 0
  s_cselect_b32 s64, 0x4000000, 0
  v_min3_u32 v8, v8, v9, v10
  v_min_u32 v8, v8, v11
  v_cmp_gt_u32 vcc, s64, v8
  s_cbranch_vccnz L_sp_arr
L_sb_arr:
  s_waitcnt lgkmcnt(0)
  v_mfma_f32_32x32x16_bf16 v[192:207], a[220:223], v[60:63], v[192:207]
  s_mov_b32 s60, 114688
  s_add_u32 m0, s62, 69632
  v_mfma_f32_32x32x16_bf16 a[128:143], a[224:227], v[248:251], a[128:143]
  buffer_load_dwordx4 v18, s[28:31], s60 offen offset:0 nt lds
  ds_read_b64_tr_b16 a[224:225], v24 offset:34816
  ds_read_b64_tr_b16 a[226:227], v24 offset:35072
  v_mfma_f32_32x32x16_bf16 a[144:159], a[228:231], v[248:251], a[144:159]
  ds_read_b64_tr_b16 a[228:229], v24 offset:34880
  ds_read_b64_tr_b16 a[230:231], v24 offset:35136
  v_exp_f32 v224, v192
  v_exp_f32 v225, v193
  v_mfma_f32_32x32x16_bf16 a[160:175], a[232:235], v[248:251], a[160:175]
  ds_read_b64_tr_b16 a[232:233], v24 offset:34944
  ds_read_b64_tr_b16 a[234:235], v24 offset:35200
  v_exp_f32 v226, v194
  v_add_f32 v28, v224, v225
  v_cvt_pk_bf16_f32 v240, v224, v225
  v_mfma_f32_32x32x16_bf16 a[176:191], a[236:239], v[248:251], a[176:191]
  ds_read_b64_tr_b16 a[236:237], v24 offset:35008
  ds_read_b64_tr_b16 a[238:239], v24 offset:35264
  v_exp_f32 v227, v195
  v_exp_f32 v228, v196
  v_mfma_f32_32x32x16_bf16 a[128:143], a[240:243], v[252:255], a[128:143]
  ds_read_b64_tr_b16 a[240:241], v24 offset:39168
  ds_read_b64_tr_b16 a[242:243], v24 offset:39424
  v_add_f32 v29, v226, v227
  v_cvt_pk_bf16_f32 v241, v226, v227
  v_exp_f32 v229, v197
  v_mfma_f32_32x32x16_bf16 a[144:159], a[244:247], v[252:255], a[144:159]
  ds_read_b64_tr_b16 a[244:245], v24 offset:39232
  ds_read_b64_tr_b16 a[246:247], v24 offset:39488
  v_exp_f32 v230, v198
  v_add_f32 v28, v28, v228
  s_add_u32 m0, s62, 69696
  v_mfma_f32_32x32x16_bf16 a[160:175], a[248:251], v[252:255], a[160:175]
  buffer_load_dwordx4 v18, s[28:31], s60 offen offset:1024 nt lds
  ds_read_b64_tr_b16 a[248:249], v24 offset:39296
  ds_read_b64_tr_b16 a[250:251], v24 offset:39552
  v_add_f32 v29, v29, v229
  v_cvt_pk_bf16_f32 v242, v228, v229
  v_mfma_f32_32x32x16_bf16 a[176:191], a[252:255], v[252:255], a[176:191]
  ds_read_b64_tr_b16 a[252:253], v24 offset:39360
  ds_read_b64_tr_b16 a[254:255], v24 offset:39616
  v_exp_f32 v231, v199
  v_exp_f32 v232, v200
  v_mfma_f32_32x32x16_bf16 v[208:223], a[192:195], v[128:131], v[176:191]
  v_add_f32 v28, v28, v230
  v_add_f32 v29, v29, v231
  v_cvt_pk_bf16_f32 v243, v230, v231
  v_exp_f32 v233, v201
  v_mfma_f32_32x32x16_bf16 v[208:223], a[196:199], v[132:135], v[208:223]
  v_exp_f32 v234, v202
  v_add_f32 v28, v28, v232
  v_add_f32 v29, v29, v233
  v_cvt_pk_bf16_f32 v244, v232, v233
  v_mfma_f32_32x32x16_bf16 v[208:223], a[200:203], v[136:139], v[208:223]
  v_exp_f32 v235, v203
  v_exp_f32 v236, v204
  v_add_f32 v28, v28, v234
  v_add_f32 v29, v29, v235
  v_mfma_f32_32x32x16_bf16 v[208:223], a[204:207], v[140:143], v[208:223]
  v_cvt_pk_bf16_f32 v245, v234, v235
  v_exp_f32 v237, v205
  v_exp_f32 v238, v206
  v_add_f32 v28, v28, v236
  v_mfma_f32_32x32x16_bf16 v[208:223], a[208:211], v[144:147], v[208:223]
  v_add_f32 v29, v29, v237
  v_cvt_pk_bf16_f32 v246, v236, v237
  v_exp_f32 v239, v207
  v_add_f32 v28, v28, v238
  s_add_u32 m0, s62, 69760
  v_mfma_f32_32x32x16_bf16 v[208:223], a[212:215], v[148:151], v[208:223]
  buffer_load_dwordx4 v18, s[28:31], s60 offen offset:2048 nt lds
  v_add_f32 v29, v29, v239
  v_cvt_pk_bf16_f32 v247, v238, v239
  v_add_f32 v28, v28, v29
  v_mfma_f32_32x32x16_bf16 v[208:223], a[216:219], v[152:155], v[208:223]
  v_cmp_nle_f32 vcc, v28, v31
  s_cbranch_vccnz L_tr36
L_bk36:
  v_add_f32 v25, v25, v28
  v_mfma_f32_32x32x16_bf16 v[208:223], a[220:223], v[156:159], v[208:223]
  s_waitcnt lgkmcnt(14)
  v_mfma_f32_32x32x16_bf16 a[0:15], a[224:227], v[240:243], a[0:15]
  s_waitcnt lgkmcnt(12)
  v_mfma_f32_32x32x16_bf16 a[16:31], a[228:231], v[240:243], a[16:31]
  v_exp_f32 v224, v208
  v_exp_f32 v225, v209
  v_exp_f32 v226, v210
  s_waitcnt lgkmcnt(10)
  v_mfma_f32_32x32x16_bf16 a[32:47], a[232:235], v[240:243], a[32:47]
  v_add_f32 v28, v224, v225
  v_cvt_pk_bf16_f32 v248, v224, v225
  v_exp_f32 v227, v211
  v_exp_f32 v228, v212
  s_waitcnt lgkmcnt(8)
  v_mfma_f32_32x32x16_bf16 a[48:63], a[236:239], v[240:243], a[48:63]
  v_add_f32 v29, v226, v227
  v_cvt_pk_bf16_f32 v249, v226, v227
  v_exp_f32 v229, v213
  s_add_u32 m0, s62, 69824
  s_waitcnt lgkmcnt(6)
  v_mfma_f32_32x32x16_bf16 a[0:15], a[240:243], v[244:247], a[0:15]
  buffer_load_dwordx4 v18, s[28:31], s60 offen offset:3072 nt lds
  v_exp_f32 v230, v214
  v_add_f32 v28, v28, v228
  v_add_f32 v29, v29, v229
  s_waitcnt lgkmcnt(4)
  v_mfma_f32_32x32x16_bf16 a[16:31], a[244:247], v[244:247], a[16:31]
  v_cvt_pk_bf16_f32 v250, v228, v229
  v_exp_f32 v231, v215
  v_exp_f32 v232, v216
  v_add_f32 v28, v28, v230
  s_waitcnt lgkmcnt(2)
  v_mfma_f32_32x32x16_bf16 a[32:47], a[248:251], v[244:247], a[32:47]
  v_add_f32 v29, v29, v231
  v_cvt_pk_bf16_f32 v251, v230, v231
  v_exp_f32 v233, v217
  v_exp_f32 v234, v218
  s_waitcnt lgkmcnt(0)
  v_mfma_f32_32x32x16_bf16 a[48:63], a[252:255], v[244:247], a[48:63]
  v_add_f32 v28, v28, v232
  v_add_f32 v29, v29, v233
  v_cvt_pk_bf16_f32 v252, v232, v233
  s_add_u32 s58, s4, 49152
  s_add_u32 m0, s63, 106496
  s_waitcnt vmcnt(4)
  s_barrier
  v_mfma_f32_32x32x16_bf16 v[192:207], a[192:195], v[64:67], v[96:111]
  buffer_load_dwordx4 v3, s[36:39], s58 offen  lds
  ds_read_b128 a[192:195], v19 offset:34816
  v_exp_f32 v235, v219
  v_mfma_f32_32x32x16_bf16 v[192:207], a[196:199], v[68:71], v[192:207]
  ds_read_b128 a[196:199], v20 offset:34816
  v_exp_f32 v236, v220
  v_add_f32 v28, v28, v234
  v_add_f32 v29, v29, v235
  v_cvt_pk_bf16_f32 v253, v234, v235
  v_mfma_f32_32x32x16_bf16 v[192:207], a[200:203], v[72:75], v[192:207]
  ds_read_b128 a[200:203], v19 offset:34880
  v_exp_f32 v237, v221
  s_mov_b32 s60, 118784
  s_add_u32 m0, s62, 73984
  v_mfma_f32_32x32x16_bf16 v[192:207], a[204:207], v[76:79], v[192:207]
  buffer_load_dwordx4 v18, s[28:31], s60 offen offset:0 nt lds
  ds_read_b128 a[204:207], v20 offset:34880
  s_add_u32 s58, s5, 49152
  s_add_u32 m0, s63, 110592
  v_mfma_f32_32x32x16_bf16 v[192:207], a[208:211], v[80:83], v[192:207]
  buffer_load_dwordx4 v3, s[36:39], s58 offen  lds
  ds_read_b128 a[208:211], v19 offset:34944
  v_exp_f32 v238, v222
  v_add_f32 v28, v28, v236
  v_mfma_f32_32x32x16_bf16 v[192:207], a[212:215], v[84:87], v[192:207]
  ds_read_b128 a[212:215], v20 offset:34944
  v_add_f32 v29, v29, v237
  v_cvt_pk_bf16_f32 v254, v236, v237
  v_exp_f32 v239, v223
  v_add_f32 v28, v28, v238
  v_mfma_f32_32x32x16_bf16 v[192:207], a[216:219], v[88:91], v[192:207]
  ds_read_b128 a[216:219], v19 offset:35008
  v_add_f32 v29, v29, v239
  v_cvt_pk_bf16_f32 v255, v238, v239
  v_add_f32 v28, v28, v29
  s_add_u32 s58, s4, 65536
  s_add_u32 m0, s63, 114688
  v_mfma_f32_32x32x16_bf16 v[192:207], a[220:223], v[92:95], v[192:207]
  buffer_load_dwordx4 v3, s[36:39], s58 offen  lds
  ds_read_b128 a[220:223], v20 offset:35008
  v_cmp_nle_f32 vcc, v28, v31
  s_cbranch_vccnz L_tr37
L_bk37:
  v_add_f32 v26, v26, v28
  v_mfma_f32_32x32x16_bf16 a[64:79], a[224:227], v[248:251], a[64:79]
  v_mfma_f32_32x32x16_bf16 a[80:95], a[228:231], v[248:251], a[80:95]
  v_exp_f32 v224, v192
  v_exp_f32 v225, v193
  s_add_u32 m0, s62, 74048
  v_mfma_f32_32x32x16_bf16 a[96:111], a[232:235], v[248:251], a[96:111]
  buffer_load_dwordx4 v18, s[28:31], s60 offen offset:1024 nt lds
  v_exp_f32 v226, v194
  s_add_u32 s58, s5, 65536
  s_add_u32 m0, s63, 118784
  v_mfma_f32_32x32x16_bf16 a[112:127], a[236:239], v[248:251], a[112:127]
  buffer_load_dwordx4 v3, s[36:39], s58 offen  lds
  v_add_f32 v28, v224, v225
  v_cvt_pk_bf16_f32 v240, v224, v225
  v_exp_f32 v227, v195
  v_mfma_f32_32x32x16_bf16 a[64:79], a[240:243], v[252:255], a[64:79]
  v_exp_f32 v228, v196
  v_add_f32 v29, v226, v227
  v_cvt_pk_bf16_f32 v241, v226, v227
  v_exp_f32 v229, v197
  v_mfma_f32_32x32x16_bf16 a[80:95], a[244:247], v[252:255], a[80:95]
  v_exp_f32 v230, v198
  v_add_f32 v28, v28, v228
  v_add_f32 v29, v29, v229
  s_add_u32 s58, s4, 81920
  s_add_u32 m0, s63, 122880
  v_mfma_f32_32x32x16_bf16 a[96:111], a[248:251], v[252:255], a[96:111]
  buffer_load_dwordx4 v3, s[36:39], s58 offen  lds
  v_cvt_pk_bf16_f32 v242, v228, v229
  v_exp_f32 v231, v199
  v_mfma_f32_32x32x16_bf16 a[112:127], a[252:255], v[252:255], a[112:127]
  v_exp_f32 v232, v200
  v_add_f32 v28, v28, v230
  v_add_f32 v29, v29, v231
  v_cvt_pk_bf16_f32 v243, v230, v231
  s_waitcnt lgkmcnt(7)
  v_mfma_f32_32x32x16_bf16 v[208:223], a[192:195], v[32:35], v[160:175]
  v_exp_f32 v233, v201
  v_exp_f32 v234, v202
  v_add_f32 v28, v28, v232
  s_add_u32 m0, s62, 74112
  s_waitcnt lgkmcnt(6)
  v_mfma_f32_32x32x16_bf16 v[208:223], a[196:199], v[36:39], v[208:223]
  buffer_load_dwordx4 v18, s[28:31], s60 offen offset:2048 nt lds
  v_add_f32 v29, v29, v233
  v_cvt_pk_bf16_f32 v244, v232, v233
  s_add_u32 s58, s5, 81920
  s_add_u32 m0, s63, 126976
  s_waitcnt lgkmcnt(5)
  v_mfma_f32_32x32x16_bf16 v[208:223], a[200:203], v[40:43], v[208:223]
  buffer_load_dwordx4 v3, s[36:39], s58 offen  lds
  v_exp_f32 v235, v203
  v_exp_f32 v236, v204
  s_waitcnt lgkmcnt(4)
  v_mfma_f32_32x32x16_bf16 v[208:223], a[204:207], v[44:47], v[208:223]
  v_add_f32 v28, v28, v234
  v_add_f32 v29, v29, v235
  v_cvt_pk_bf16_f32 v245, v234, v235
  v_exp_f32 v237, v205
  s_waitcnt lgkmcnt(3)
  v_mfma_f32_32x32x16_bf16 v[208:223], a[208:211], v[48:51], v[208:223]
  v_exp_f32 v238, v206
  v_add_f32 v28, v28, v236
  v_add_f32 v29, v29, v237
  s_add_u32 s58, s4, 98304
  s_add_u32 m0, s63, 131072
  s_waitcnt lgkmcnt(2)
  v_mfma_f32_32x32x16_bf16 v[208:223], a[212:215], v[52:55], v[208:223]
  buffer_load_dwordx4 v3, s[36:39], s58 offen  lds
  v_cvt_pk_bf16_f32 v246, v236, v237
  v_exp_f32 v239, v207
  v_add_f32 v28, v28, v238
  s_waitcnt lgkmcnt(1)
  v_mfma_f32_32x32x16_bf16 v[208:223], a[216:219], v[56:59], v[208:223]
  v_add_f32 v29, v29, v239
  v_cvt_pk_bf16_f32 v247, v238, v239
  v_add_f32 v28, v28, v29
  v_cmp_nle_f32 vcc, v28, v31
  s_cbranch_vccnz L_tr38
L_bk38:
  v_add_f32 v27, v27, v28
  s_waitcnt lgkmcnt(0)
  v_mfma_f32_32x32x16_bf16 v[208:223], a[220:223], v[60:63], v[208:223]
  s_add_u32 m0, s62, 74176
  v_mfma_f32_32x32x16_bf16 a[128:143], a[224:227], v[240:243], a[128:143]
  buffer_load_dwordx4 v18, s[28:31], s60 offen offset:3072 nt lds
  ds_read_b64_tr_b16 a[224:225], v23 offset:34816
  ds_read_b64_tr_b16 a[226:227], v23 offset:35072
  s_add_u32 s58, s5, 98304
  s_add_u32 m0, s63, 135168
  v_mfma_f32_32x32x16_bf16 a[144:159], a[228:231], v[240:243], a[144:159]
  buffer_load_dwordx4 v3, s[36:39], s58 offen  lds
  ds_read_b64_tr_b16 a[228:229], v23 offset:34880
  ds_read_b64_tr_b16 a[230:231], v23 offset:35136
  v_exp_f32 v224, v208
  v_mfma_f32_32x32x16_bf16 a[160:175], a[232:235], v[240:243], a[160:175]
  ds_read_b64_tr_b16 a[232:233], v23 offset:34944
  ds_read_b64_tr_b16 a[234:235], v23 offset:35200
  v_exp_f32 v225, v209
  v_exp_f32 v226, v210
  v_mfma_f32_32x32x16_bf16 a[176:191], a[236:239], v[240:243], a[176:191]
  ds_read_b64_tr_b16 a[236:237], v23 offset:35008
  ds_read_b64_tr_b16 a[238:239], v23 offset:35264
  v_add_f32 v28, v224, v225
  v_cvt_pk_bf16_f32 v248, v224, v225
  v_exp_f32 v227, v211
  v_mfma_f32_32x32x16_bf16 a[128:143], a[240:243], v[244:247], a[128:143]
  ds_read_b64_tr_b16 a[240:241], v23 offset:39168
  ds_read_b64_tr_b16 a[242:243], v23 offset:39424
  v_exp_f32 v228, v212
  v_add_f32 v29, v226, v227
  v_cvt_pk_bf16_f32 v249, v226, v227
  v_mfma_f32_32x32x16_bf16 a[144:159], a[244:247], v[244:247], a[144:159]
  ds_read_b64_tr_b16 a[244:245], v23 offset:39232
  ds_read_b64_tr_b16 a[246:247], v23 offset:39488
  v_exp_f32 v229, v213
  v_exp_f32 v230, v214
  v_mfma_f32_32x32x16_bf16 a[160:175], a[248:251], v[244:247], a[160:175]
  ds_read_b64_tr_b16 a[248:249], v23 offset:39296
  ds_read_b64_tr_b16 a[250:251], v23 offset:39552
  v_add_f32 v28, v28, v228
  v_add_f32 v29, v29, v229
  s_mov_b32 s60, 122880
  s_add_u32 m0, s62, 0
  v_mfma_f32_32x32x16_bf16 a[176:191], a[252:255], v[244:247], a[176:191]
  buffer_load_dwordx4 v18, s[28:31], s60 offen offset:0 nt lds
  ds_read_b64_tr_b16 a[252:253], v23 offset:39360
  ds_read_b64_tr_b16 a[254:255], v23 offset:39616
  v_cvt_pk_bf16_f32 v250, v228, v229
  v_mfma_f32_32x32x16_bf16 v[192:207], a[192:195], v[128:131], v[176:191]
  v_exp_f32 v231, v215
  v_exp_f32 v232, v216
  v_add_f32 v28, v28, v230
  v_add_f32 v29, v29, v231
  v_mfma_f32_32x32x16_bf16 v[192:207], a[196:199], v[132:135], v[192:207]
  v_cvt_pk_bf16_f32 v251, v230, v231
  v_exp_f32 v233, v217
  v_exp_f32 v234, v218
  v_add_f32 v28, v28, v232
  v_mfma_f32_32x32x16_bf16 v[192:207], a[200:203], v[136:139], v[192:207]
  v_add_f32 v29, v29, v233
  v_cvt_pk_bf16_f32 v252, v232, v233
  v_exp_f32 v235, v219
  v_exp_f32 v236, v220
  v_mfma_f32_32x32x16_bf16 v[192:207], a[204:207], v[140:143], v[192:207]
  v_add_f32 v28, v28, v234
  v_add_f32 v29, v29, v235
  v_cvt_pk_bf16_f32 v253, v234, v235
  v_exp_f32 v237, v221
  v_mfma_f32_32x32x16_bf16 v[192:207], a[208:211], v[144:147], v[192:207]
  v_exp_f32 v238, v222
  v_add_f32 v28, v28, v236
  v_add_f32 v29, v29, v237
  v_cvt_pk_bf16_f32 v254, v236, v237
  v_mfma_f32_32x32x16_bf16 v[192:207], a[212:215], v[148:151], v[192:207]
  v_exp_f32 v239, v223
  v_add_f32 v28, v28, v238
  v_add_f32 v29, v29, v239
  v_cvt_pk_bf16_f32 v255, v238, v239
  s_add_u32 m0, s62, 64
  v_mfma_f32_32x32x16_bf16 v[192:207], a[216:219], v[152:155], v[192:207]
  buffer_load_dwordx4 v18, s[28:31], s60 offen offset:1024 nt lds
  v_add_f32 v28, v28, v29
  v_cmp_nle_f32 vcc, v28, v31
  s_cbranch_vccnz L_tr39
L_bk39:
  v_add_f32 v25, v25, v28
  v_mfma_f32_32x32x16_bf16 v[192:207], a[220:223], v[156:159], v[192:207]
  s_waitcnt lgkmcnt(14)
  v_mfma_f32_32x32x16_bf16 a[0:15], a[224:227], v[248:251], a[0:15]
  s_waitcnt lgkmcnt(12)
  v_mfma_f32_32x32x16_bf16 a[16:31], a[228:231], v[248:251], a[16:31]
  v_exp_f32 v224, v192
  v_exp_f32 v225, v193
  v_exp_f32 v226, v194
  s_waitcnt lgkmcnt(10)
  v_mfma_f32_32x32x16_bf16 a[32:47], a[232:235], v[248:251], a[32:47]
  v_add_f32 v28, v224, v225
  v_cvt_pk_bf16_f32 v240, v224, v225
  v_exp_f32 v227, v195
  v_exp_f32 v228, v196
  s_waitcnt lgkmcnt(8)
  v_mfma_f32_32x32x16_bf16 a[48:63], a[236:239], v[248:251], a[48:63]
  v_add_f32 v29, v226, v227
  v_cvt_pk_bf16_f32 v241, v226, v227
  v_exp_f32 v229, v197
  v_exp_f32 v230, v198
  s_waitcnt lgkmcnt(6)
  v_mfma_f32_32x32x16_bf16 a[0:15], a[240:243], v[252:255], a[0:15]
  v_add_f32 v28, v28, v228
  v_add_f32 v29, v29, v229
  v_cvt_pk_bf16_f32 v242, v228, v229
  v_exp_f32 v231, v199
  s_add_u32 m0, s62, 128
  s_waitcnt lgkmcnt(4)
  v_mfma_f32_32x32x16_bf16 a[16:31], a[244:247], v[252:255], a[16:31]
  buffer_load_dwordx4 v18, s[28:31], s60 offen offset:2048 nt lds
  v_exp_f32 v232, v200
  v_add_f32 v28, v28, v230
  v_add_f32 v29, v29, v231
  s_waitcnt lgkmcnt(2)
  v_mfma_f32_32x32x16_bf16 a[32:47], a[248:251], v[252:255], a[32:47]
  v_cvt_pk_bf16_f32 v243, v230, v231
  v_exp_f32 v233, v201
  v_exp_f32 v234, v202
  v_add_f32 v28, v28, v232
  s_waitcnt lgkmcnt(0)
  v_mfma_f32_32x32x16_bf16 a[48:63], a[252:255], v[252:255], a[48:63]
  v_add_f32 v29, v29, v233
  v_cvt_pk_bf16_f32 v244, v232, v233
  v_exp_f32 v235, v203
  s_add_u32 s58, s4, 114688
  s_add_u32 m0, s63, 65536
  s_waitcnt vmcnt(4)
  s_barrier
  v_mfma_f32_32x32x16_bf16 v[208:223], a[192:195], v[64:67], v[96:111]
  buffer_load_dwordx4 v3, s[36:39], s58 offen  lds
  ds_read_b128 a[192:195], v21 offset:0
  v_exp_f32 v236, v204
  v_add_f32 v28, v28, v234
  v_mfma_f32_32x32x16_bf16 v[208:223], a[196:199], v[68:71], v[208:223]
  ds_read_b128 a[196:199], v22 offset:0
  v_add_f32 v29, v29, v235
  v_cvt_pk_bf16_f32 v245, v234, v235
  v_exp_f32 v237, v205
  v_mfma_f32_32x32x16_bf16 v[208:223], a[200:203], v[72:75], v[208:223]
  ds_read_b128 a[200:203], v21 offset:64
  v_exp_f32 v238, v206
  v_add_f32 v28, v28, v236
  v_add_f32 v29, v29, v237
  s_add_u32 m0, s62, 192
  v_mfma_f32_32x32x16_bf16 v[208:223], a[204:207], v[76:79], v[208:223]
  buffer_load_dwordx4 v18, s[28:31], s60 offen offset:3072 nt lds
  ds_read_b128 a[204:207], v22 offset:64
  v_cvt_pk_bf16_f32 v246, v236, v237
  s_add_u32 s58, s5, 114688
  s_add_u32 m0, s63, 61440
  v_mfma_f32_32x32x16_bf16 v[208:223], a[208:211], v[80:83], v[208:223]
  buffer_load_dwordx4 v3, s[36:39], s58 offen  lds
  ds_read_b128 a[208:211], v21 offset:128
  v_exp_f32 v239, v207
  v_add_f32 v28, v28, v238
  v_mfma_f32_32x32x16_bf16 v[208:223], a[212:215], v[84:87], v[208:223]
  ds_read_b128 a[212:215], v22 offset:128
  v_add_f32 v29, v29, v239
  v_cvt_pk_bf16_f32 v247, v238, v239
  v_add_f32 v28, v28, v29
  v_mfma_f32_32x32x16_bf16 v[208:223], a[216:219], v[88:91], v[208:223]
  ds_read_b128 a[216:219], v21 offset:192
  v_cmp_nle_f32 vcc, v28, v31
  s_cbranch_vccnz L_tr40
L_bk40:
  v_add_f32 v26, v26, v28
  s_add_u32 s58, s6, 0
  s_add_u32 m0, s63, 57344
  v_mfma_f32_32x32x16_bf16 v[208:223], a[220:223], v[92:95], v[208:223]
  buffer_load_dwordx4 v3, s[36:39], s58 offen  lds
  ds_read_b128 a[220:223], v22 offset:192
  v_mfma_f32_32x32x16_bf16 a[64:79], a[224:227], v[240:243], a[64:79]
  v_mfma_f32_32x32x16_bf16 a[80:95], a[228:231], v[240:243], a[80:95]
  v_exp_f32 v224, v208
  v_exp_f32 v225, v209
  s_mov_b32 s60, 126976
  s_add_u32 m0, s62, 4352
  v_mfma_f32_32x32x16_bf16 a[96:111], a[232:235], v[240:243], a[96:111]
  buffer_load_dwordx4 v18, s[28:31], s60 offen offset:0 nt lds
  v_exp_f32 v226, v210
  s_add_u32 s58, s7, 0
  s_add_u32 m0, s63, 53248
  v_mfma_f32_32x32x16_bf16 a[112:127], a[236:239], v[240:243], a[112:127]
  buffer_load_dwordx4 v3, s[36:39], s58 offen  lds
  v_add_f32 v28, v224, v225
  v_cvt_pk_bf16_f32 v248, v224, v225
  v_exp_f32 v227, v211
  v_mfma_f32_32x32x16_bf16 a[64:79], a[240:243], v[244:247], a[64:79]
  v_exp_f32 v228, v212
  v_add_f32 v29, v226, v227
  v_cvt_pk_bf16_f32 v249, v226, v227
  v_exp_f32 v229, v213
  v_mfma_f32_32x32x16_bf16 a[80:95], a[244:247], v[244:247], a[80:95]
  v_exp_f32 v230, v214
  v_add_f32 v28, v28, v228
  v_add_f32 v29, v29, v229
  s_add_u32 s58, s8, 0
  s_add_u32 m0, s63, 49152
  v_mfma_f32_32x32x16_bf16 a[96:111], a[248:251], v[244:247], a[96:111]
  buffer_load_dwordx4 v3, s[36:39], s58 offen  lds
  v_cvt_pk_bf16_f32 v250, v228, v229
  v_exp_f32 v231, v215
  v_mfma_f32_32x32x16_bf16 a[112:127], a[252:255], v[244:247], a[112:127]
  v_exp_f32 v232, v216
  v_add_f32 v28, v28, v230
  v_add_f32 v29, v29, v231
  v_cvt_pk_bf16_f32 v251, v230, v231
  s_waitcnt lgkmcnt(7)
  v_mfma_f32_32x32x16_bf16 v[192:207], a[192:195], v[32:35], v[160:175]
  v_exp_f32 v233, v217
  v_exp_f32 v234, v218
  v_add_f32 v28, v28, v232
  s_add_u32 m0, s62, 4416
  s_waitcnt lgkmcnt(6)
  v_mfma_f32_32x32x16_bf16 v[192:207], a[196:199], v[36:39], v[192:207]
  buffer_load_dwordx4 v18, s[28:31], s60 offen offset:1024 nt lds
  v_add_f32 v29, v29, v233
  v_cvt_pk_bf16_f32 v252, v232, v233
  s_add_u32 s58, s6, 16384
  s_add_u32 m0, s63, 45056
  s_waitcnt lgkmcnt(5)
  v_mfma_f32_32x32x16_bf16 v[192:207], a[200:203], v[40:43], v[192:207]
  buffer_load_dwordx4 v3, s[36:39], s58 offen  lds
  v_exp_f32 v235, v219
  v_exp_f32 v236, v220
  s_waitcnt lgkmcnt(4)
  v_mfma_f32_32x32x16_bf16 v[192:207], a[204:207], v[44:47], v[192:207]
  v_add_f32 v28, v28, v234
  v_add_f32 v29, v29, v235
  v_cvt_pk_bf16_f32 v253, v234, v235
  v_exp_f32 v237, v221
  s_waitcnt lgkmcnt(3)
  v_mfma_f32_32x32x16_bf16 v[192:207], a[208:211], v[48:51], v[192:207]
  v_exp_f32 v238, v222
  v_add_f32 v28, v28, v236
  v_add_f32 v29, v29, v237
  s_add_u32 s58, s7, 16384
  s_add_u32 m0, s63, 40960
  s_waitcnt lgkmcnt(2)
  v_mfma_f32_32x32x16_bf16 v[192:207], a[212:215], v[52:55], v[192:207]
  buffer_load_dwordx4 v3, s[36:39], s58 offen  lds
  v_cvt_pk_bf16_f32 v254, v236, v237
  v_exp_f32 v239, v223
  v_add_f32 v28, v28, v238
  s_waitcnt lgkmcnt(1)
  v_mfma_f32_32x32x16_bf16 v[192:207], a[216:219], v[56:59], v[192:207]
  v_add_f32 v29, v29, v239
  v_cvt_pk_bf16_f32 v255, v238, v239
  v_add_f32 v28, v28, v29
  v_cmp_nle_f32 vcc, v28, v31
  s_cbranch_vccnz L_tr41
L_bk41:
  v_add_f32 v27, v27, v28
  s_waitcnt lgkmcnt(0)
  v_mfma_f32_32x32x16_bf16 v[192:207], a[220:223], v[60:63], v[192:207]
  s_add_u32 m0, s62, 4480
  v_mfma_f32_32x32x16_bf16 a[128:143], a[224:227], v[248:251], a[128:143]
  buffer_load_dwordx4 v18, s[28:31], s60 offen offset:2048 nt lds
  ds_read_b64_tr_b16 a[224:225], v24 offset:0
  ds_read_b64_tr_b16 a[226:227], v24 offset:256
  s_add_u32 s58, s8, 16384
  s_add_u32 m0, s63, 36864
  v_mfma_f32_32x32x16_bf16 a[144:159], a[228:231], v[248:251], a[144:159]
  buffer_load_dwordx4 v3, s[36:39], s58 offen  lds
  ds_read_b64_tr_b16 a[228:229], v24 offset:64
  ds_read_b64_tr_b16 a[230:231], v24 offset:320
  v_exp_f32 v224, v192
  v_mfma_f32_32x32x16_bf16 a[160:175], a[232:235], v[248:251], a[160:175]
  ds_read_b64_tr_b16 a[232:233], v24 offset:128
  ds_read_b64_tr_b16 a[234:235], v24 offset:384
  v_exp_f32 v225, v193
  v_exp_f32 v226, v194
  v_mfma_f32_32x32x16_bf16 a[176:191], a[236:239], v[248:251], a[176:191]
  ds_read_b64_tr_b16 a[236:237], v24 offset:192
  ds_read_b64_tr_b16 a[238:239], v24 offset:448
  v_add_f32 v28, v224, v225
  v_cvt_pk_bf16_f32 v240, v224, v225
  v_exp_f32 v227, v195
  v_mfma_f32_32x32x16_bf16 a[128:143], a[240:243], v[252:255], a[128:143]
  ds_read_b64_tr_b16 a[240:241], v24 offset:4352
  ds_read_b64_tr_b16 a[242:243], v24 offset:4608
  v_exp_f32 v228, v196
  v_add_f32 v29, v226, v227
  v_cvt_pk_bf16_f32 v241, v226, v227
  v_mfma_f32_32x32x16_bf16 a[144:159], a[244:247], v[252:255], a[144:159]
  ds_read_b64_tr_b16 a[244:245], v24 offset:4416
  ds_read_b64_tr_b16 a[246:247], v24 offset:4672
  v_exp_f32 v229, v197
  v_exp_f32 v230, v198
  v_mfma_f32_32x32x16_bf16 a[160:175], a[248:251], v[252:255], a[160:175]
  ds_read_b64_tr_b16 a[248:249], v24 offset:4480
  ds_read_b64_tr_b16 a[250:251], v24 offset:4736
  v_add_f32 v28, v28, v228
  v_add_f32 v29, v29, v229
  v_cvt_pk_bf16_f32 v242, v228, v229
  s_add_u32 m0, s62, 4544
  v_mfma_f32_32x32x16_bf16 a[176:191], a[252:255], v[252:255], a[176:191]
  buffer_load_dwordx4 v18, s[28:31], s60 offen offset:3072 nt lds
  ds_read_b64_tr_b16 a[252:253], v24 offset:4544
  ds_read_b64_tr_b16 a[254:255], v24 offset:4800
  v_exp_f32 v231, v199
  v_mfma_f32_32x32x16_bf16 v[208:223], a[192:195], v[128:131], v[176:191]
  v_exp_f32 v232, v200
  v_add_f32 v28, v28, v230
  v_add_f32 v29, v29, v231
  v_cvt_pk_bf16_f32 v243, v230, v231
  v_mfma_f32_32x32x16_bf16 v[208:223], a[196:199], v[132:135], v[208:223]
  v_exp_f32 v233, v201
  v_exp_f32 v234, v202
  v_add_f32 v28, v28, v232
  v_add_f32 v29, v29, v233
  v_mfma_f32_32x32x16_bf16 v[208:223], a[200:203], v[136:139], v[208:223]
  v_cvt_pk_bf16_f32 v244, v232, v233
  v_exp_f32 v235, v203
  v_exp_f32 v236, v204
  v_add_f32 v28, v28, v234
  v_mfma_f32_32x32x16_bf16 v[208:223], a[204:207], v[140:143], v[208:223]
  v_add_f32 v29, v29, v235
  v_cvt_pk_bf16_f32 v245, v234, v235
  v_exp_f32 v237, v205
  v_exp_f32 v238, v206
  v_mfma_f32_32x32x16_bf16 v[208:223], a[208:211], v[144:147], v[208:223]
  v_add_f32 v28, v28, v236
  v_add_f32 v29, v29, v237
  v_cvt_pk_bf16_f32 v246, v236, v237
  v_exp_f32 v239, v207
  v_add_f32 v28, v28, v238
  v_mfma_f32_32x32x16_bf16 v[208:223], a[212:215], v[148:151], v[208:223]
  v_add_f32 v29, v29, v239
  v_cvt_pk_bf16_f32 v247, v238, v239
  v_add_f32 v28, v28, v29
  v_cmp_nle_f32 vcc, v28, v31
  s_cbranch_vccnz L_tr42
L_bk42:
  v_add_f32 v25, v25, v28
  v_mfma_f32_32x32x16_bf16 v[208:223], a[216:219], v[152:155], v[208:223]
  v_mfma_f32_32x32x16_bf16 v[208:223], a[220:223], v[156:159], v[208:223]
  s_waitcnt lgkmcnt(14)
  v_mfma_f32_32x32x16_bf16 a[0:15], a[224:227], v[240:243], a[0:15]
  s_waitcnt lgkmcnt(12)
  v_mfma_f32_32x32x16_bf16 a[16:31], a[228:231], v[240:243], a[16:31]
  v_exp_f32 v224, v208
  v_exp_f32 v225, v209
  v_exp_f32 v226, v210
  s_waitcnt lgkmcnt(10)
  v_mfma_f32_32x32x16_bf16 a[32:47], a[232:235], v[240:243], a[32:47]
  v_add_f32 v28, v224, v225
  v_cvt_pk_bf16_f32 v248, v224, v225
  v_exp_f32 v227, v211
  v_exp_f32 v228, v212
  s_waitcnt lgkmcnt(8)
  v_mfma_f32_32x32x16_bf16 a[48:63], a[236:239], v[240:243], a[48:63]
  v_add_f32 v29, v226, v227
  v_cvt_pk_bf16_f32 v249, v226, v227
  v_exp_f32 v229, v213
  v_exp_f32 v230, v214
  s_waitcnt lgkmcnt(6)
  v_mfma_f32_32x32x16_bf16 a[0:15], a[240:243], v[244:247], a[0:15]
  v_add_f32 v28, v28, v228
  v_add_f32 v29, v29, v229
  v_cvt_pk_bf16_f32 v250, v228, v229
  v_exp_f32 v231, v215
  s_waitcnt lgkmcnt(4)
  v_mfma_f32_32x32x16_bf16 a[16:31], a[244:247], v[244:247], a[16:31]
  v_exp_f32 v232, v216
  v_add_f32 v28, v28, v230
  v_add_f32 v29, v29, v231
  v_cvt_pk_bf16_f32 v251, v230, v231
  s_waitcnt lgkmcnt(2)
  v_mfma_f32_32x32x16_bf16 a[32:47], a[248:251], v[244:247], a[32:47]
  v_exp_f32 v233, v217
  v_exp_f32 v234, v218
  v_add_f32 v28, v28, v232
  v_add_f32 v29, v29, v233
  s_waitcnt lgkmcnt(0)
  v_mfma_f32_32x32x16_bf16 a[48:63], a[252:255], v[244:247], a[48:63]
  v_cvt_pk_bf16_f32 v252, v232, v233
  v_exp_f32 v235, v219
  s_add_u32 s58, s9, 0
  s_add_u32 m0, s63, 69632
  s_waitcnt vmcnt(0)
  s_barrier
  v_mfma_f32_32x32x16_bf16 v[192:207], a[192:195], v[64:67], v[96:111]
  buffer_load_dwordx4 v3, s[36:39], s58 offen  lds
  ds_read_b128 a[192:195], v19 offset:0
  v_exp_f32 v236, v220
  v_add_f32 v28, v28, v234
  v_mfma_f32_32x32x16_bf16 v[192:207], a[196:199], v[68:71], v[192:207]
  ds_read_b128 a[196:199], v20 offset:0
  v_add_f32 v29, v29, v235
  v_cvt_pk_bf16_f32 v253, v234, v235
  v_exp_f32 v237, v221
  v_mfma_f32_32x32x16_bf16 v[192:207], a[200:203], v[72:75], v[192:207]
  ds_read_b128 a[200:203], v19 offset:64
  v_exp_f32 v238, v222
  v_add_f32 v28, v28, v236
  s_add_u32 s58, s10, 0
  s_add_u32 m0, s63, 73728
  v_mfma_f32_32x32x16_bf16 v[192:207], a[204:207], v[76:79], v[192:207]
  buffer_load_dwordx4 v3, s[36:39], s58 offen  lds
  ds_read_b128 a[204:207], v20 offset:64
  v_add_f32 v29, v29, v237
  v_cvt_pk_bf16_f32 v254, v236, v237
  v_mfma_f32_32x32x16_bf16 v[192:207], a[208:211], v[80:83], v[192:207]
  ds_read_b128 a[208:211], v19 offset:128
  v_exp_f32 v239, v223
  v_add_f32 v28, v28, v238
  v_add_f32 v29, v29, v239
  v_cvt_pk_bf16_f32 v255, v238, v239
  v_mfma_f32_32x32x16_bf16 v[192:207], a[212:215], v[84:87], v[192:207]
  ds_read_b128 a[212:215], v20 offset:128
  v_add_f32 v28, v28, v29
  s_add_u32 s58, s11, 0
  s_add_u32 m0, s63, 77824
  v_mfma_f32_32x32x16_bf16 v[192:207], a[216:219], v[88:91], v[192:207]
  buffer_load_dwordx4 v3, s[36:39], s58 offen  lds
  ds_read_b128 a[216:219], v19 offset:192
  v_cmp_nle_f32 vcc, v28, v31
  s_cbranch_vccnz L_tr43
L_bk43:
  v_add_f32 v26, v26, v28
  v_mfma_f32_32x32x16_bf16 v[192:207], a[220:223], v[92:95], v[192:207]
  ds_read_b128 a[220:223], v20 offset:192
  v_mfma_f32_32x32x16_bf16 a[64:79], a[224:227], v[248:251], a[64:79]
  s_add_u32 s58, s6, 32768
  s_add_u32 m0, s63, 81920
  v_mfma_f32_32x32x16_bf16 a[80:95], a[228:231], v[248:251], a[80:95]
  buffer_load_dwordx4 v3, s[36:39], s58 offen  lds
  v_exp_f32 v224, v192
  v_exp_f32 v225, v193
  v_mfma_f32_32x32x16_bf16 a[96:111], a[232:235], v[248:251], a[96:111]
  v_exp_f32 v226, v194
  v_add_f32 v28, v224, v225
  v_cvt_pk_bf16_f32 v240, v224, v225
  v_exp_f32 v227, v195
  v_mfma_f32_32x32x16_bf16 a[112:127], a[236:239], v[248:251], a[112:127]
  v_exp_f32 v228, v196
  v_add_f32 v29, v226, v227
  v_cvt_pk_bf16_f32 v241, v226, v227
  s_add_u32 s58, s7, 32768
  s_add_u32 m0, s63, 86016
  v_mfma_f32_32x32x16_bf16 a[64:79], a[240:243], v[252:255], a[64:79]
  buffer_load_dwordx4 v3, s[36:39], s58 offen  lds
  v_exp_f32 v229, v197
  v_exp_f32 v230, v198
  v_mfma_f32_32x32x16_bf16 a[80:95], a[244:247], v[252:255], a[80:95]
  v_add_f32 v28, v28, v228
  v_add_f32 v29, v29, v229
  v_cvt_pk_bf16_f32 v242, v228, v229
  v_exp_f32 v231, v199
  v_mfma_f32_32x32x16_bf16 a[96:111], a[248:251], v[252:255], a[96:111]
  v_exp_f32 v232, v200
  v_add_f32 v28, v28, v230
  v_add_f32 v29, v29, v231
  s_add_u32 s58, s8, 32768
  s_add_u32 m0, s63, 90112
  v_mfma_f32_32x32x16_bf16 a[112:127], a[252:255], v[252:255], a[112:127]
  buffer_load_dwordx4 v3, s[36:39], s58 offen  lds
  v_cvt_pk_bf16_f32 v243, v230, v231
  v_exp_f32 v233, v201
  s_waitcnt lgkmcnt(7)
  v_mfma_f32_32x32x16_bf16 v[208:223], a[192:195], v[32:35], v[160:175]
  v_exp_f32 v234, v202
  v_add_f32 v28, v28, v232
  v_add_f32 v29, v29, v233
  v_cvt_pk_bf16_f32 v244, v232, v233
  s_waitcnt lgkmcnt(6)
  v_mfma_f32_32x32x16_bf16 v[208:223], a[196:199], v[36:39], v[208:223]
  v_exp_f32 v235, v203
  v_exp_f32 v236, v204
  s_add_u32 s58, s6, 49152
  s_add_u32 m0, s63, 94208
  s_waitcnt lgkmcnt(5)
  v_mfma_f32_32x32x16_bf16 v[208:223], a[200:203], v[40:43], v[208:223]
  buffer_load_dwordx4 v3, s[36:39], s58 offen  lds
  v_add_f32 v28, v28, v234
  v_add_f32 v29, v29, v235
  v_cvt_pk_bf16_f32 v245, v234, v235
  s_waitcnt lgkmcnt(4)
  v_mfma_f32_32x32x16_bf16 v[208:223], a[204:207], v[44:47], v[208:223]
  v_exp_f32 v237, v205
  v_exp_f32 v238, v206
  v_add_f32 v28, v28, v236
  v_add_f32 v29, v29, v237
  s_waitcnt lgkmcnt(3)
  v_mfma_f32_32x32x16_bf16 v[208:223], a[208:211], v[48:51], v[208:223]
  v_cvt_pk_bf16_f32 v246, v236, v237
  v_exp_f32 v239, v207
  v_add_f32 v28, v28, v238
  s_add_u32 s58, s7, 49152
  s_add_u32 m0, s63, 98304
  s_waitcnt lgkmcnt(2)
  v_mfma_f32_32x32x16_bf16 v[208:223], a[212:215], v[52:55], v[208:223]
  buffer_load_dwordx4 v3, s[36:39], s58 offen  lds
  v_add_f32 v29, v29, v239
  v_cvt_pk_bf16_f32 v247, v238, v239
  v_add_f32 v28, v28, v29
  s_waitcnt lgkmcnt(1)
  v_mfma_f32_32x32x16_bf16 v[208:223], a[216:219], v[56:59], v[208:223]
  v_cmp_nle_f32 vcc, v28, v31
  s_cbranch_vccnz L_tr44
L_bk44:
  v_add_f32 v27, v27, v28
  s_waitcnt lgkmcnt(0)
  v_mfma_f32_32x32x16_bf16 v[208:223], a[220:223], v[60:63], v[208:223]
  s_add_u32 s58, s8, 49152
  s_add_u32 m0, s63, 102400
  v_mfma_f32_32x32x16_bf16 a[128:143], a[224:227], v[240:243], a[128:143]
  buffer_load_dwordx4 v3, s[36:39], s58 offen  lds
  ds_read_b64_tr_b16 a[224:225], v23 offset:0
  ds_read_b64_tr_b16 a[226:227], v23 offset:256
  v_mfma_f32_32x32x16_bf16 a[144:159], a[228:231], v[240:243], a[144:159]
  ds_read_b64_tr_b16 a[228:229], v23 offset:64
  ds_read_b64_tr_b16 a[230:231], v23 offset:320
  v_exp_f32 v224, v208
  v_exp_f32 v225, v209
  v_mfma_f32_32x32x16_bf16 a[160:175], a[232:235], v[240:243], a[160:175]
  ds_read_b64_tr_b16 a[232:233], v23 offset:128
  ds_read_b64_tr_b16 a[234:235], v23 offset:384
  v_exp_f32 v226, v210
  v_add_f32 v28, v224, v225
  v_cvt_pk_bf16_f32 v248, v224, v225
  v_mfma_f32_32x32x16_bf16 a[176:191], a[236:239], v[240:243], a[176:191]
  ds_read_b64_tr_b16 a[236:237], v23 offset:192
  ds_read_b64_tr_b16 a[238:239], v23 offset:448
  v_exp_f32 v227, v211
  v_exp_f32 v228, v212
  v_mfma_f32_32x32x16_bf16 a[128:143], a[240:243], v[244:247], a[128:143]
  ds_read_b64_tr_b16 a[240:241], v23 offset:4352
  ds_read_b64_tr_b16 a[242:243], v23 offset:4608
  v_add_f32 v29, v226, v227
  v_cvt_pk_bf16_f32 v249, v226, v227
  v_exp_f32 v229, v213
  v_mfma_f32_32x32x16_bf16 a[144:159], a[244:247], v[244:247], a[144:159]
  ds_read_b64_tr_b16 a[244:245], v23 offset:4416
  ds_read_b64_tr_b16 a[246:247], v23 offset:4672
  v_exp_f32 v230, v214
  v_add_f32 v28, v28, v228
  v_add_f32 v29, v29, v229
  v_mfma_f32_32x32x16_bf16 a[160:175], a[248:251], v[244:247], a[160:175]
  ds_read_b64_tr_b16 a[248:249], v23 offset:4480
  ds_read_b64_tr_b16 a[250:251], v23 offset:4736
  v_cvt_pk_bf16_f32 v250, v228, v229
  v_exp_f32 v231, v215
  v_mfma_f32_32x32x16_bf16 a[176:191], a[252:255], v[244:247], a[176:191]
  ds_read_b64_tr_b16 a[252:253], v23 offset:4544
  ds_read_b64_tr_b16 a[254:255], v23 offset:4800
  v_exp_f32 v232, v216
  v_add_f32 v28, v28, v230
  v_add_f32 v29, v29, v231
  v_mfma_f32_32x32x16_bf16 v[192:207], a[192:195], v[128:131], v[176:191]
  v_cvt_pk_bf16_f32 v251, v230, v231
  v_exp_f32 v233, v217
  v_exp_f32 v234, v218
  v_add_f32 v28, v28, v232
  v_mfma_f32_32x32x16_bf16 v[192:207], a[196:199], v[132:135], v[192:207]
  v_add_f32 v29, v29, v233
  v_cvt_pk_bf16_f32 v252, v232, v233
  v_exp_f32 v235, v219
  v_exp_f32 v236, v220
  v_mfma_f32_32x32x16_bf16 v[192:207], a[200:203], v[136:139], v[192:207]
  v_add_f32 v28, v28, v234
  v_add_f32 v29, v29, v235
  v_cvt_pk_bf16_f32 v253, v234, v235
  v_exp_f32 v237, v221
  v_mfma_f32_32x32x16_bf16 v[192:207], a[204:207], v[140:143], v[192:207]
  v_exp_f32 v238, v222
  v_add_f32 v28, v28, v236
  v_add_f32 v29, v29, v237
  v_cvt_pk_bf16_f32 v254, v236, v237
  v_mfma_f32_32x32x16_bf16 v[192:207], a[208:211], v[144:147], v[192:207]
  v_exp_f32 v239, v223
  v_add_f32 v28, v28, v238
  v_add_f32 v29, v29, v239
  v_cvt_pk_bf16_f32 v255, v238, v239
  v_add_f32 v28, v28, v29
  v_mfma_f32_32x32x16_bf16 v[192:207], a[212:215], v[148:151], v[192:207]
  v_cmp_nle_f32 vcc, v28, v31
  s_cbranch_vccnz L_tr45
L_bk45:
  v_add_f32 v25, v25, v28
  v_mfma_f32_32x32x16_bf16 v[192:207], a[216:219], v[152:155], v[192:207]
  v_mfma_f32_32x32x16_bf16 v[192:207], a[220:223], v[156:159], v[192:207]
  s_waitcnt lgkmcnt(14)
  v_mfma_f32_32x32x16_bf16 a[0:15], a[224:227], v[248:251], a[0:15]
  s_waitcnt lgkmcnt(12)
  v_mfma_f32_32x32x16_bf16 a[16:31], a[228:231], v[248:251], a[16:31]
  v_exp_f32 v224, v192
  v_exp_f32 v225, v193
  v_exp_f32 v226, v194
  s_waitcnt lgkmcnt(10)
  v_mfma_f32_32x32x16_bf16 a[32:47], a[232:235], v[248:251], a[32:47]
  v_add_f32 v28, v224, v225
  v_cvt_pk_bf16_f32 v240, v224, v225
  v_exp_f32 v227, v195
  v_exp_f32 v228, v196
  s_waitcnt lgkmcnt(8)
  v_mfma_f32_32x32x16_bf16 a[48:63], a[236:239], v[248:251], a[48:63]
  v_add_f32 v29, v226, v227
  v_cvt_pk_bf16_f32 v241, v226, v227
  v_exp_f32 v229, v197
  v_exp_f32 v230, v198
  s_waitcnt lgkmcnt(6)
  v_mfma_f32_32x32x16_bf16 a[0:15], a[240:243], v[252:255], a[0:15]
  v_add_f32 v28, v28, v228
  v_add_f32 v29, v29, v229
  v_cvt_pk_bf16_f32 v242, v228, v229
  v_exp_f32 v231, v199
  s_waitcnt lgkmcnt(4)
  v_mfma_f32_32x32x16_bf16 a[16:31], a[244:247], v[252:255], a[16:31]
  v_exp_f32 v232, v200
  v_add_f32 v28, v28, v230
  v_add_f32 v29, v29, v231
  v_cvt_pk_bf16_f32 v243, v230, v231
  s_waitcnt lgkmcnt(2)
  v_mfma_f32_32x32x16_bf16 a[32:47], a[248:251], v[252:255], a[32:47]
  v_exp_f32 v233, v201
  v_exp_f32 v234, v202
  v_add_f32 v28, v28, v232
  v_add_f32 v29, v29, v233
  s_waitcnt lgkmcnt(0)
  v_mfma_f32_32x32x16_bf16 a[48:63], a[252:255], v[252:255], a[48:63]
  v_cvt_pk_bf16_f32 v244, v232, v233
  v_exp_f32 v235, v203
  v_mov_b32 v13, v25
  s_add_u32 s58, s9, 32768
  s_add_u32 m0, s63, 0
  s_barrier
  v_mfma_f32_32x32x16_bf16 v[208:223], a[192:195], v[64:67], v[96:111]
  buffer_load_dwordx4 v3, s[36:39], s58 offen  lds
  v_exp_f32 v236, v204
  v_add_f32 v28, v28, v234
  v_add_f32 v29, v29, v235
  v_mfma_f32_32x32x16_bf16 v[208:223], a[196:199], v[68:71], v[208:223]
  v_cvt_pk_bf16_f32 v245, v234, v235
  v_exp_f32 v237, v205
  v_exp_f32 v238, v206
  v_add_f32 v28, v28, v236
  v_mfma_f32_32x32x16_bf16 v[208:223], a[200:203], v[72:75], v[208:223]
  v_add_f32 v29, v29, v237
  v_cvt_pk_bf16_f32 v246, v236, v237
  v_exp_f32 v239, v207
  s_add_u32 s58, s10, 32768
  s_add_u32 m0, s63, 4096
  v_mfma_f32_32x32x16_bf16 v[208:223], a[204:207], v[76:79], v[208:223]
  buffer_load_dwordx4 v3, s[36:39], s58 offen  lds
  v_add_f32 v28, v28, v238
  v_add_f32 v29, v29, v239
  v_cvt_pk_bf16_f32 v247, v238, v239
  v_add_f32 v28, v28, v29
  v_mfma_f32_32x32x16_bf16 v[208:223], a[208:211], v[80:83], v[208:223]
  v_cmp_nle_f32 vcc, v28, v31
  s_cbranch_vccnz L_tr46
L_bk46:
  v_add_f32 v26, v26, v28
  v_mov_b32 v112, v25
  s_nop 1
  v_permlane32_swap_b32 v13, v112
  v_add_f32 v13, v13, v112
  v_mfma_f32_32x32x16_bf16 v[208:223], a[212:215], v[84:87], v[208:223]
  v_rcp_f32 v13, v13
  v_accvgpr_read_b32 v112, a0
  v_accvgpr_read_b32 v113, a1
  s_add_u32 s58, s11, 32768
  s_add_u32 m0, s63, 8192
  v_mfma_f32_32x32x16_bf16 v[208:223], a[216:219], v[88:91], v[208:223]
  buffer_load_dwordx4 v3, s[36:39], s58 offen  lds
  v_accvgpr_read_b32 v114, a2
  v_accvgpr_read_b32 v115, a3
  v_accvgpr_read_b32 v116, a4
  v_accvgpr_read_b32 v117, a5
  v_mfma_f32_32x32x16_bf16 v[208:223], a[220:223], v[92:95], v[208:223]
  v_accvgpr_read_b32 v118, a6
  v_accvgpr_read_b32 v119, a7
  v_mul_f32 v112, v112, v13
  v_mul_f32 v113, v113, v13
  v_mul_f32 v114, v114, v13
  v_mul_f32 v115, v115, v13
  v_mfma_f32_32x32x16_bf16 a[64:79], a[224:227], v[240:243], a[64:79]
  v_mul_f32 v116, v116, v13
  v_mul_f32 v117, v117, v13
  v_mul_f32 v118, v118, v13
  v_mul_f32 v119, v119, v13
  s_add_u32 s58, s6, 65536
  s_add_u32 m0, s63, 12288
  v_mfma_f32_32x32x16_bf16 a[80:95], a[228:231], v[240:243], a[80:95]
  buffer_load_dwordx4 v3, s[36:39], s58 offen  lds
  ds_read_b64_tr_b16 a[208:209], v6 offset:8192
  ds_read_b64_tr_b16 a[210:211], v6 offset:8704
  v_exp_f32 v224, v208
  v_mfma_f32_32x32x16_bf16 a[96:111], a[232:235], v[240:243], a[96:111]
  ds_read_b64_tr_b16 a[212:213], v6 offset:10240
  ds_read_b64_tr_b16 a[214:215], v6 offset:10752
  v_exp_f32 v225, v209
  v_exp_f32 v226, v210
  v_mfma_f32_32x32x16_bf16 a[112:127], a[236:239], v[240:243], a[112:127]
  ds_read_b64_tr_b16 a[216:217], v6 offset:12288
  ds_read_b64_tr_b16 a[218:219], v6 offset:12800
  v_add_f32 v28, v224, v225
  v_cvt_pk_bf16_f32 v248, v224, v225
  s_add_u32 s58, s7, 65536
  s_add_u32 m0, s63, 16384
  v_mfma_f32_32x32x16_bf16 a[64:79], a[240:243], v[244:247], a[64:79]
  buffer_load_dwordx4 v3, s[36:39], s58 offen  lds
  ds_read_b64_tr_b16 a[220:221], v6 offset:14336
  ds_read_b64_tr_b16 a[222:223], v6 offset:14848
  v_exp_f32 v227, v211
  v_mfma_f32_32x32x16_bf16 a[80:95], a[244:247], v[244:247], a[80:95]
  v_exp_f32 v228, v212
  v_add_f32 v29, v226, v227
  v_cvt_pk_bf16_f32 v249, v226, v227
  v_exp_f32 v229, v213
  v_mfma_f32_32x32x16_bf16 a[96:111], a[248:251], v[244:247], a[96:111]
  v_exp_f32 v230, v214
  v_add_f32 v28, v28, v228
  v_add_f32 v29, v29, v229
  s_add_u32 s58, s8, 65536
  s_add_u32 m0, s63, 20480
  v_mfma_f32_32x32x16_bf16 a[112:127], a[252:255], v[244:247], a[112:127]
  buffer_load_dwordx4 v3, s[36:39], s58 offen  lds
  v_cvt_pk_bf16_f32 v250, v228, v229
  v_exp_f32 v231, v215
  v_cvt_pk_bf16_f32 v20, v112, v113
  v_cvt_pk_bf16_f32 v21, v114, v115
  v_cvt_pk_bf16_f32 v22, v116, v117
  v_cvt_pk_bf16_f32 v23, v118, v119
  s_add_u32 s67, s77, 0
  buffer_store_dwordx4 v[20:23], v2, s[32:35], s67 offen sc1
  s_waitcnt lgkmcnt(6)
  v_mfma_f32_32x32x16_bf16 v[32:47], a[208:211], v[20:23], 0
  v_exp_f32 v232, v216
  v_add_f32 v28, v28, v230
  v_add_f32 v29, v29, v231
  v_cvt_pk_bf16_f32 v251, v230, v231
  v_accvgpr_read_b32 v112, a8
  s_waitcnt lgkmcnt(4)
  v_mfma_f32_32x32x16_bf16 v[48:63], a[212:215], v[20:23], 0
  v_exp_f32 v233, v217
  v_exp_f32 v234, v218
  s_add_u32 s58, s6, 81920
  s_add_u32 m0, s63, 24576
  s_waitcnt lgkmcnt(2)
  v_mfma_f32_32x32x16_bf16 v[128:143], a[216:219], v[20:23], 0
  buffer_load_dwordx4 v3, s[36:39], s58 offen  lds
  v_add_f32 v28, v28, v232
  v_add_f32 v29, v29, v233
  v_cvt_pk_bf16_f32 v252, v232, v233
  v_accvgpr_read_b32 v113, a9
  s_waitcnt lgkmcnt(0)
  v_mfma_f32_32x32x16_bf16 v[144:159], a[220:223], v[20:23], 0
  v_exp_f32 v235, v219
  v_exp_f32 v236, v220
  v_add_f32 v28, v28, v234
  v_add_f32 v29, v29, v235
  v_cvt_pk_bf16_f32 v253, v234, v235
  v_exp_f32 v237, v221
  v_exp_f32 v238, v222
  v_add_f32 v28, v28, v236
  v_add_f32 v29, v29, v237
  v_cvt_pk_bf16_f32 v254, v236, v237
  v_exp_f32 v239, v223
  v_add_f32 v28, v28, v238
  v_add_f32 v29, v29, v239
  v_cvt_pk_bf16_f32 v255, v238, v239
  v_add_f32 v28, v28, v29
  v_cmp_nle_f32 vcc, v28, v31
  s_cbranch_vccnz L_tr47
L_bk47:
  v_add_f32 v27, v27, v28
  v_mfma_f32_32x32x16_bf16 a[128:143], a[224:227], v[248:251], a[128:143]
  v_accvgpr_read_b32 v114, a10
  v_accvgpr_read_b32 v115, a11
  v_accvgpr_read_b32 v116, a12
  v_accvgpr_read_b32 v117, a13
  s_add_u32 s58, s7, 81920
  s_add_u32 m0, s63, 28672
  v_mfma_f32_32x32x16_bf16 a[144:159], a[228:231], v[248:251], a[144:159]
  buffer_load_dwordx4 v3, s[36:39], s58 offen  lds
  v_accvgpr_read_b32 v118, a14
  v_accvgpr_read_b32 v119, a15
  v_mul_f32 v112, v112, v13
  v_mul_f32 v113, v113, v13
  v_mfma_f32_32x32x16_bf16 a[160:175], a[232:235], v[248:251], a[160:175]
  ds_read_b64_tr_b16 a[196:197], v6 offset:16384
  ds_read_b64_tr_b16 a[198:199], v6 offset:16896
  v_mul_f32 v114, v114, v13
  v_mul_f32 v115, v115, v13
  v_mul_f32 v116, v116, v13
  v_mul_f32 v117, v117, v13
  v_mfma_f32_32x32x16_bf16 a[176:191], a[236:239], v[248:251], a[176:191]
  v_mul_f32 v118, v118, v13
  v_mul_f32 v119, v119, v13
  v_cvt_pk_bf16_f32 v120, v112, v113
  v_cvt_pk_bf16_f32 v121, v114, v115
  s_add_u32 s58, s8, 81920
  s_add_u32 m0, s63, 32768
  v_mfma_f32_32x32x16_bf16 a[128:143], a[240:243], v[252:255], a[128:143]
  buffer_load_dwordx4 v3, s[36:39], s58 offen  lds
  ds_read_b64_tr_b16 a[200:201], v6 offset:18432
  ds_read_b64_tr_b16 a[202:203], v6 offset:18944
  v_cvt_pk_bf16_f32 v122, v116, v117
  v_cvt_pk_bf16_f32 v123, v118, v119
  v_mfma_f32_32x32x16_bf16 a[144:159], a[244:247], v[252:255], a[144:159]
  s_add_u32 s67, s77, 3072
  buffer_store_dwordx4 v[120:123], v2, s[32:35], s67 offen sc1
  v_mov_b32 v14, v26
  v_mov_b32 v112, v26
  s_nop 1
  v_permlane32_swap_b32 v14, v112
  v_mfma_f32_32x32x16_bf16 a[160:175], a[248:251], v[252:255], a[160:175]
  ds_read_b64_tr_b16 a[192:193], v6 offset:20480
  ds_read_b64_tr_b16 a[194:195], v6 offset:20992
  v_add_f32 v14, v14, v112
  v_rcp_f32 v14, v14
  v_accvgpr_read_b32 v112, a64
  v_mfma_f32_32x32x16_bf16 a[176:191], a[252:255], v[252:255], a[176:191]
  v_accvgpr_read_b32 v113, a65
  v_accvgpr_read_b32 v114, a66
  v_accvgpr_read_b32 v115, a67
  v_accvgpr_read_b32 v116, a68
  v_accvgpr_read_b32 v117, a69
  v_accvgpr_read_b32 v118, a70
  v_accvgpr_read_b32 v119, a71
  v_mul_f32 v112, v112, v14
  v_mul_f32 v113, v113, v14
  v_mul_f32 v114, v114, v14
  v_mul_f32 v115, v115, v14
  v_mul_f32 v116, v116, v14
  v_mul_f32 v117, v117, v14
  v_mul_f32 v118, v118, v14
  v_mul_f32 v119, v119, v14
  v_cvt_pk_bf16_f32 v240, v112, v113
  v_cvt_pk_bf16_f32 v241, v114, v115
  v_cvt_pk_bf16_f32 v242, v116, v117
  v_cvt_pk_bf16_f32 v243, v118, v119
  s_add_u32 s67, s77, 1024
  buffer_store_dwordx4 v[240:243], v2, s[32:35], s67 offen sc1
  v_mfma_f32_32x32x16_bf16 v[64:79], a[208:211], v[240:243], 0
  v_accvgpr_read_b32 v112, a72
  v_accvgpr_read_b32 v113, a73
  v_accvgpr_read_b32 v114, a74
  v_accvgpr_read_b32 v115, a75
  v_accvgpr_read_b32 v116, a76
  v_accvgpr_read_b32 v117, a77
  v_mfma_f32_32x32x16_bf16 v[80:95], a[212:215], v[240:243], 0
  v_accvgpr_read_b32 v118, a78
  v_accvgpr_read_b32 v119, a79
  v_mul_f32 v112, v112, v14
  v_mul_f32 v113, v113, v14
  v_mul_f32 v114, v114, v14
  v_mul_f32 v115, v115, v14
  v_mfma_f32_32x32x16_bf16 v[96:111], a[216:219], v[240:243], 0
  v_mul_f32 v116, v116, v14
  v_mul_f32 v117, v117, v14
  v_mul_f32 v118, v118, v14
  v_mul_f32 v119, v119, v14
  v_cvt_pk_bf16_f32 v124, v112, v113
  v_cvt_pk_bf16_f32 v125, v114, v115
  v_mfma_f32_32x32x16_bf16 v[160:175], a[220:223], v[240:243], 0
  v_cvt_pk_bf16_f32 v126, v116, v117
  v_cvt_pk_bf16_f32 v127, v118, v119
  s_add_u32 s67, s77, 4096
  buffer_store_dwordx4 v[124:127], v2, s[32:35], s67 offen sc1
  v_mov_b32 v15, v27
  v_mov_b32 v112, v27
  s_nop 1
  v_permlane32_swap_b32 v15, v112
  v_add_f32 v15, v15, v112
  v_rcp_f32 v15, v15
  v_accvgpr_read_b32 v112, a128
  v_accvgpr_read_b32 v113, a129
  v_accvgpr_read_b32 v114, a130
  v_accvgpr_read_b32 v115, a131
  v_accvgpr_read_b32 v116, a132
  v_accvgpr_read_b32 v117, a133
  v_accvgpr_read_b32 v118, a134
  v_accvgpr_read_b32 v119, a135
  v_mul_f32 v112, v112, v15
  v_mul_f32 v113, v113, v15
  v_mul_f32 v114, v114, v15
  v_mul_f32 v115, v115, v15
  v_mul_f32 v116, v116, v15
  v_mul_f32 v117, v117, v15
  v_mul_f32 v118, v118, v15
  v_mul_f32 v119, v119, v15
  v_cvt_pk_bf16_f32 v244, v112, v113
  v_cvt_pk_bf16_f32 v245, v114, v115
  v_cvt_pk_bf16_f32 v246, v116, v117
  v_cvt_pk_bf16_f32 v247, v118, v119
  s_add_u32 s67, s77, 2048
  buffer_store_dwordx4 v[244:247], v2, s[32:35], s67 offen sc1
  v_mfma_f32_32x32x16_bf16 v[176:191], a[208:211], v[244:247], 0
  v_accvgpr_read_b32 v112, a136
  v_accvgpr_read_b32 v113, a137
  v_accvgpr_read_b32 v114, a138
  v_accvgpr_read_b32 v115, a139
  v_accvgpr_read_b32 v116, a140
  v_accvgpr_read_b32 v117, a141
  v_mfma_f32_32x32x16_bf16 v[192:207], a[212:215], v[244:247], 0
  v_accvgpr_read_b32 v118, a142
  v_accvgpr_read_b32 v119, a143
  v_mul_f32 v112, v112, v15
  v_mul_f32 v113, v113, v15
  v_mul_f32 v114, v114, v15
  v_mul_f32 v115, v115, v15
  v_mfma_f32_32x32x16_bf16 v[208:223], a[216:219], v[244:247], 0
  v_mul_f32 v116, v116, v15
  v_mul_f32 v117, v117, v15
  v_mul_f32 v118, v118, v15
  v_mul_f32 v119, v119, v15
  v_cvt_pk_bf16_f32 v24, v112, v113
  v_cvt_pk_bf16_f32 v25, v114, v115
  v_mfma_f32_32x32x16_bf16 v[224:239], a[220:223], v[244:247], 0
  v_cvt_pk_bf16_f32 v26, v116, v117
  v_cvt_pk_bf16_f32 v27, v118, v119
  s_add_u32 s67, s77, 5120
  buffer_store_dwordx4 v[24:27], v2, s[32:35], s67 offen sc1
  v_accvgpr_read_b32 v112, a16
  s_barrier
  s_waitcnt lgkmcnt(4)
  v_mfma_f32_32x32x16_bf16 v[32:47], a[196:199], v[120:123], v[32:47]
  v_accvgpr_read_b32 v113, a17
  v_accvgpr_read_b32 v114, a18
  v_accvgpr_read_b32 v115, a19
  v_accvgpr_read_b32 v116, a20
  v_accvgpr_read_b32 v117, a21
  v_accvgpr_read_b32 v118, a22
  v_mfma_f32_32x32x16_bf16 v[64:79], a[196:199], v[124:127], v[64:79]
  v_accvgpr_read_b32 v119, a23
  v_mul_f32 v112, v112, v13
  v_mul_f32 v113, v113, v13
  v_mul_f32 v114, v114, v13
  v_mul_f32 v115, v115, v13
  v_mul_f32 v116, v116, v13
  v_mfma_f32_32x32x16_bf16 v[176:191], a[196:199], v[24:27], v[176:191]
  ds_read_b64_tr_b16 a[196:197], v6 offset:22528
  ds_read_b64_tr_b16 a[198:199], v6 offset:23040
  v_mul_f32 v117, v117, v13
  v_mul_f32 v118, v118, v13
  v_mul_f32 v119, v119, v13
  v_cvt_pk_bf16_f32 v248, v112, v113
  s_waitcnt lgkmcnt(4)
  v_mfma_f32_32x32x16_bf16 v[48:63], a[200:203], v[120:123], v[48:63]
  v_cvt_pk_bf16_f32 v249, v114, v115
  v_cvt_pk_bf16_f32 v250, v116, v117
  v_cvt_pk_bf16_f32 v251, v118, v119
  s_add_u32 s67, s77, 6144
  buffer_store_dwordx4 v[248:251], v2, s[32:35], s67 offen sc1
  v_mfma_f32_32x32x16_bf16 v[80:95], a[200:203], v[124:127], v[80:95]
  v_accvgpr_read_b32 v112, a80
  v_accvgpr_read_b32 v113, a81
  v_accvgpr_read_b32 v114, a82
  v_accvgpr_read_b32 v115, a83
  v_accvgpr_read_b32 v116, a84
  v_accvgpr_read_b32 v117, a85
  v_mfma_f32_32x32x16_bf16 v[192:207], a[200:203], v[24:27], v[192:207]
  ds_read_b64_tr_b16 a[200:201], v6 offset:24576
  ds_read_b64_tr_b16 a[202:203], v6 offset:25088
  v_accvgpr_read_b32 v118, a86
  v_accvgpr_read_b32 v119, a87
  v_mul_f32 v112, v112, v14
  v_mul_f32 v113, v113, v14
  s_waitcnt lgkmcnt(4)
  v_mfma_f32_32x32x16_bf16 v[128:143], a[192:195], v[120:123], v[128:143]
  v_mul_f32 v114, v114, v14
  v_mul_f32 v115, v115, v14
  v_mul_f32 v116, v116, v14
  v_mul_f32 v117, v117, v14
  v_mul_f32 v118, v118, v14
  v_mul_f32 v119, v119, v14
  v_mfma_f32_32x32x16_bf16 v[96:111], a[192:195], v[124:127], v[96:111]
  v_cvt_pk_bf16_f32 v252, v112, v113
  v_cvt_pk_bf16_f32 v253, v114, v115
  v_cvt_pk_bf16_f32 v254, v116, v117
  v_cvt_pk_bf16_f32 v255, v118, v119
  v_mfma_f32_32x32x16_bf16 v[208:223], a[192:195], v[24:27], v[208:223]
  ds_read_b64_tr_b16 a[192:193], v6 offset:26624
  ds_read_b64_tr_b16 a[194:195], v6 offset:27136
  s_add_u32 s67, s77, 7168
  buffer_store_dwordx4 v[252:255], v2, s[32:35], s67 offen sc1
  v_accvgpr_read_b32 v112, a144
  s_waitcnt lgkmcnt(4)
  v_mfma_f32_32x32x16_bf16 v[144:159], a[196:199], v[120:123], v[144:159]
  v_accvgpr_read_b32 v113, a145
  v_accvgpr_read_b32 v114, a146
  v_accvgpr_read_b32 v115, a147
  v_accvgpr_read_b32 v116, a148
  v_accvgpr_read_b32 v117, a149
  v_accvgpr_read_b32 v118, a150
  v_mfma_f32_32x32x16_bf16 v[160:175], a[196:199], v[124:127], v[160:175]
  v_accvgpr_read_b32 v119, a151
  v_mul_f32 v112, v112, v15
  v_mul_f32 v113, v113, v15
  v_mul_f32 v114, v114, v15
  v_mul_f32 v115, v115, v15
  v_mul_f32 v116, v116, v15
  v_mfma_f32_32x32x16_bf16 v[224:239], a[196:199], v[24:27], v[224:239]
  ds_read_b64_tr_b16 a[196:197], v6 offset:28672
  ds_read_b64_tr_b16 a[198:199], v6 offset:29184
  v_mul_f32 v117, v117, v15
  v_mul_f32 v118, v118, v15
  v_mul_f32 v119, v119, v15
  v_cvt_pk_bf16_f32 v28, v112, v113
  s_waitcnt lgkmcnt(4)
  v_mfma_f32_32x32x16_bf16 v[32:47], a[200:203], v[248:251], v[32:47]
  v_cvt_pk_bf16_f32 v29, v114, v115
  v_cvt_pk_bf16_f32 v30, v116, v117
  v_cvt_pk_bf16_f32 v31, v118, v119
  s_add_u32 s67, s77, 8192
  buffer_store_dwordx4 v[28:31], v2, s[32:35], s67 offen sc1
  v_mfma_f32_32x32x16_bf16 v[64:79], a[200:203], v[252:255], v[64:79]
  v_accvgpr_read_b32 v112, a24
  v_accvgpr_read_b32 v113, a25
  v_accvgpr_read_b32 v114, a26
  v_accvgpr_read_b32 v115, a27
  v_accvgpr_read_b32 v116, a28
  v_accvgpr_read_b32 v117, a29
  v_mfma_f32_32x32x16_bf16 v[176:191], a[200:203], v[28:31], v[176:191]
  ds_read_b64_tr_b16 a[200:201], v6 offset:30720
  ds_read_b64_tr_b16 a[202:203], v6 offset:31232
  v_accvgpr_read_b32 v118, a30
  v_accvgpr_read_b32 v119, a31
  v_mul_f32 v112, v112, v13
  v_mul_f32 v113, v113, v13
  s_waitcnt lgkmcnt(4)
  v_mfma_f32_32x32x16_bf16 v[48:63], a[192:195], v[248:251], v[48:63]
  v_mul_f32 v114, v114, v13
  v_mul_f32 v115, v115, v13
  v_mul_f32 v116, v116, v13
  v_mul_f32 v117, v117, v13
  v_mul_f32 v118, v118, v13
  v_mul_f32 v119, v119, v13
  v_mfma_f32_32x32x16_bf16 v[80:95], a[192:195], v[252:255], v[80:95]
  v_cvt_pk_bf16_f32 v20, v112, v113
  v_cvt_pk_bf16_f32 v21, v114, v115
  v_cvt_pk_bf16_f32 v22, v116, v117
  v_cvt_pk_bf16_f32 v23, v118, v119
  v_mfma_f32_32x32x16_bf16 v[192:207], a[192:195], v[28:31], v[192:207]
  ds_read_b64_tr_b16 a[192:193], v5 offset:40960
  ds_read_b64_tr_b16 a[194:195], v5 offset:41472
  s_add_u32 s67, s77, 9216
  buffer_store_dwordx4 v[20:23], v2, s[32:35], s67 offen sc1
  v_accvgpr_read_b32 v112, a88
  s_waitcnt lgkmcnt(4)
  v_mfma_f32_32x32x16_bf16 v[128:143], a[196:199], v[248:251], v[128:143]
  v_accvgpr_read_b32 v113, a89
  v_accvgpr_read_b32 v114, a90
  v_accvgpr_read_b32 v115, a91
  v_accvgpr_read_b32 v116, a92
  v_accvgpr_read_b32 v117, a93
  v_accvgpr_read_b32 v118, a94
  v_mfma_f32_32x32x16_bf16 v[96:111], a[196:199], v[252:255], v[96:111]
  v_accvgpr_read_b32 v119, a95
  v_mul_f32 v112, v112, v14
  v_mul_f32 v113, v113, v14
  v_mul_f32 v114, v114, v14
  v_mul_f32 v115, v115, v14
  v_mul_f32 v116, v116, v14
  v_mfma_f32_32x32x16_bf16 v[208:223], a[196:199], v[28:31], v[208:223]
  ds_read_b64_tr_b16 a[196:197], v5 offset:43008
  ds_read_b64_tr_b16 a[198:199], v5 offset:43520
  v_mul_f32 v117, v117, v14
  v_mul_f32 v118, v118, v14
  v_mul_f32 v119, v119, v14
  v_cvt_pk_bf16_f32 v240, v112, v113
  s_waitcnt lgkmcnt(4)
  v_mfma_f32_32x32x16_bf16 v[144:159], a[200:203], v[248:251], v[144:159]
  v_cvt_pk_bf16_f32 v241, v114, v115
  v_cvt_pk_bf16_f32 v242, v116, v117
  v_cvt_pk_bf16_f32 v243, v118, v119
  s_add_u32 s67, s77, 10240
  buffer_store_dwordx4 v[240:243], v2, s[32:35], s67 offen sc1
  v_mfma_f32_32x32x16_bf16 v[160:175], a[200:203], v[252:255], v[160:175]
  v_accvgpr_read_b32 v112, a152
  v_accvgpr_read_b32 v113, a153
  v_accvgpr_read_b32 v114, a154
  v_accvgpr_read_b32 v115, a155
  v_accvgpr_read_b32 v116, a156
  v_accvgpr_read_b32 v117, a157
  v_mfma_f32_32x32x16_bf16 v[224:239], a[200:203], v[28:31], v[224:239]
  ds_read_b64_tr_b16 a[200:201], v5 offset:45056
  ds_read_b64_tr_b16 a[202:203], v5 offset:45568
  v_accvgpr_read_b32 v118, a158
  v_accvgpr_read_b32 v119, a159
  v_mul_f32 v112, v112, v15
  v_mul_f32 v113, v113, v15
  s_barrier
  s_waitcnt lgkmcnt(4)
  v_mfma_f32_32x32x16_bf16 v[32:47], a[192:195], v[20:23], v[32:47]
  v_mul_f32 v114, v114, v15
  v_mul_f32 v115, v115, v15
  v_mul_f32 v116, v116, v15
  v_mul_f32 v117, v117, v15
  v_mul_f32 v118, v118, v15
  v_mul_f32 v119, v119, v15
  v_mfma_f32_32x32x16_bf16 v[64:79], a[192:195], v[240:243], v[64:79]
  v_cvt_pk_bf16_f32 v244, v112, v113
  v_cvt_pk_bf16_f32 v245, v114, v115
  v_cvt_pk_bf16_f32 v246, v116, v117
  v_cvt_pk_bf16_f32 v247, v118, v119
  s_add_u32 s67, s77, 11264
  buffer_store_dwordx4 v[244:247], v2, s[32:35], s67 offen sc1
  v_mfma_f32_32x32x16_bf16 v[176:191], a[192:195], v[244:247], v[176:191]
  ds_read_b64_tr_b16 a[192:193], v5 offset:47104
  ds_read_b64_tr_b16 a[194:195], v5 offset:47616
  v_accvgpr_read_b32 v112, a32
  v_accvgpr_read_b32 v113, a33
  v_accvgpr_read_b32 v114, a34
  v_accvgpr_read_b32 v115, a35
  s_waitcnt lgkmcnt(4)
  v_mfma_f32_32x32x16_bf16 v[48:63], a[196:199], v[20:23], v[48:63]
  v_accvgpr_read_b32 v116, a36
  v_accvgpr_read_b32 v117, a37
  v_accvgpr_read_b32 v118, a38
  v_accvgpr_read_b32 v119, a39
  v_mul_f32 v112, v112, v13
  v_mul_f32 v113, v113, v13
  v_mfma_f32_32x32x16_bf16 v[80:95], a[196:199], v[240:243], v[80:95]
  v_mul_f32 v114, v114, v13
  v_mul_f32 v115, v115, v13
  v_mul_f32 v116, v116, v13
  v_mul_f32 v117, v117, v13
  v_mul_f32 v118, v118, v13
  v_mul_f32 v119, v119, v13
  v_mfma_f32_32x32x16_bf16 v[192:207], a[196:199], v[244:247], v[192:207]
  ds_read_b64_tr_b16 a[196:197], v5 offset:49152
  ds_read_b64_tr_b16 a[198:199], v5 offset:49664
  v_cvt_pk_bf16_f32 v120, v112, v113
  v_cvt_pk_bf16_f32 v121, v114, v115
  v_cvt_pk_bf16_f32 v122, v116, v117
  v_cvt_pk_bf16_f32 v123, v118, v119
  s_waitcnt lgkmcnt(4)
  v_mfma_f32_32x32x16_bf16 v[128:143], a[200:203], v[20:23], v[128:143]
  s_add_u32 s67, s77, 12288
  buffer_store_dwordx4 v[120:123], v2, s[32:35], s67 offen sc1
  v_accvgpr_read_b32 v112, a96
  v_accvgpr_read_b32 v113, a97
  v_accvgpr_read_b32 v114, a98
  v_mfma_f32_32x32x16_bf16 v[96:111], a[200:203], v[240:243], v[96:111]
  v_accvgpr_read_b32 v115, a99
  v_accvgpr_read_b32 v116, a100
  v_accvgpr_read_b32 v117, a101
  v_accvgpr_read_b32 v118, a102
  v_accvgpr_read_b32 v119, a103
  v_mul_f32 v112, v112, v14
  v_mfma_f32_32x32x16_bf16 v[208:223], a[200:203], v[244:247], v[208:223]
  ds_read_b64_tr_b16 a[200:201], v5 offset:51200
  ds_read_b64_tr_b16 a[202:203], v5 offset:51712
  v_mul_f32 v113, v113, v14
  v_mul_f32 v114, v114, v14
  v_mul_f32 v115, v115, v14
  v_mul_f32 v116, v116, v14
  s_waitcnt lgkmcnt(4)
  v_mfma_f32_32x32x16_bf16 v[144:159], a[192:195], v[20:23], v[144:159]
  v_mul_f32 v117, v117, v14
  v_mul_f32 v118, v118, v14
  v_mul_f32 v119, v119, v14
  v_cvt_pk_bf16_f32 v124, v112, v113
  v_cvt_pk_bf16_f32 v125, v114, v115
  v_cvt_pk_bf16_f32 v126, v116, v117
  v_mfma_f32_32x32x16_bf16 v[160:175], a[192:195], v[240:243], v[160:175]
  v_cvt_pk_bf16_f32 v127, v118, v119
  s_add_u32 s67, s77, 13312
  buffer_store_dwordx4 v[124:127], v2, s[32:35], s67 offen sc1
  v_accvgpr_read_b32 v112, a160
  v_accvgpr_read_b32 v113, a161
  v_mfma_f32_32x32x16_bf16 v[224:239], a[192:195], v[244:247], v[224:239]
  ds_read_b64_tr_b16 a[192:193], v5 offset:53248
  ds_read_b64_tr_b16 a[194:195], v5 offset:53760
  v_accvgpr_read_b32 v114, a162
  v_accvgpr_read_b32 v115, a163
  v_accvgpr_read_b32 v116, a164
  v_accvgpr_read_b32 v117, a165
  s_waitcnt lgkmcnt(4)
  v_mfma_f32_32x32x16_bf16 v[32:47], a[196:199], v[120:123], v[32:47]
  v_accvgpr_read_b32 v118, a166
  v_accvgpr_read_b32 v119, a167
  v_mul_f32 v112, v112, v15
  v_mul_f32 v113, v113, v15
  v_mul_f32 v114, v114, v15
  v_mul_f32 v115, v115, v15
  v_mfma_f32_32x32x16_bf16 v[64:79], a[196:199], v[124:127], v[64:79]
  v_mul_f32 v116, v116, v15
  v_mul_f32 v117, v117, v15
  v_mul_f32 v118, v118, v15
  v_mul_f32 v119, v119, v15
  v_cvt_pk_bf16_f32 v24, v112, v113
  v_cvt_pk_bf16_f32 v25, v114, v115
  v_cvt_pk_bf16_f32 v26, v116, v117
  v_cvt_pk_bf16_f32 v27, v118, v119
  s_add_u32 s67, s77, 14336
  buffer_store_dwordx4 v[24:27], v2, s[32:35], s67 offen sc1
  v_mfma_f32_32x32x16_bf16 v[176:191], a[196:199], v[24:27], v[176:191]
  ds_read_b64_tr_b16 a[196:197], v5 offset:55296
  ds_read_b64_tr_b16 a[198:199], v5 offset:55808
  v_accvgpr_read_b32 v112, a40
  v_accvgpr_read_b32 v113, a41
  v_accvgpr_read_b32 v114, a42
  v_accvgpr_read_b32 v115, a43
  s_waitcnt vmcnt(3)
  v_mov_b32 v7, 4
  s_waitcnt lgkmcnt(4)
  v_mfma_f32_32x32x16_bf16 v[48:63], a[200:203], v[120:123], v[48:63]
  buffer_store_dword v7, v2, s[44:47], s75 offen sc1
  v_accvgpr_read_b32 v116, a44
  v_accvgpr_read_b32 v117, a45
  v_accvgpr_read_b32 v118, a46
  v_accvgpr_read_b32 v119, a47
  v_mul_f32 v112, v112, v13
  v_mul_f32 v113, v113, v13
  v_mfma_f32_32x32x16_bf16 v[80:95], a[200:203], v[124:127], v[80:95]
  v_mul_f32 v114, v114, v13
  v_mul_f32 v115, v115, v13
  v_mul_f32 v116, v116, v13
  v_mul_f32 v117, v117, v13
  v_mul_f32 v118, v118, v13
  v_mul_f32 v119, v119, v13
  v_mfma_f32_32x32x16_bf16 v[192:207], a[200:203], v[24:27], v[192:207]
  ds_read_b64_tr_b16 a[200:201], v5 offset:57344
  ds_read_b64_tr_b16 a[202:203], v5 offset:57856
  v_cvt_pk_bf16_f32 v248, v112, v113
  v_cvt_pk_bf16_f32 v249, v114, v115
  v_cvt_pk_bf16_f32 v250, v116, v117
  v_cvt_pk_bf16_f32 v251, v118, v119
  s_waitcnt lgkmcnt(4)
  v_mfma_f32_32x32x16_bf16 v[128:143], a[192:195], v[120:123], v[128:143]
  v_accvgpr_read_b32 v112, a104
  v_accvgpr_read_b32 v113, a105
  v_accvgpr_read_b32 v114, a106
  v_accvgpr_read_b32 v115, a107
  v_accvgpr_read_b32 v116, a108
  v_accvgpr_read_b32 v117, a109
  v_mfma_f32_32x32x16_bf16 v[96:111], a[192:195], v[124:127], v[96:111]
  v_accvgpr_read_b32 v118, a110
  v_accvgpr_read_b32 v119, a111
  v_mul_f32 v112, v112, v14
  v_mul_f32 v113, v113, v14
  v_mul_f32 v114, v114, v14
  v_mul_f32 v115, v115, v14
  v_mfma_f32_32x32x16_bf16 v[208:223], a[192:195], v[24:27], v[208:223]
  ds_read_b64_tr_b16 a[192:193], v5 offset:59392
  ds_read_b64_tr_b16 a[194:195], v5 offset:59904
  v_mul_f32 v116, v116, v14
  v_mul_f32 v117, v117, v14
  v_mul_f32 v118, v118, v14
  v_mul_f32 v119, v119, v14
  s_waitcnt lgkmcnt(4)
  v_mfma_f32_32x32x16_bf16 v[144:159], a[196:199], v[120:123], v[144:159]
  v_cvt_pk_bf16_f32 v252, v112, v113
  v_cvt_pk_bf16_f32 v253, v114, v115
  v_cvt_pk_bf16_f32 v254, v116, v117
  v_cvt_pk_bf16_f32 v255, v118, v119
  v_accvgpr_read_b32 v112, a168
  v_accvgpr_read_b32 v113, a169
  v_mfma_f32_32x32x16_bf16 v[160:175], a[196:199], v[124:127], v[160:175]
  v_accvgpr_read_b32 v114, a170
  v_accvgpr_read_b32 v115, a171
  v_accvgpr_read_b32 v116, a172
  v_accvgpr_read_b32 v117, a173
  v_accvgpr_read_b32 v118, a174
  v_accvgpr_read_b32 v119, a175
  v_mfma_f32_32x32x16_bf16 v[224:239], a[196:199], v[24:27], v[224:239]
  ds_read_b64_tr_b16 a[196:197], v5 offset:61440
  ds_read_b64_tr_b16 a[198:199], v5 offset:61952
  v_mul_f32 v112, v112, v15
  v_mul_f32 v113, v113, v15
  v_mul_f32 v114, v114, v15
  v_mul_f32 v115, v115, v15
  s_barrier
  s_waitcnt lgkmcnt(4)
  v_mfma_f32_32x32x16_bf16 v[32:47], a[200:203], v[248:251], v[32:47]
  v_mul_f32 v116, v116, v15
  v_mul_f32 v117, v117, v15
  v_mul_f32 v118, v118, v15
  v_mul_f32 v119, v119, v15
  v_cvt_pk_bf16_f32 v28, v112, v113
  v_cvt_pk_bf16_f32 v29, v114, v115
  v_mfma_f32_32x32x16_bf16 v[64:79], a[200:203], v[252:255], v[64:79]
  v_cvt_pk_bf16_f32 v30, v116, v117
  v_cvt_pk_bf16_f32 v31, v118, v119
  v_accvgpr_read_b32 v112, a48
  v_accvgpr_read_b32 v113, a49
  v_accvgpr_read_b32 v114, a50
  v_accvgpr_read_b32 v115, a51
  v_mfma_f32_32x32x16_bf16 v[176:191], a[200:203], v[28:31], v[176:191]
  ds_read_b64_tr_b16 a[200:201], v5 offset:63488
  ds_read_b64_tr_b16 a[202:203], v5 offset:64000
  v_accvgpr_read_b32 v116, a52
  v_accvgpr_read_b32 v117, a53
  v_accvgpr_read_b32 v118, a54
  v_accvgpr_read_b32 v119, a55
  s_waitcnt lgkmcnt(4)
  v_mfma_f32_32x32x16_bf16 v[48:63], a[192:195], v[248:251], v[48:63]
  v_mul_f32 v112, v112, v13
  v_mul_f32 v113, v113, v13
  v_mul_f32 v114, v114, v13
  v_mul_f32 v115, v115, v13
  v_mul_f32 v116, v116, v13
  v_mul_f32 v117, v117, v13
  v_mfma_f32_32x32x16_bf16 v[80:95], a[192:195], v[252:255], v[80:95]
  v_mul_f32 v118, v118, v13
  v_mul_f32 v119, v119, v13
  v_cvt_pk_bf16_f32 v20, v112, v113
  v_cvt_pk_bf16_f32 v21, v114, v115
  v_cvt_pk_bf16_f32 v22, v116, v117
  v_cvt_pk_bf16_f32 v23, v118, v119
  v_mfma_f32_32x32x16_bf16 v[192:207], a[192:195], v[28:31], v[192:207]
  ds_read_b64_tr_b16 a[192:193], v6 offset:0
  ds_read_b64_tr_b16 a[194:195], v6 offset:512
  v_accvgpr_read_b32 v112, a112
  v_accvgpr_read_b32 v113, a113
  v_accvgpr_read_b32 v114, a114
  v_accvgpr_read_b32 v115, a115
  s_waitcnt lgkmcnt(4)
  v_mfma_f32_32x32x16_bf16 v[128:143], a[196:199], v[248:251], v[128:143]
  v_accvgpr_read_b32 v116, a116
  v_accvgpr_read_b32 v117, a117
  v_accvgpr_read_b32 v118, a118
  v_accvgpr_read_b32 v119, a119
  v_mul_f32 v112, v112, v14
  v_mul_f32 v113, v113, v14
  v_mfma_f32_32x32x16_bf16 v[96:111], a[196:199], v[252:255], v[96:111]
  v_mul_f32 v114, v114, v14
  v_mul_f32 v115, v115, v14
  v_mul_f32 v116, v116, v14
  v_mul_f32 v117, v117, v14
  v_mul_f32 v118, v118, v14
  v_mul_f32 v119, v119, v14
  v_mfma_f32_32x32x16_bf16 v[208:223], a[196:199], v[28:31], v[208:223]
  ds_read_b64_tr_b16 a[196:197], v6 offset:2048
  ds_read_b64_tr_b16 a[198:199], v6 offset:2560
  v_cvt_pk_bf16_f32 v240, v112, v113
  v_cvt_pk_bf16_f32 v241, v114, v115
  v_cvt_pk_bf16_f32 v242, v116, v117
  v_cvt_pk_bf16_f32 v243, v118, v119
  s_waitcnt lgkmcnt(4)
  v_mfma_f32_32x32x16_bf16 v[144:159], a[200:203], v[248:251], v[144:159]
  v_accvgpr_read_b32 v112, a176
  v_accvgpr_read_b32 v113, a177
  v_accvgpr_read_b32 v114, a178
  v_accvgpr_read_b32 v115, a179
  v_accvgpr_read_b32 v116, a180
  v_accvgpr_read_b32 v117, a181
  v_mfma_f32_32x32x16_bf16 v[160:175], a[200:203], v[252:255], v[160:175]
  v_accvgpr_read_b32 v118, a182
  v_accvgpr_read_b32 v119, a183
  v_mul_f32 v112, v112, v15
  v_mul_f32 v113, v113, v15
  v_mul_f32 v114, v114, v15
  v_mul_f32 v115, v115, v15
  v_mfma_f32_32x32x16_bf16 v[224:239], a[200:203], v[28:31], v[224:239]
  ds_read_b64_tr_b16 a[200:201], v6 offset:4096
  ds_read_b64_tr_b16 a[202:203], v6 offset:4608
  v_mul_f32 v116, v116, v15
  v_mul_f32 v117, v117, v15
  v_mul_f32 v118, v118, v15
  v_mul_f32 v119, v119, v15
  s_waitcnt lgkmcnt(4)
  v_mfma_f32_32x32x16_bf16 v[32:47], a[192:195], v[20:23], v[32:47]
  v_cvt_pk_bf16_f32 v244, v112, v113
  v_cvt_pk_bf16_f32 v245, v114, v115
  v_cvt_pk_bf16_f32 v246, v116, v117
  v_cvt_pk_bf16_f32 v247, v118, v119
  v_accvgpr_read_b32 v112, a56
  v_accvgpr_read_b32 v113, a57
  v_mfma_f32_32x32x16_bf16 v[64:79], a[192:195], v[240:243], v[64:79]
  v_accvgpr_read_b32 v114, a58
  v_accvgpr_read_b32 v115, a59
  v_accvgpr_read_b32 v116, a60
  v_accvgpr_read_b32 v117, a61
  v_accvgpr_read_b32 v118, a62
  v_accvgpr_read_b32 v119, a63
  v_mfma_f32_32x32x16_bf16 v[176:191], a[192:195], v[244:247], v[176:191]
  ds_read_b64_tr_b16 a[192:193], v6 offset:6144
  ds_read_b64_tr_b16 a[194:195], v6 offset:6656
  v_mul_f32 v112, v112, v13
  v_mul_f32 v113, v113, v13
  v_mul_f32 v114, v114, v13
  v_mul_f32 v115, v115, v13
  s_waitcnt lgkmcnt(4)
  v_mfma_f32_32x32x16_bf16 v[48:63], a[196:199], v[20:23], v[48:63]
  v_mul_f32 v116, v116, v13
  v_mul_f32 v117, v117, v13
  v_mul_f32 v118, v118, v13
  v_mul_f32 v119, v119, v13
  v_cvt_pk_bf16_f32 v120, v112, v113
  v_cvt_pk_bf16_f32 v121, v114, v115
  v_mfma_f32_32x32x16_bf16 v[80:95], a[196:199], v[240:243], v[80:95]
  v_cvt_pk_bf16_f32 v122, v116, v117
  v_cvt_pk_bf16_f32 v123, v118, v119
  v_accvgpr_read_b32 v112, a120
  v_accvgpr_read_b32 v113, a121
  v_accvgpr_read_b32 v114, a122
  v_accvgpr_read_b32 v115, a123
  v_mfma_f32_32x32x16_bf16 v[192:207], a[196:199], v[244:247], v[192:207]
  ds_read_b64_tr_b16 a[196:197], v5 offset:0
  ds_read_b64_tr_b16 a[198:199], v5 offset:512
  v_accvgpr_read_b32 v116, a124
  v_accvgpr_read_b32 v117, a125
  v_accvgpr_read_b32 v118, a126
  v_accvgpr_read_b32 v119, a127
  s_waitcnt lgkmcnt(4)
  v_mfma_f32_32x32x16_bf16 v[128:143], a[200:203], v[20:23], v[128:143]
  v_mul_f32 v112, v112, v14
  v_mul_f32 v113, v113, v14
  v_mul_f32 v114, v114, v14
  v_mul_f32 v115, v115, v14
  v_mul_f32 v116, v116, v14
  v_mul_f32 v117, v117, v14
  v_mfma_f32_32x32x16_bf16 v[96:111], a[200:203], v[240:243], v[96:111]
  v_mul_f32 v118, v118, v14
  v_mul_f32 v119, v119, v14
  v_cvt_pk_bf16_f32 v124, v112, v113
  v_cvt_pk_bf16_f32 v125, v114, v115
  v_cvt_pk_bf16_f32 v126, v116, v117
  v_cvt_pk_bf16_f32 v127, v118, v119
  v_mfma_f32_32x32x16_bf16 v[208:223], a[200:203], v[244:247], v[208:223]
  buffer_load_dwordx4 v[8:11], off, s[44:47], 0 sc1
  ds_read_b64_tr_b16 a[200:201], v5 offset:2048
  ds_read_b64_tr_b16 a[202:203], v5 offset:2560
  v_accvgpr_read_b32 v112, a184
  v_accvgpr_read_b32 v113, a185
  v_accvgpr_read_b32 v114, a186
  v_accvgpr_read_b32 v115, a187
  s_waitcnt lgkmcnt(4)
  v_mfma_f32_32x32x16_bf16 v[144:159], a[192:195], v[20:23], v[144:159]
  v_accvgpr_read_b32 v116, a188
  v_accvgpr_read_b32 v117, a189
  v_accvgpr_read_b32 v118, a190
  v_accvgpr_read_b32 v119, a191
  v_mul_f32 v112, v112, v15
  v_mul_f32 v113, v113, v15
  v_mfma_f32_32x32x16_bf16 v[160:175], a[192:195], v[240:243], v[160:175]
  v_mul_f32 v114, v114, v15
  v_mul_f32 v115, v115, v15
  v_mul_f32 v116, v116, v15
  v_mul_f32 v117, v117, v15
  v_mul_f32 v118, v118, v15
  v_mul_f32 v119, v119, v15
  v_mfma_f32_32x32x16_bf16 v[224:239], a[192:195], v[244:247], v[224:239]
  ds_read_b64_tr_b16 a[192:193], v4 offset:61440
  ds_read_b64_tr_b16 a[194:195], v4 offset:61952
  v_cvt_pk_bf16_f32 v24, v112, v113
  v_cvt_pk_bf16_f32 v25, v114, v115
  v_cvt_pk_bf16_f32 v26, v116, v117
  v_cvt_pk_bf16_f32 v27, v118, v119
  s_barrier
  s_waitcnt lgkmcnt(4)
  v_mfma_f32_32x32x16_bf16 v[32:47], a[196:199], v[120:123], v[32:47]
  v_mfma_f32_32x32x16_bf16 v[64:79], a[196:199], v[124:127], v[64:79]
  v_mfma_f32_32x32x16_bf16 v[176:191], a[196:199], v[24:27], v[176:191]
  ds_read_b64_tr_b16 a[196:197], v4 offset:63488
  ds_read_b64_tr_b16 a[198:199], v4 offset:64000
  s_waitcnt lgkmcnt(4)
  v_mfma_f32_32x32x16_bf16 v[48:63], a[200:203], v[120:123], v[48:63]
  v_mfma_f32_32x32x16_bf16 v[80:95], a[200:203], v[124:127], v[80:95]
  v_mfma_f32_32x32x16_bf16 v[192:207], a[200:203], v[24:27], v[192:207]
  ds_read_b64_tr_b16 a[200:201], v4 offset:57344
  ds_read_b64_tr_b16 a[202:203], v4 offset:57856
  s_waitcnt lgkmcnt(4)
  v_mfma_f32_32x32x16_bf16 v[128:143], a[192:195], v[120:123], v[128:143]
  v_mfma_f32_32x32x16_bf16 v[96:111], a[192:195], v[124:127], v[96:111]
  v_mfma_f32_32x32x16_bf16 v[208:223], a[192:195], v[24:27], v[208:223]
  ds_read_b64_tr_b16 a[192:193], v4 offset:59392
  ds_read_b64_tr_b16 a[194:195], v4 offset:59904
  s_waitcnt lgkmcnt(4)
  v_mfma_f32_32x32x16_bf16 v[144:159], a[196:199], v[120:123], v[144:159]
  v_mfma_f32_32x32x16_bf16 v[160:175], a[196:199], v[124:127], v[160:175]
  v_mfma_f32_32x32x16_bf16 v[224:239], a[196:199], v[24:27], v[224:239]
  ds_read_b64_tr_b16 a[196:197], v4 offset:53248
  ds_read_b64_tr_b16 a[198:199], v4 offset:53760
  s_waitcnt vmcnt(0)
  v_min3_u32 v8, v8, v9, v10
  v_min_u32 v8, v8, v11
  v_cmp_gt_u32 vcc, 4, v8
  s_cbranch_vccnz L_sp_f0
L_sb_f0:
  s_add_u32 s59, s78, 0
  buffer_load_dwordx4 a[204:207], v2, s[32:35], s59 offen offset:0 sc1
  buffer_load_dwordx4 a[208:211], v2, s[32:35], s59 offen offset:1024 sc1
  buffer_load_dwordx4 a[212:215], v2, s[32:35], s59 offen offset:2048 sc1
  s_add_u32 s59, s79, 0
  buffer_load_dwordx4 a[216:219], v2, s[32:35], s59 offen offset:0 sc1
  buffer_load_dwordx4 a[220:223], v2, s[32:35], s59 offen offset:1024 sc1
  buffer_load_dwordx4 a[224:227], v2, s[32:35], s59 offen offset:2048 sc1
  s_add_u32 s59, s17, 0
  buffer_load_dwordx4 a[228:231], v2, s[32:35], s59 offen offset:0 sc1
  buffer_load_dwordx4 a[232:235], v2, s[32:35], s59 offen offset:1024 sc1
  buffer_load_dwordx4 a[236:239], v2, s[32:35], s59 offen offset:2048 sc1
  s_add_u32 s67, s77, 15360
  buffer_store_dwordx4 v[248:251], v2, s[32:35], s67 offen sc1
  s_add_u32 s67, s77, 16384
  buffer_store_dwordx4 v[252:255], v2, s[32:35], s67 offen sc1
  s_add_u32 s67, s77, 17408
  buffer_store_dwordx4 v[28:31], v2, s[32:35], s67 offen sc1
  s_add_u32 s67, s77, 18432
  buffer_store_dwordx4 v[20:23], v2, s[32:35], s67 offen sc1
  s_add_u32 s67, s77, 19456
  buffer_store_dwordx4 v[240:243], v2, s[32:35], s67 offen sc1
  s_add_u32 s67, s77, 20480
  buffer_store_dwordx4 v[244:247], v2, s[32:35], s67 offen sc1
  s_add_u32 s67, s77, 21504
  buffer_store_dwordx4 v[120:123], v2, s[32:35], s67 offen sc1
  s_add_u32 s67, s77, 22528
  buffer_store_dwordx4 v[124:127], v2, s[32:35], s67 offen sc1
  s_add_u32 s67, s77, 23552
  buffer_store_dwordx4 v[24:27], v2, s[32:35], s67 offen sc1
  s_waitcnt vmcnt(17) lgkmcnt(4)
  v_mfma_f32_32x32x16_bf16 v[32:47], a[200:203], a[204:207], v[32:47]
  s_add_u32 s59, s78, 3072
  s_waitcnt vmcnt(16)
  v_mfma_f32_32x32x16_bf16 v[64:79], a[200:203], a[208:211], v[64:79]
  buffer_load_dwordx4 a[240:243], v2, s[32:35], s59 offen offset:0 sc1
  s_waitcnt vmcnt(16)
  v_mfma_f32_32x32x16_bf16 v[176:191], a[200:203], a[212:215], v[176:191]
  buffer_load_dwordx4 a[244:247], v2, s[32:35], s59 offen offset:1024 sc1
  ds_read_b64_tr_b16 a[200:201], v4 offset:55296
  ds_read_b64_tr_b16 a[202:203], v4 offset:55808
  s_waitcnt lgkmcnt(4)
  v_mfma_f32_32x32x16_bf16 v[48:63], a[192:195], a[204:207], v[48:63]
  buffer_load_dwordx4 a[248:251], v2, s[32:35], s59 offen offset:2048 sc1
  v_mfma_f32_32x32x16_bf16 v[80:95], a[192:195], a[208:211], v[80:95]
  s_add_u32 s59, s79, 3072
  v_mfma_f32_32x32x16_bf16 v[192:207], a[192:195], a[212:215], v[192:207]
  buffer_load_dwordx4 a[252:255], v2, s[32:35], s59 offen offset:0 sc1
  ds_read_b64_tr_b16 a[192:193], v4 offset:49152
  ds_read_b64_tr_b16 a[194:195], v4 offset:49664
  s_waitcnt vmcnt(18) lgkmcnt(4)
  v_mfma_f32_32x32x16_bf16 v[32:47], a[196:199], a[216:219], v[32:47]
  s_waitcnt vmcnt(17)
  v_mfma_f32_32x32x16_bf16 v[64:79], a[196:199], a[220:223], v[64:79]
  buffer_load_dwordx4 a[0:3], v2, s[32:35], s59 offen offset:1024 sc1
  s_waitcnt vmcnt(17)
  v_mfma_f32_32x32x16_bf16 v[176:191], a[196:199], a[224:227], v[176:191]
  buffer_load_dwordx4 a[4:7], v2, s[32:35], s59 offen offset:2048 sc1
  ds_read_b64_tr_b16 a[196:197], v4 offset:51200
  ds_read_b64_tr_b16 a[198:199], v4 offset:51712
  s_waitcnt lgkmcnt(4)
  v_mfma_f32_32x32x16_bf16 v[48:63], a[200:203], a[216:219], v[48:63]
  s_add_u32 s59, s17, 3072
  v_mfma_f32_32x32x16_bf16 v[80:95], a[200:203], a[220:223], v[80:95]
  buffer_load_dwordx4 a[64:67], v2, s[32:35], s59 offen offset:0 sc1
  v_mfma_f32_32x32x16_bf16 v[192:207], a[200:203], a[224:227], v[192:207]
  ds_read_b64_tr_b16 a[200:201], v4 offset:45056
  ds_read_b64_tr_b16 a[202:203], v4 offset:45568
  s_barrier
  s_waitcnt vmcnt(18) lgkmcnt(4)
  v_mfma_f32_32x32x16_bf16 v[32:47], a[192:195], a[228:231], v[32:47]
  buffer_load_dwordx4 a[68:71], v2, s[32:35], s59 offen offset:1024 sc1
  s_waitcnt vmcnt(18)
  v_mfma_f32_32x32x16_bf16 v[64:79], a[192:195], a[232:235], v[64:79]
  s_waitcnt vmcnt(17)
  v_mfma_f32_32x32x16_bf16 v[176:191], a[192:195], a[236:239], v[176:191]
  buffer_load_dwordx4 a[128:131], v2, s[32:35], s59 offen offset:2048 sc1
  ds_read_b64_tr_b16 a[192:193], v4 offset:47104
  ds_read_b64_tr_b16 a[194:195], v4 offset:47616
  s_waitcnt lgkmcnt(4)
  v_mfma_f32_32x32x16_bf16 v[48:63], a[196:199], a[228:231], v[48:63]
  v_mfma_f32_32x32x16_bf16 v[80:95], a[196:199], a[232:235], v[80:95]
  v_mfma_f32_32x32x16_bf16 v[192:207], a[196:199], a[236:239], v[192:207]
  ds_read_b64_tr_b16 a[196:197], v4 offset:40960
  ds_read_b64_tr_b16 a[198:199], v4 offset:41472
  s_waitcnt vmcnt(8) lgkmcnt(4)
  v_mfma_f32_32x32x16_bf16 v[32:47], a[200:203], a[240:243], v[32:47]
  s_waitcnt vmcnt(7)
  v_mfma_f32_32x32x16_bf16 v[64:79], a[200:203], a[244:247], v[64:79]
  s_waitcnt vmcnt(6)
  v_mfma_f32_32x32x16_bf16 v[176:191], a[200:203], a[248:251], v[176:191]
  ds_read_b64_tr_b16 a[200:201], v4 offset:43008
  ds_read_b64_tr_b16 a[202:203], v4 offset:43520
  s_waitcnt lgkmcnt(4)
  v_mfma_f32_32x32x16_bf16 v[48:63], a[192:195], a[240:243], v[48:63]
  v_mov_b32 v7, 8
  v_mfma_f32_32x32x16_bf16 v[80:95], a[192:195], a[244:247], v[80:95]
  buffer_store_dword v7, v2, s[44:47], s75 offen sc1
L_seg1:
  s_add_u32 s59, s78, 6144
  v_mfma_f32_32x32x16_bf16 v[192:207], a[192:195], a[248:251], v[192:207]
  buffer_load_dwordx4 a[132:135], v2, s[32:35], s59 offen offset:0 sc1
  ds_read_b64_tr_b16 a[192:193], v4 offset:36864
  ds_read_b64_tr_b16 a[194:195], v4 offset:37376
  s_waitcnt vmcnt(7) lgkmcnt(4)
  v_mfma_f32_32x32x16_bf16 v[32:47], a[196:199], a[252:255], v[32:47]
  s_waitcnt vmcnt(6)
  v_mfma_f32_32x32x16_bf16 v[64:79], a[196:199], a[0:3], v[64:79]
  buffer_load_dwordx4 a[8:11], v2, s[32:35], s59 offen offset:1024 sc1
  s_waitcnt vmcnt(6)
  v_mfma_f32_32x32x16_bf16 v[176:191], a[196:199], a[4:7], v[176:191]
  ds_read_b64_tr_b16 a[196:197], v4 offset:38912
  ds_read_b64_tr_b16 a[198:199], v4 offset:39424
  s_waitcnt lgkmcnt(4)
  v_mfma_f32_32x32x16_bf16 v[48:63], a[200:203], a[252:255], v[48:63]
  buffer_load_dwordx4 a[12:15], v2, s[32:35], s59 offen offset:2048 sc1
  v_mfma_f32_32x32x16_bf16 v[80:95], a[200:203], a[0:3], v[80:95]
  s_add_u32 s59, s79, 6144
  v_mfma_f32_32x32x16_bf16 v[192:207], a[200:203], a[4:7], v[192:207]
  buffer_load_dwordx4 a[72:75], v2, s[32:35], s59 offen offset:0 sc1
  ds_read_b64_tr_b16 a[200:201], v5 offset:4096
  ds_read_b64_tr_b16 a[202:203], v5 offset:4608
  s_waitcnt vmcnt(7) lgkmcnt(4)
  v_mfma_f32_32x32x16_bf16 v[32:47], a[192:195], a[64:67], v[32:47]
  s_waitcnt vmcnt(6)
  v_mfma_f32_32x32x16_bf16 v[64:79], a[192:195], a[68:71], v[64:79]
  buffer_load_dwordx4 a[76:79], v2, s[32:35], s59 offen offset:1024 sc1
  s_waitcnt vmcnt(6)
  v_mfma_f32_32x32x16_bf16 v[176:191], a[192:195], a[128:131], v[176:191]
  ds_read_b64_tr_b16 a[192:193], v5 offset:6144
  ds_read_b64_tr_b16 a[194:195], v5 offset:6656
  s_waitcnt lgkmcnt(4)
  v_mfma_f32_32x32x16_bf16 v[48:63], a[196:199], a[64:67], v[48:63]
  v_mfma_f32_32x32x16_bf16 v[80:95], a[196:199], a[68:71], v[80:95]
  buffer_load_dwordx4 a[136:139], v2, s[32:35], s59 offen offset:2048 sc1
  v_mfma_f32_32x32x16_bf16 v[192:207], a[196:199], a[128:131], v[192:207]
  ds_read_b64_tr_b16 a[196:197], v5 offset:8192
  ds_read_b64_tr_b16 a[198:199], v5 offset:8704
  s_add_u32 s59, s17, 6144
  s_barrier
  s_waitcnt lgkmcnt(4)
  v_mfma_f32_32x32x16_bf16 v[128:143], a[200:203], a[204:207], v[128:143]
  buffer_load_dwordx4 a[140:143], v2, s[32:35], s59 offen offset:0 sc1
  v_mfma_f32_32x32x16_bf16 v[96:111], a[200:203], a[208:211], v[96:111]
  v_mfma_f32_32x32x16_bf16 v[208:223], a[200:203], a[212:215], v[208:223]
  buffer_load_dwordx4 a[16:19], v2, s[32:35], s59 offen offset:1024 sc1
  ds_read_b64_tr_b16 a[200:201], v5 offset:10240
  ds_read_b64_tr_b16 a[202:203], v5 offset:10752
  s_waitcnt lgkmcnt(4)
  v_mfma_f32_32x32x16_bf16 v[128:143], a[192:195], a[240:243], v[128:143]
  v_mfma_f32_32x32x16_bf16 v[96:111], a[192:195], a[244:247], v[96:111]
  buffer_load_dwordx4 a[20:23], v2, s[32:35], s59 offen offset:2048 sc1
  v_mfma_f32_32x32x16_bf16 v[208:223], a[192:195], a[248:251], v[208:223]
  ds_read_b64_tr_b16 a[192:193], v5 offset:12288
  ds_read_b64_tr_b16 a[194:195], v5 offset:12800
  s_waitcnt lgkmcnt(4)
  v_mfma_f32_32x32x16_bf16 v[128:143], a[196:199], a[216:219], v[128:143]
  v_mfma_f32_32x32x16_bf16 v[96:111], a[196:199], a[220:223], v[96:111]
  v_mfma_f32_32x32x16_bf16 v[208:223], a[196:199], a[224:227], v[208:223]
  buffer_load_dwordx4 v[8:11], off, s[44:47], 0 sc1
  ds_read_b64_tr_b16 a[196:197], v5 offset:14336
  ds_read_b64_tr_b16 a[198:199], v5 offset:14848
  s_add_u32 s59, s78, 9216
  s_waitcnt lgkmcnt(4)
  v_mfma_f32_32x32x16_bf16 v[128:143], a[200:203], a[252:255], v[128:143]
  buffer_load_dwordx4 a[80:83], v2, s[32:35], s59 offen offset:0 sc1
  v_mfma_f32_32x32x16_bf16 v[96:111], a[200:203], a[0:3], v[96:111]
  v_mfma_f32_32x32x16_bf16 v[208:223], a[200:203], a[4:7], v[208:223]
  buffer_load_dwordx4 a[84:87], v2, s[32:35], s59 offen offset:1024 sc1
  ds_read_b64_tr_b16 a[200:201], v5 offset:16384
  ds_read_b64_tr_b16 a[202:203], v5 offset:16896
  s_waitcnt lgkmcnt(4)
  v_mfma_f32_32x32x16_bf16 v[128:143], a[192:195], a[228:231], v[128:143]
  v_mfma_f32_32x32x16_bf16 v[96:111], a[192:195], a[232:235], v[96:111]
  buffer_load_dwordx4 a[144:147], v2, s[32:35], s59 offen offset:2048 sc1
  v_mfma_f32_32x32x16_bf16 v[208:223], a[192:195], a[236:239], v[208:223]
  ds_read_b64_tr_b16 a[192:193], v5 offset:18432
  ds_read_b64_tr_b16 a[194:195], v5 offset:18944
  s_add_u32 s59, s79, 9216
  s_waitcnt lgkmcnt(4)
  v_mfma_f32_32x32x16_bf16 v[128:143], a[196:199], a[64:67], v[128:143]
  buffer_load_dwordx4 a[148:151], v2, s[32:35], s59 offen offset:0 sc1
  v_mfma_f32_32x32x16_bf16 v[96:111], a[196:199], a[68:71], v[96:111]
  v_mfma_f32_32x32x16_bf16 v[208:223], a[196:199], a[128:131], v[208:223]
  buffer_load_dwordx4 a[24:27], v2, s[32:35], s59 offen offset:1024 sc1
  ds_read_b64_tr_b16 a[196:197], v5 offset:20480
  ds_read_b64_tr_b16 a[198:199], v5 offset:20992
  s_waitcnt vmcnt(14) lgkmcnt(4)
  v_mfma_f32_32x32x16_bf16 v[32:47], a[200:203], a[132:135], v[32:47]
  s_waitcnt vmcnt(13)
  v_mfma_f32_32x32x16_bf16 v[64:79], a[200:203], a[8:11], v[64:79]
  s_waitcnt vmcnt(12)
  v_mfma_f32_32x32x16_bf16 v[176:191], a[200:203], a[12:15], v[176:191]
  buffer_load_dwordx4 a[28:31], v2, s[32:35], s59 offen offset:2048 sc1
  ds_read_b64_tr_b16 a[200:201], v5 offset:22528
  ds_read_b64_tr_b16 a[202:203], v5 offset:23040
  s_waitcnt lgkmcnt(4)
  v_mfma_f32_32x32x16_bf16 v[48:63], a[192:195], a[132:135], v[48:63]
  s_add_u32 s59, s17, 9216
  v_mfma_f32_32x32x16_bf16 v[80:95], a[192:195], a[8:11], v[80:95]
  buffer_load_dwordx4 a[88:91], v2, s[32:35], s59 offen offset:0 sc1
  v_mfma_f32_32x32x16_bf16 v[192:207], a[192:195], a[12:15], v[192:207]
  ds_read_b64_tr_b16 a[192:193], v5 offset:24576
  ds_read_b64_tr_b16 a[194:195], v5 offset:25088
  s_barrier
  s_waitcnt vmcnt(13) lgkmcnt(4)
  v_mfma_f32_32x32x16_bf16 v[32:47], a[196:199], a[72:75], v[32:47]
  buffer_load_dwordx4 a[92:95], v2, s[32:35], s59 offen offset:1024 sc1
  s_waitcnt vmcnt(13)
  v_mfma_f32_32x32x16_bf16 v[64:79], a[196:199], a[76:79], v[64:79]
  s_waitcnt vmcnt(12)
  v_mfma_f32_32x32x16_bf16 v[176:191], a[196:199], a[136:139], v[176:191]
  buffer_load_dwordx4 a[152:155], v2, s[32:35], s59 offen offset:2048 sc1
  ds_read_b64_tr_b16 a[196:197], v5 offset:26624
  ds_read_b64_tr_b16 a[198:199], v5 offset:27136
  s_waitcnt lgkmcnt(4)
  v_mfma_f32_32x32x16_bf16 v[48:63], a[200:203], a[72:75], v[48:63]
  v_mfma_f32_32x32x16_bf16 v[80:95], a[200:203], a[76:79], v[80:95]
  s_waitcnt vmcnt(9)
  v_min3_u32 v8, v8, v9, v10
  v_min_u32 v8, v8, v11
  v_cmp_gt_u32 vcc, 8, v8
  s_cbranch_vccnz L_sp_f1
L_sb_f1:
  s_add_u32 s59, s78, 12288
  v_mfma_f32_32x32x16_bf16 v[192:207], a[200:203], a[136:139], v[192:207]
  buffer_load_dwordx4 a[156:159], v2, s[32:35], s59 offen offset:0 sc1
  ds_read_b64_tr_b16 a[200:201], v5 offset:28672
  ds_read_b64_tr_b16 a[202:203], v5 offset:29184
  s_waitcnt lgkmcnt(4)
  v_mfma_f32_32x32x16_bf16 v[32:47], a[192:195], a[140:143], v[32:47]
  v_mfma_f32_32x32x16_bf16 v[64:79], a[192:195], a[16:19], v[64:79]
  buffer_load_dwordx4 a[32:35], v2, s[32:35], s59 offen offset:1024 sc1
  v_mfma_f32_32x32x16_bf16 v[176:191], a[192:195], a[20:23], v[176:191]
  ds_read_b64_tr_b16 a[192:193], v5 offset:30720
  ds_read_b64_tr_b16 a[194:195], v5 offset:31232
  s_waitcnt lgkmcnt(4)
  v_mfma_f32_32x32x16_bf16 v[48:63], a[196:199], a[140:143], v[48:63]
  buffer_load_dwordx4 a[36:39], v2, s[32:35], s59 offen offset:2048 sc1
  v_mfma_f32_32x32x16_bf16 v[80:95], a[196:199], a[16:19], v[80:95]
  v_mfma_f32_32x32x16_bf16 v[192:207], a[196:199], a[20:23], v[192:207]
  ds_read_b64_tr_b16 a[196:197], v5 offset:32768
  ds_read_b64_tr_b16 a[198:199], v5 offset:33280
  s_add_u32 s59, s79, 12288
  s_waitcnt vmcnt(11) lgkmcnt(4)
  v_mfma_f32_32x32x16_bf16 v[32:47], a[200:203], a[80:83], v[32:47]
  buffer_load_dwordx4 a[96:99], v2, s[32:35], s59 offen offset:0 sc1
  s_waitcnt vmcnt(11)
  v_mfma_f32_32x32x16_bf16 v[64:79], a[200:203], a[84:87], v[64:79]
  s_waitcnt vmcnt(10)
  v_mfma_f32_32x32x16_bf16 v[176:191], a[200:203], a[144:147], v[176:191]
  buffer_load_dwordx4 a[100:103], v2, s[32:35], s59 offen offset:1024 sc1
  ds_read_b64_tr_b16 a[200:201], v5 offset:34816
  ds_read_b64_tr_b16 a[202:203], v5 offset:35328
  s_waitcnt lgkmcnt(4)
  v_mfma_f32_32x32x16_bf16 v[48:63], a[192:195], a[80:83], v[48:63]
  v_mfma_f32_32x32x16_bf16 v[80:95], a[192:195], a[84:87], v[80:95]
  v_mfma_f32_32x32x16_bf16 v[192:207], a[192:195], a[144:147], v[192:207]
  buffer_load_dwordx4 a[160:163], v2, s[32:35], s59 offen offset:2048 sc1
  ds_read_b64_tr_b16 a[192:193], v5 offset:36864
  ds_read_b64_tr_b16 a[194:195], v5 offset:37376
  s_waitcnt vmcnt(11) lgkmcnt(4)
  v_mfma_f32_32x32x16_bf16 v[32:47], a[196:199], a[148:151], v[32:47]
  s_add_u32 s59, s17, 12288
  s_waitcnt vmcnt(10)
  v_mfma_f32_32x32x16_bf16 v[64:79], a[196:199], a[24:27], v[64:79]
  buffer_load_dwordx4 a[164:167], v2, s[32:35], s59 offen offset:0 sc1
  s_waitcnt vmcnt(10)
  v_mfma_f32_32x32x16_bf16 v[176:191], a[196:199], a[28:31], v[176:191]
  ds_read_b64_tr_b16 a[196:197], v5 offset:38912
  ds_read_b64_tr_b16 a[198:199], v5 offset:39424
  s_waitcnt lgkmcnt(4)
  v_mfma_f32_32x32x16_bf16 v[48:63], a[200:203], a[148:151], v[48:63]
  buffer_load_dwordx4 a[40:43], v2, s[32:35], s59 offen offset:1024 sc1
  v_mfma_f32_32x32x16_bf16 v[80:95], a[200:203], a[24:27], v[80:95]
  v_mfma_f32_32x32x16_bf16 v[192:207], a[200:203], a[28:31], v[192:207]
  ds_read_b64_tr_b16 a[200:201], v4 offset:0
  ds_read_b64_tr_b16 a[202:203], v4 offset:512
  s_barrier
  s_waitcnt vmcnt(10) lgkmcnt(4)
  v_mfma_f32_32x32x16_bf16 v[32:47], a[192:195], a[88:91], v[32:47]
  buffer_load_dwordx4 a[44:47], v2, s[32:35], s59 offen offset:2048 sc1
  s_waitcnt vmcnt(10)
  v_mfma_f32_32x32x16_bf16 v[64:79], a[192:195], a[92:95], v[64:79]
  s_add_u32 s59, s78, 15360
  s_waitcnt vmcnt(9)
  v_mfma_f32_32x32x16_bf16 v[176:191], a[192:195], a[152:155], v[176:191]
  buffer_load_dwordx4 a[104:107], v2, s[32:35], s59 offen offset:0 sc1
  ds_read_b64_tr_b16 a[192:193], v4 offset:2048
  ds_read_b64_tr_b16 a[194:195], v4 offset:2560
  s_waitcnt lgkmcnt(4)
  v_mfma_f32_32x32x16_bf16 v[48:63], a[196:199], a[88:91], v[48:63]
  v_mfma_f32_32x32x16_bf16 v[80:95], a[196:199], a[92:95], v[80:95]
  v_mfma_f32_32x32x16_bf16 v[192:207], a[196:199], a[152:155], v[192:207]
  buffer_load_dwordx4 a[108:111], v2, s[32:35], s59 offen offset:1024 sc1
  ds_read_b64_tr_b16 a[196:197], v4 offset:4096
  ds_read_b64_tr_b16 a[198:199], v4 offset:4608
  s_add_u32 s58, s6, 98304
  s_add_u32 m0, s63, 139264
  s_waitcnt lgkmcnt(4)
  v_mfma_f32_32x32x16_bf16 v[128:143], a[200:203], a[132:135], v[128:143]
  buffer_load_dwordx4 v3, s[36:39], s58 offen  lds
  v_mfma_f32_32x32x16_bf16 v[96:111], a[200:203], a[8:11], v[96:111]
  buffer_load_dwordx4 a[168:171], v2, s[32:35], s59 offen offset:2048 sc1
  v_mfma_f32_32x32x16_bf16 v[208:223], a[200:203], a[12:15], v[208:223]
  ds_read_b64_tr_b16 a[200:201], v4 offset:6144
  ds_read_b64_tr_b16 a[202:203], v4 offset:6656
  s_add_u32 s59, s79, 15360
  s_waitcnt lgkmcnt(4)
  v_mfma_f32_32x32x16_bf16 v[128:143], a[192:195], a[80:83], v[128:143]
  buffer_load_dwordx4 a[172:175], v2, s[32:35], s59 offen offset:0 sc1
  v_mfma_f32_32x32x16_bf16 v[96:111], a[192:195], a[84:87], v[96:111]
  v_mfma_f32_32x32x16_bf16 v[208:223], a[192:195], a[144:147], v[208:223]
  ds_read_b64_tr_b16 a[192:193], v4 offset:8192
  ds_read_b64_tr_b16 a[194:195], v4 offset:8704
  s_waitcnt lgkmcnt(4)
  v_mfma_f32_32x32x16_bf16 v[128:143], a[196:199], a[72:75], v[128:143]
  buffer_load_dwordx4 a[48:51], v2, s[32:35], s59 offen offset:1024 sc1
  s_add_u32 s58, s7, 98304
  s_add_u32 m0, s63, 143360
  v_mfma_f32_32x32x16_bf16 v[96:111], a[196:199], a[76:79], v[96:111]
  buffer_load_dwordx4 v3, s[36:39], s58 offen  lds
  v_mfma_f32_32x32x16_bf16 v[208:223], a[196:199], a[136:139], v[208:223]
  buffer_load_dwordx4 a[52:55], v2, s[32:35], s59 offen offset:2048 sc1
  ds_read_b64_tr_b16 a[196:197], v4 offset:10240
  ds_read_b64_tr_b16 a[198:199], v4 offset:10752
  s_waitcnt lgkmcnt(4)
  v_mfma_f32_32x32x16_bf16 v[128:143], a[200:203], a[148:151], v[128:143]
  v_mfma_f32_32x32x16_bf16 v[96:111], a[200:203], a[24:27], v[96:111]
  s_add_u32 s59, s17, 15360
  v_mfma_f32_32x32x16_bf16 v[208:223], a[200:203], a[28:31], v[208:223]
  buffer_load_dwordx4 a[112:115], v2, s[32:35], s59 offen offset:0 sc1
  ds_read_b64_tr_b16 a[200:201], v4 offset:12288
  ds_read_b64_tr_b16 a[202:203], v4 offset:12800
  s_add_u32 s58, s8, 98304
  s_add_u32 m0, s63, 147456
  s_waitcnt lgkmcnt(4)
  v_mfma_f32_32x32x16_bf16 v[128:143], a[192:195], a[140:143], v[128:143]
  buffer_load_dwordx4 v3, s[36:39], s58 offen  lds
  v_mfma_f32_32x32x16_bf16 v[96:111], a[192:195], a[16:19], v[96:111]
  buffer_load_dwordx4 a[116:119], v2, s[32:35], s59 offen offset:1024 sc1
  v_mfma_f32_32x32x16_bf16 v[208:223], a[192:195], a[20:23], v[208:223]
  ds_read_b64_tr_b16 a[192:193], v4 offset:14336
  ds_read_b64_tr_b16 a[194:195], v4 offset:14848
  s_waitcnt lgkmcnt(4)
  v_mfma_f32_32x32x16_bf16 v[128:143], a[196:199], a[88:91], v[128:143]
  buffer_load_dwordx4 a[176:179], v2, s[32:35], s59 offen offset:2048 sc1
  v_mfma_f32_32x32x16_bf16 v[96:111], a[196:199], a[92:95], v[96:111]
  v_mfma_f32_32x32x16_bf16 v[208:223], a[196:199], a[152:155], v[208:223]
  ds_read_b64_tr_b16 a[196:197], v4 offset:16384
  ds_read_b64_tr_b16 a[198:199], v4 offset:16896
  s_add_u32 s59, s78, 18432
  s_barrier
  s_waitcnt vmcnt(20) lgkmcnt(4)
  v_mfma_f32_32x32x16_bf16 v[32:47], a[200:203], a[156:159], v[32:47]
  buffer_load_dwordx4 a[180:183], v2, s[32:35], s59 offen offset:0 sc1
  s_add_u32 s58, s6, 114688
  s_add_u32 m0, s63, 151552
  s_waitcnt vmcnt(20)
  v_mfma_f32_32x32x16_bf16 v[64:79], a[200:203], a[32:35], v[64:79]
  buffer_load_dwordx4 v3, s[36:39], s58 offen  lds
  s_waitcnt vmcnt(20)
  v_mfma_f32_32x32x16_bf16 v[176:191], a[200:203], a[36:39], v[176:191]
  buffer_load_dwordx4 a[56:59], v2, s[32:35], s59 offen offset:1024 sc1
  ds_read_b64_tr_b16 a[200:201], v4 offset:18432
  ds_read_b64_tr_b16 a[202:203], v4 offset:18944
  s_waitcnt lgkmcnt(4)
  v_mfma_f32_32x32x16_bf16 v[48:63], a[192:195], a[156:159], v[48:63]
  v_mfma_f32_32x32x16_bf16 v[80:95], a[192:195], a[32:35], v[80:95]
  v_mfma_f32_32x32x16_bf16 v[192:207], a[192:195], a[36:39], v[192:207]
  buffer_load_dwordx4 a[60:63], v2, s[32:35], s59 offen offset:2048 sc1
  ds_read_b64_tr_b16 a[192:193], v4 offset:20480
  ds_read_b64_tr_b16 a[194:195], v4 offset:20992
  s_add_u32 s58, s7, 114688
  s_add_u32 m0, s63, 155648
  s_waitcnt vmcnt(21) lgkmcnt(4)
  v_mfma_f32_32x32x16_bf16 v[32:47], a[196:199], a[96:99], v[32:47]
  buffer_load_dwordx4 v3, s[36:39], s58 offen  lds
  s_add_u32 s59, s79, 18432
  s_waitcnt vmcnt(21)
  v_mfma_f32_32x32x16_bf16 v[64:79], a[196:199], a[100:103], v[64:79]
  buffer_load_dwordx4 a[120:123], v2, s[32:35], s59 offen offset:0 sc1
  s_waitcnt vmcnt(21)
  v_mfma_f32_32x32x16_bf16 v[176:191], a[196:199], a[160:163], v[176:191]
  ds_read_b64_tr_b16 a[196:197], v4 offset:22528
  ds_read_b64_tr_b16 a[198:199], v4 offset:23040
  s_waitcnt lgkmcnt(4)
  v_mfma_f32_32x32x16_bf16 v[48:63], a[200:203], a[96:99], v[48:63]
  buffer_load_dwordx4 a[124:127], v2, s[32:35], s59 offen offset:1024 sc1
  v_mfma_f32_32x32x16_bf16 v[80:95], a[200:203], a[100:103], v[80:95]
  v_mfma_f32_32x32x16_bf16 v[192:207], a[200:203], a[160:163], v[192:207]
  ds_read_b64_tr_b16 a[200:201], v4 offset:24576
  ds_read_b64_tr_b16 a[202:203], v4 offset:25088
  s_waitcnt vmcnt(21) lgkmcnt(4)
  v_mfma_f32_32x32x16_bf16 v[32:47], a[192:195], a[164:167], v[32:47]
  buffer_load_dwordx4 a[184:187], v2, s[32:35], s59 offen offset:2048 sc1
  s_add_u32 s58, s8, 114688
  s_add_u32 m0, s63, 159744
  s_waitcnt vmcnt(21)
  v_mfma_f32_32x32x16_bf16 v[64:79], a[192:195], a[40:43], v[64:79]
  buffer_load_dwordx4 v3, s[36:39], s58 offen  lds
  s_add_u32 s59, s17, 18432
  s_waitcnt vmcnt(21)
  v_mfma_f32_32x32x16_bf16 v[176:191], a[192:195], a[44:47], v[176:191]
  buffer_load_dwordx4 a[188:191], v2, s[32:35], s59 offen offset:0 sc1
  ds_read_b64_tr_b16 a[192:193], v4 offset:26624
  ds_read_b64_tr_b16 a[194:195], v4 offset:27136
  s_waitcnt lgkmcnt(4)
  v_mfma_f32_32x32x16_bf16 v[48:63], a[196:199], a[164:167], v[48:63]
  v_mfma_f32_32x32x16_bf16 v[80:95], a[196:199], a[40:43], v[80:95]
  v_mfma_f32_32x32x16_bf16 v[192:207], a[196:199], a[44:47], v[192:207]
  buffer_load_dwordx4 v[112:115], v2, s[32:35], s59 offen offset:1024 sc1
  ds_read_b64_tr_b16 a[196:197], v4 offset:28672
  ds_read_b64_tr_b16 a[198:199], v4 offset:29184
  s_add_u32 s58, s9, 65536
  s_add_u32 m0, s63, 106496
  s_waitcnt vmcnt(22) lgkmcnt(4)
  v_mfma_f32_32x32x16_bf16 v[32:47], a[200:203], a[104:107], v[32:47]
  buffer_load_dwordx4 v3, s[36:39], s58 offen  lds
  s_waitcnt vmcnt(22)
  v_mfma_f32_32x32x16_bf16 v[64:79], a[200:203], a[108:111], v[64:79]
  buffer_load_dwordx4 v[116:119], v2, s[32:35], s59 offen offset:2048 sc1
  s_waitcnt vmcnt(21)
  v_mfma_f32_32x32x16_bf16 v[176:191], a[200:203], a[168:171], v[176:191]
  ds_read_b64_tr_b16 a[200:201], v4 offset:30720
  ds_read_b64_tr_b16 a[202:203], v4 offset:31232
  s_add_u32 s59, s78, 21504
  s_waitcnt lgkmcnt(4)
  v_mfma_f32_32x32x16_bf16 v[48:63], a[192:195], a[104:107], v[48:63]
  buffer_load_dwordx4 v[248:251], v2, s[32:35], s59 offen offset:0 sc1
  v_mfma_f32_32x32x16_bf16 v[80:95], a[192:195], a[108:111], v[80:95]
  v_mfma_f32_32x32x16_bf16 v[192:207], a[192:195], a[168:171], v[192:207]
  ds_read_b64_tr_b16 a[192:193], v4 offset:32768
  ds_read_b64_tr_b16 a[194:195], v4 offset:33280
  s_waitcnt vmcnt(12)
  s_barrier
  s_waitcnt lgkmcnt(4)
  v_mfma_f32_32x32x16_bf16 v[32:47], a[196:199], a[172:175], v[32:47]
  buffer_load_dwordx4 v[252:255], v2, s[32:35], s59 offen offset:1024 sc1
  s_add_u32 s58, s10, 65536
  s_add_u32 m0, s63, 110592
  v_mfma_f32_32x32x16_bf16 v[64:79], a[196:199], a[48:51], v[64:79]
  buffer_load_dwordx4 v3, s[36:39], s58 offen  lds
  v_mfma_f32_32x32x16_bf16 v[176:191], a[196:199], a[52:55], v[176:191]
  buffer_load_dwordx4 v[28:31], v2, s[32:35], s59 offen offset:2048 sc1
  ds_read_b64_tr_b16 a[196:197], v4 offset:34816
  ds_read_b64_tr_b16 a[198:199], v4 offset:35328
  s_waitcnt lgkmcnt(4)
  v_mfma_f32_32x32x16_bf16 v[48:63], a[200:203], a[172:175], v[48:63]
  v_mfma_f32_32x32x16_bf16 v[80:95], a[200:203], a[48:51], v[80:95]
  s_add_u32 s59, s79, 21504
  v_mfma_f32_32x32x16_bf16 v[192:207], a[200:203], a[52:55], v[192:207]
  buffer_load_dwordx4 v[20:23], v2, s[32:35], s59 offen offset:0 sc1
  ds_read_b64_tr_b16 a[200:201], v6 offset:8192
  ds_read_b64_tr_b16 a[202:203], v6 offset:8704
  s_add_u32 s58, s11, 65536
  s_add_u32 m0, s63, 114688
  s_waitcnt lgkmcnt(4)
  v_mfma_f32_32x32x16_bf16 v[32:47], a[192:195], a[112:115], v[32:47]
  buffer_load_dwordx4 v3, s[36:39], s58 offen  lds
  v_mfma_f32_32x32x16_bf16 v[64:79], a[192:195], a[116:119], v[64:79]
  buffer_load_dwordx4 v[240:243], v2, s[32:35], s59 offen offset:1024 sc1
  v_mfma_f32_32x32x16_bf16 v[176:191], a[192:195], a[176:179], v[176:191]
  ds_read_b64_tr_b16 a[192:193], v6 offset:10240
  ds_read_b64_tr_b16 a[194:195], v6 offset:10752
  s_waitcnt lgkmcnt(4)
  v_mfma_f32_32x32x16_bf16 v[48:63], a[196:199], a[112:115], v[48:63]
  buffer_load_dwordx4 v[244:247], v2, s[32:35], s59 offen offset:2048 sc1
  v_mfma_f32_32x32x16_bf16 v[80:95], a[196:199], a[116:119], v[80:95]
  v_mfma_f32_32x32x16_bf16 v[192:207], a[196:199], a[176:179], v[192:207]
  ds_read_b64_tr_b16 a[196:197], v6 offset:12288
  ds_read_b64_tr_b16 a[198:199], v6 offset:12800
  s_add_u32 s59, s17, 21504
  s_waitcnt lgkmcnt(4)
  v_mfma_f32_32x32x16_bf16 v[32:47], a[200:203], a[180:183], v[32:47]
  buffer_load_dwordx4 v[120:123], v2, s[32:35], s59 offen offset:0 sc1
  s_add_u32 s58, s9, 98304
  s_add_u32 m0, s63, 118784
  s_waitcnt vmcnt(19)
  v_mfma_f32_32x32x16_bf16 v[64:79], a[200:203], a[56:59], v[64:79]
  buffer_load_dwordx4 v3, s[36:39], s58 offen  lds
  s_waitcnt vmcnt(19)
  v_mfma_f32_32x32x16_bf16 v[176:191], a[200:203], a[60:63], v[176:191]
  buffer_load_dwordx4 v[124:127], v2, s[32:35], s59 offen offset:1024 sc1
  ds_read_b64_tr_b16 a[200:201], v6 offset:14336
  ds_read_b64_tr_b16 a[202:203], v6 offset:14848
  s_waitcnt lgkmcnt(4)
  v_mfma_f32_32x32x16_bf16 v[48:63], a[192:195], a[180:183], v[48:63]
  v_mfma_f32_32x32x16_bf16 v[80:95], a[192:195], a[56:59], v[80:95]
  v_mfma_f32_32x32x16_bf16 v[192:207], a[192:195], a[60:63], v[192:207]
  buffer_load_dwordx4 v[24:27], v2, s[32:35], s59 offen offset:2048 sc1
  ds_read_b64_tr_b16 a[192:193], v6 offset:16384
  ds_read_b64_tr_b16 a[194:195], v6 offset:16896
  s_add_u32 s58, s10, 98304
  s_add_u32 m0, s63, 122880
  s_waitcnt vmcnt(19) lgkmcnt(4)
  v_mfma_f32_32x32x16_bf16 v[32:47], a[196:199], a[120:123], v[32:47]
  buffer_load_dwordx4 v3, s[36:39], s58 offen  lds
  s_waitcnt vmcnt(19)
  v_mfma_f32_32x32x16_bf16 v[64:79], a[196:199], a[124:127], v[64:79]
  s_waitcnt vmcnt(18)
  v_mfma_f32_32x32x16_bf16 v[176:191], a[196:199], a[184:187], v[176:191]
  ds_read_b64_tr_b16 a[196:197], v6 offset:18432
  ds_read_b64_tr_b16 a[198:199], v6 offset:18944
  s_waitcnt lgkmcnt(4)
  v_mfma_f32_32x32x16_bf16 v[48:63], a[200:203], a[120:123], v[48:63]
  v_mfma_f32_32x32x16_bf16 v[80:95], a[200:203], a[124:127], v[80:95]
  v_mfma_f32_32x32x16_bf16 v[192:207], a[200:203], a[184:187], v[192:207]
  ds_read_b64_tr_b16 a[200:201], v6 offset:20480
  ds_read_b64_tr_b16 a[202:203], v6 offset:20992
  s_add_u32 s58, s11, 98304
  s_add_u32 m0, s63, 126976
  s_waitcnt vmcnt(10)
  s_barrier
  s_waitcnt lgkmcnt(4)
  v_mfma_f32_32x32x16_bf16 v[32:47], a[192:195], a[188:191], v[32:47]
  buffer_load_dwordx4 v3, s[36:39], s58 offen  lds
  v_mfma_f32_32x32x16_bf16 v[64:79], a[192:195], v[112:115], v[64:79]
  v_mfma_f32_32x32x16_bf16 v[176:191], a[192:195], v[116:119], v[176:191]
  ds_read_b64_tr_b16 a[192:193], v6 offset:22528
  ds_read_b64_tr_b16 a[194:195], v6 offset:23040
  s_waitcnt lgkmcnt(4)
  v_mfma_f32_32x32x16_bf16 v[48:63], a[196:199], a[188:191], v[48:63]
  v_mfma_f32_32x32x16_bf16 v[80:95], a[196:199], v[112:115], v[80:95]
  v_mfma_f32_32x32x16_bf16 v[192:207], a[196:199], v[116:119], v[192:207]
  ds_read_b64_tr_b16 a[196:197], v6 offset:24576
  ds_read_b64_tr_b16 a[198:199], v6 offset:25088
  s_add_u32 s58, s12, 0
  s_add_u32 m0, s63, 131072
  s_waitcnt lgkmcnt(4)
  v_mfma_f32_32x32x16_bf16 v[32:47], a[200:203], v[248:251], v[32:47]
  buffer_load_dwordx4 v3, s[36:39], s58 offen  lds
  v_mfma_f32_32x32x16_bf16 v[64:79], a[200:203], v[252:255], v[64:79]
  s_waitcnt vmcnt(11)
  v_mfma_f32_32x32x16_bf16 v[176:191], a[200:203], v[28:31], v[176:191]
  ds_read_b64_tr_b16 a[200:201], v6 offset:26624
  ds_read_b64_tr_b16 a[202:203], v6 offset:27136
  s_waitcnt lgkmcnt(4)
  v_mfma_f32_32x32x16_bf16 v[48:63], a[192:195], v[248:251], v[48:63]
  v_mfma_f32_32x32x16_bf16 v[80:95], a[192:195], v[252:255], v[80:95]
  v_mfma_f32_32x32x16_bf16 v[192:207], a[192:195], v[28:31], v[192:207]
  ds_read_b64_tr_b16 a[192:193], v6 offset:28672
  ds_read_b64_tr_b16 a[194:195], v6 offset:29184
  s_add_u32 s58, s13, 0
  s_add_u32 m0, s63, 135168
  s_waitcnt vmcnt(10) lgkmcnt(4)
  v_mfma_f32_32x32x16_bf16 v[32:47], a[196:199], v[20:23], v[32:47]
  buffer_load_dwordx4 v3, s[36:39], s58 offen  lds
  s_waitcnt vmcnt(9)
  v_mfma_f32_32x32x16_bf16 v[64:79], a[196:199], v[240:243], v[64:79]
  s_waitcnt vmcnt(8)
  v_mfma_f32_32x32x16_bf16 v[176:191], a[196:199], v[244:247], v[176:191]
  ds_read_b64_tr_b16 a[196:197], v6 offset:30720
  ds_read_b64_tr_b16 a[198:199], v6 offset:31232
  s_waitcnt lgkmcnt(4)
  v_mfma_f32_32x32x16_bf16 v[48:63], a[200:203], v[20:23], v[48:63]
  v_mfma_f32_32x32x16_bf16 v[80:95], a[200:203], v[240:243], v[80:95]
  v_mfma_f32_32x32x16_bf16 v[192:207], a[200:203], v[244:247], v[192:207]
  ds_read_b64_tr_b16 a[200:201], v5 offset:40960
  ds_read_b64_tr_b16 a[202:203], v5 offset:41472
  s_add_u32 s58, s16, 0
  s_add_u32 m0, s63, 65536
  s_waitcnt vmcnt(7) lgkmcnt(4)
  v_mfma_f32_32x32x16_bf16 v[32:47], a[192:195], v[120:123], v[32:47]
  buffer_load_dwordx4 v3, s[36:39], s58 offen  lds
  s_waitcnt vmcnt(6)
  v_mfma_f32_32x32x16_bf16 v[64:79], a[192:195], v[124:127], v[64:79]
  s_waitcnt vmcnt(5)
  v_mfma_f32_32x32x16_bf16 v[176:191], a[192:195], v[24:27], v[176:191]
  ds_read_b64_tr_b16 a[192:193], v5 offset:43008
  ds_read_b64_tr_b16 a[194:195], v5 offset:43520
  s_waitcnt lgkmcnt(4)
  v_mfma_f32_32x32x16_bf16 v[48:63], a[196:199], v[120:123], v[48:63]
  v_mfma_f32_32x32x16_bf16 v[80:95], a[196:199], v[124:127], v[80:95]
  v_mfma_f32_32x32x16_bf16 v[192:207], a[196:199], v[24:27], v[192:207]
  ds_read_b64_tr_b16 a[196:197], v5 offset:45056
  ds_read_b64_tr_b16 a[198:199], v5 offset:45568
  s_barrier
  s_waitcnt lgkmcnt(4)
  v_mfma_f32_32x32x16_bf16 v[128:143], a[200:203], a[156:159], v[128:143]
  v_mfma_f32_32x32x16_bf16 v[96:111], a[200:203], a[32:35], v[96:111]
  ds_write_b128 v16, v[40:43] offset:0
  v_mfma_f32_32x32x16_bf16 v[208:223], a[200:203], a[36:39], v[208:223]
  ds_read_b64_tr_b16 a[200:201], v5 offset:47104
  ds_read_b64_tr_b16 a[202:203], v5 offset:47616
  ds_write_b128 v16, v[44:47] offset:1024
  s_waitcnt lgkmcnt(6)
  v_mfma_f32_32x32x16_bf16 v[128:143], a[192:195], a[104:107], v[128:143]
  ds_write_b128 v16, v[72:75] offset:2048
  v_mfma_f32_32x32x16_bf16 v[96:111], a[192:195], a[108:111], v[96:111]
  ds_write_b128 v16, v[76:79] offset:3072
  v_mfma_f32_32x32x16_bf16 v[208:223], a[192:195], a[168:171], v[208:223]
  ds_read_b64_tr_b16 a[192:193], v5 offset:49152
  ds_read_b64_tr_b16 a[194:195], v5 offset:49664
  ds_write_b128 v16, v[184:187] offset:4096
  s_waitcnt lgkmcnt(9)
  v_mfma_f32_32x32x16_bf16 v[128:143], a[196:199], a[96:99], v[128:143]
  ds_write_b128 v16, v[188:191] offset:5120
  v_mfma_f32_32x32x16_bf16 v[96:111], a[196:199], a[100:103], v[96:111]
  ds_write_b128 v16, v[56:59] offset:24576
  v_mfma_f32_32x32x16_bf16 v[208:223], a[196:199], a[160:163], v[208:223]
  ds_read_b64_tr_b16 a[196:197], v5 offset:51200
  ds_read_b64_tr_b16 a[198:199], v5 offset:51712
  ds_write_b128 v16, v[60:63] offset:25600
  s_waitcnt lgkmcnt(11)
  v_mfma_f32_32x32x16_bf16 v[128:143], a[200:203], a[172:175], v[128:143]
  ds_write_b128 v16, v[88:91] offset:26624
  v_mfma_f32_32x32x16_bf16 v[96:111], a[200:203], a[48:51], v[96:111]
  ds_write_b128 v16, v[92:95] offset:27648
  v_mfma_f32_32x32x16_bf16 v[208:223], a[200:203], a[52:55], v[208:223]
  ds_read_b64_tr_b16 a[200:201], v5 offset:53248
  ds_read_b64_tr_b16 a[202:203], v5 offset:53760
  ds_write_b128 v16, v[200:203] offset:28672
  s_waitcnt lgkmcnt(11)
  v_mfma_f32_32x32x16_bf16 v[128:143], a[192:195], a[164:167], v[128:143]
  ds_write_b128 v16, v[204:207] offset:29696
  s_add_u32 s58, s12, 32768
  s_add_u32 m0, s63, 61440
  v_mfma_f32_32x32x16_bf16 v[96:111], a[192:195], a[40:43], v[96:111]
  buffer_load_dwordx4 v3, s[36:39], s58 offen  lds
  v_mfma_f32_32x32x16_bf16 v[208:223], a[192:195], a[44:47], v[208:223]
  ds_read_b64_tr_b16 a[192:193], v5 offset:55296
  ds_read_b64_tr_b16 a[194:195], v5 offset:55808
  s_waitcnt lgkmcnt(9)
  v_mfma_f32_32x32x16_bf16 v[128:143], a[196:199], a[112:115], v[128:143]
  s_add_u32 s58, s13, 32768
  s_add_u32 m0, s63, 57344
  s_waitcnt vmcnt(2)
  s_waitcnt lgkmcnt(0)
  s_barrier
  v_mfma_f32_32x32x16_bf16 v[96:111], a[196:199], a[116:119], v[96:111]
  buffer_load_dwordx4 v3, s[36:39], s58 offen  lds
  ds_read_b128 v[40:43], v17 offset:0
  ds_read_b128 v[44:47], v17 offset:1024
  v_mfma_f32_32x32x16_bf16 v[208:223], a[196:199], a[176:179], v[208:223]
  ds_read_b64_tr_b16 a[196:197], v5 offset:57344
  ds_read_b64_tr_b16 a[198:199], v5 offset:57856
  ds_read_b128 v[72:75], v17 offset:2048
  ds_read_b128 v[76:79], v17 offset:3072
  s_add_u32 s58, s16, 32768
  s_add_u32 m0, s63, 53248
  v_mfma_f32_32x32x16_bf16 v[128:143], a[200:203], a[180:183], v[128:143]
  buffer_load_dwordx4 v3, s[36:39], s58 offen  lds
  ds_read_b128 v[184:187], v17 offset:4096
  ds_read_b128 v[188:191], v17 offset:5120
  v_mfma_f32_32x32x16_bf16 v[96:111], a[200:203], a[56:59], v[96:111]
  ds_read_b128 v[56:59], v17 offset:24576
  ds_read_b128 v[60:63], v17 offset:25600
  s_add_u32 s58, s12, 65536
  s_add_u32 m0, s63, 49152
  v_mfma_f32_32x32x16_bf16 v[208:223], a[200:203], a[60:63], v[208:223]
  buffer_load_dwordx4 v3, s[36:39], s58 offen  lds
  ds_read_b64_tr_b16 a[200:201], v5 offset:59392
  ds_read_b64_tr_b16 a[202:203], v5 offset:59904
  ds_read_b128 v[88:91], v17 offset:26624
  ds_read_b128 v[92:95], v17 offset:27648
  v_mfma_f32_32x32x16_bf16 v[128:143], a[192:195], v[248:251], v[128:143]
  ds_read_b128 v[200:203], v17 offset:28672
  ds_read_b128 v[204:207], v17 offset:29696
  s_waitcnt lgkmcnt(15)
  v_pk_add_f32 v[32:33], v[32:33], v[40:41]
  v_pk_add_f32 v[34:35], v[34:35], v[42:43]
  s_waitcnt lgkmcnt(14)
  v_pk_add_f32 v[36:37], v[36:37], v[44:45]
  v_pk_add_f32 v[38:39], v[38:39], v[46:47]
  v_mfma_f32_32x32x16_bf16 v[96:111], a[192:195], v[252:255], v[96:111]
  v_cvt_pk_bf16_f32 v32, v32, v33
  v_cvt_pk_bf16_f32 v33, v34, v35
  v_cvt_pk_bf16_f32 v34, v36, v37
  v_cvt_pk_bf16_f32 v35, v38, v39
  v_mfma_f32_32x32x16_bf16 v[208:223], a[192:195], v[28:31], v[208:223]
  buffer_store_dwordx4 v[32:35], v2, s[40:43], s68 offen offset:0 sc1
  ds_read_b64_tr_b16 a[192:193], v5 offset:61440
  ds_read_b64_tr_b16 a[194:195], v5 offset:61952
  s_add_u32 s58, s13, 65536
  s_add_u32 m0, s63, 69632
  s_waitcnt lgkmcnt(14)
  v_mfma_f32_32x32x16_bf16 v[128:143], a[196:199], a[120:123], v[128:143]
  buffer_load_dwordx4 v3, s[36:39], s58 offen  lds
  s_waitcnt lgkmcnt(13)
  v_pk_add_f32 v[64:65], v[64:65], v[72:73]
  v_pk_add_f32 v[66:67], v[66:67], v[74:75]
  s_waitcnt lgkmcnt(12)
  v_pk_add_f32 v[68:69], v[68:69], v[76:77]
  v_pk_add_f32 v[70:71], v[70:71], v[78:79]
  v_mfma_f32_32x32x16_bf16 v[96:111], a[196:199], a[124:127], v[96:111]
  v_cvt_pk_bf16_f32 v64, v64, v65
  v_cvt_pk_bf16_f32 v65, v66, v67
  v_cvt_pk_bf16_f32 v66, v68, v69
  v_cvt_pk_bf16_f32 v67, v70, v71
  v_mfma_f32_32x32x16_bf16 v[208:223], a[196:199], a[184:187], v[208:223]
  buffer_store_dwordx4 v[64:67], v2, s[40:43], s68 offen offset:1024 sc1
  ds_read_b64_tr_b16 a[196:197], v5 offset:63488
  ds_read_b64_tr_b16 a[198:199], v5 offset:64000
  s_waitcnt lgkmcnt(13)
  v_pk_add_f32 v[176:177], v[176:177], v[184:185]
  v_pk_add_f32 v[178:179], v[178:179], v[186:187]
  s_waitcnt lgkmcnt(8)
  v_mfma_f32_32x32x16_bf16 v[128:143], a[200:203], v[20:23], v[128:143]
  v_pk_add_f32 v[180:181], v[180:181], v[188:189]
  v_pk_add_f32 v[182:183], v[182:183], v[190:191]
  v_cvt_pk_bf16_f32 v176, v176, v177
  v_cvt_pk_bf16_f32 v177, v178, v179
  v_cvt_pk_bf16_f32 v178, v180, v181
  v_cvt_pk_bf16_f32 v179, v182, v183
  v_mfma_f32_32x32x16_bf16 v[96:111], a[200:203], v[240:243], v[96:111]
  buffer_store_dwordx4 v[176:179], v2, s[40:43], s68 offen offset:2048 sc1
  v_mfma_f32_32x32x16_bf16 v[208:223], a[200:203], v[244:247], v[208:223]
  ds_read_b64_tr_b16 a[200:201], v6 offset:0
  ds_read_b64_tr_b16 a[202:203], v6 offset:512
  v_pk_add_f32 v[48:49], v[48:49], v[56:57]
  v_pk_add_f32 v[50:51], v[50:51], v[58:59]
  s_add_u32 s58, s16, 65536
  s_add_u32 m0, s63, 73728
  s_waitcnt lgkmcnt(4)
  v_mfma_f32_32x32x16_bf16 v[128:143], a[192:195], a[188:191], v[128:143]
  buffer_load_dwordx4 v3, s[36:39], s58 offen  lds
  v_pk_add_f32 v[52:53], v[52:53], v[60:61]
  v_pk_add_f32 v[54:55], v[54:55], v[62:63]
  v_cvt_pk_bf16_f32 v48, v48, v49
  v_cvt_pk_bf16_f32 v49, v50, v51
  v_mfma_f32_32x32x16_bf16 v[96:111], a[192:195], v[112:115], v[96:111]
  v_cvt_pk_bf16_f32 v50, v52, v53
  v_cvt_pk_bf16_f32 v51, v54, v55
  v_mfma_f32_32x32x16_bf16 v[208:223], a[192:195], v[116:119], v[208:223]
  buffer_store_dwordx4 v[48:51], v2, s[40:43], s69 offen offset:0 sc1
  ds_read_b64_tr_b16 a[192:193], v6 offset:2048
  ds_read_b64_tr_b16 a[194:195], v6 offset:2560
  v_pk_add_f32 v[80:81], v[80:81], v[88:89]
  v_pk_add_f32 v[82:83], v[82:83], v[90:91]
  s_waitcnt lgkmcnt(4)
  v_mfma_f32_32x32x16_bf16 v[128:143], a[196:199], v[120:123], v[128:143]
  v_pk_add_f32 v[84:85], v[84:85], v[92:93]
  v_pk_add_f32 v[86:87], v[86:87], v[94:95]
  v_cvt_pk_bf16_f32 v80, v80, v81
  v_cvt_pk_bf16_f32 v81, v82, v83
  v_cvt_pk_bf16_f32 v82, v84, v85
  v_cvt_pk_bf16_f32 v83, v86, v87
  v_mfma_f32_32x32x16_bf16 v[96:111], a[196:199], v[124:127], v[96:111]
  buffer_store_dwordx4 v[80:83], v2, s[40:43], s69 offen offset:1024 sc1
  v_pk_add_f32 v[192:193], v[192:193], v[200:201]
  v_pk_add_f32 v[194:195], v[194:195], v[202:203]
  v_pk_add_f32 v[196:197], v[196:197], v[204:205]
  v_pk_add_f32 v[198:199], v[198:199], v[206:207]
  v_mfma_f32_32x32x16_bf16 v[208:223], a[196:199], v[24:27], v[208:223]
  ds_read_b64_tr_b16 a[196:197], v6 offset:4096
  ds_read_b64_tr_b16 a[198:199], v6 offset:4608
  v_cvt_pk_bf16_f32 v192, v192, v193
  v_cvt_pk_bf16_f32 v193, v194, v195
  s_waitcnt vmcnt(11)
  s_barrier
  s_waitcnt lgkmcnt(4)
  v_mfma_f32_32x32x16_bf16 v[144:159], a[200:203], a[204:207], v[144:159]
  v_cvt_pk_bf16_f32 v194, v196, v197
  v_cvt_pk_bf16_f32 v195, v198, v199
  v_mfma_f32_32x32x16_bf16 v[160:175], a[200:203], a[208:211], v[160:175]
  buffer_store_dwordx4 v[192:195], v2, s[40:43], s69 offen offset:2048 sc1
  v_mfma_f32_32x32x16_bf16 v[224:239], a[200:203], a[212:215], v[224:239]
  ds_read_b64_tr_b16 a[200:201], v6 offset:6144
  ds_read_b64_tr_b16 a[202:203], v6 offset:6656
  ds_write_b128 v16, v[136:139] offset:0
  s_waitcnt lgkmcnt(5)
  v_mfma_f32_32x32x16_bf16 v[144:159], a[192:195], a[240:243], v[144:159]
  ds_write_b128 v16, v[140:143] offset:1024
  v_mfma_f32_32x32x16_bf16 v[160:175], a[192:195], a[244:247], v[160:175]
  ds_write_b128 v16, v[104:107] offset:2048
  v_mfma_f32_32x32x16_bf16 v[224:239], a[192:195], a[248:251], v[224:239]
  ds_read_b64_tr_b16 a[192:193], v5 offset:0
  ds_read_b64_tr_b16 a[194:195], v5 offset:512
  ds_write_b128 v16, v[108:111] offset:3072
  s_waitcnt lgkmcnt(8)
  v_mfma_f32_32x32x16_bf16 v[144:159], a[196:199], a[216:219], v[144:159]
  ds_write_b128 v16, v[216:219] offset:4096
  v_mfma_f32_32x32x16_bf16 v[160:175], a[196:199], a[220:223], v[160:175]
  ds_write_b128 v16, v[220:223] offset:5120
  s_add_u32 s58, s12, 98304
  s_add_u32 m0, s63, 77824
  v_mfma_f32_32x32x16_bf16 v[224:239], a[196:199], a[224:227], v[224:239]
  buffer_load_dwordx4 v3, s[36:39], s58 offen  lds
  ds_read_b64_tr_b16 a[196:197], v5 offset:2048
  ds_read_b64_tr_b16 a[198:199], v5 offset:2560
  s_waitcnt lgkmcnt(10)
  v_mfma_f32_32x32x16_bf16 v[144:159], a[200:203], a[252:255], v[144:159]
  s_add_u32 s58, s13, 98304
  s_add_u32 m0, s63, 81920
  s_waitcnt vmcnt(7)
  s_waitcnt lgkmcnt(0)
  s_barrier
  v_mfma_f32_32x32x16_bf16 v[160:175], a[200:203], a[0:3], v[160:175]
  buffer_load_dwordx4 v3, s[36:39], s58 offen  lds
  ds_read_b128 v[136:139], v17 offset:0
  ds_read_b128 v[140:143], v17 offset:1024
  v_mfma_f32_32x32x16_bf16 v[224:239], a[200:203], a[4:7], v[224:239]
  ds_read_b64_tr_b16 a[200:201], v4 offset:61440
  ds_read_b64_tr_b16 a[202:203], v4 offset:61952
  ds_read_b128 v[104:107], v17 offset:2048
  ds_read_b128 v[108:111], v17 offset:3072
  s_add_u32 s58, s16, 98304
  s_add_u32 m0, s63, 86016
  v_mfma_f32_32x32x16_bf16 v[144:159], a[192:195], a[228:231], v[144:159]
  buffer_load_dwordx4 v3, s[36:39], s58 offen  lds
  ds_read_b128 v[216:219], v17 offset:4096
  ds_read_b128 v[220:223], v17 offset:5120
  v_and_b32 v18, 31, v1
  v_lshlrev_b32 v18, 10, v18
  v_mfma_f32_32x32x16_bf16 v[160:175], a[192:195], a[232:235], v[160:175]
  v_lshrrev_b32 v19, 5, v1
  v_lshl_add_u32 v18, v19, 4, v18
  v_mfma_f32_32x32x16_bf16 v[224:239], a[192:195], a[236:239], v[224:239]
  ds_read_b64_tr_b16 a[192:193], v4 offset:63488
  ds_read_b64_tr_b16 a[194:195], v4 offset:64000
  s_waitcnt lgkmcnt(9)
  v_pk_add_f32 v[128:129], v[128:129], v[136:137]
  v_pk_add_f32 v[130:131], v[130:131], v[138:139]
  s_waitcnt lgkmcnt(8)
  v_pk_add_f32 v[132:133], v[132:133], v[140:141]
  v_pk_add_f32 v[134:135], v[134:135], v[142:143]
  v_mfma_f32_32x32x16_bf16 v[144:159], a[196:199], a[64:67], v[144:159]
  v_cvt_pk_bf16_f32 v128, v128, v129
  v_cvt_pk_bf16_f32 v129, v130, v131
  v_cvt_pk_bf16_f32 v130, v132, v133
  v_cvt_pk_bf16_f32 v131, v134, v135
  v_mfma_f32_32x32x16_bf16 v[160:175], a[196:199], a[68:71], v[160:175]
  buffer_store_dwordx4 v[128:131], v2, s[40:43], s70 offen offset:0 sc1
  s_waitcnt lgkmcnt(5)
  v_pk_add_f32 v[96:97], v[96:97], v[104:105]
  v_pk_add_f32 v[98:99], v[98:99], v[106:107]
  s_waitcnt lgkmcnt(4)
  v_pk_add_f32 v[100:101], v[100:101], v[108:109]
  v_pk_add_f32 v[102:103], v[102:103], v[110:111]
  v_mfma_f32_32x32x16_bf16 v[224:239], a[196:199], a[128:131], v[224:239]
  ds_read_b64_tr_b16 a[196:197], v4 offset:57344
  ds_read_b64_tr_b16 a[198:199], v4 offset:57856
  v_cvt_pk_bf16_f32 v96, v96, v97
  v_cvt_pk_bf16_f32 v97, v98, v99
  v_cvt_pk_bf16_f32 v98, v100, v101
  v_cvt_pk_bf16_f32 v99, v102, v103
  v_mfma_f32_32x32x16_bf16 v[144:159], a[200:203], a[132:135], v[144:159]
  buffer_store_dwordx4 v[96:99], v2, s[40:43], s70 offen offset:1024 sc1
  s_waitcnt lgkmcnt(5)
  v_pk_add_f32 v[208:209], v[208:209], v[216:217]
  v_pk_add_f32 v[210:211], v[210:211], v[218:219]
  s_waitcnt vmcnt(9)
  s_add_u32 s67, s68, 9216
  v_mfma_f32_32x32x16_bf16 v[160:175], a[200:203], a[8:11], v[160:175]
  buffer_store_dword v7, off, s[40:43], s67 sc1
  s_waitcnt lgkmcnt(4)
  v_pk_add_f32 v[212:213], v[212:213], v[220:221]
  v_pk_add_f32 v[214:215], v[214:215], v[222:223]
  s_waitcnt vmcnt(6)
  s_add_u32 s67, s69, 6148
  v_mfma_f32_32x32x16_bf16 v[224:239], a[200:203], a[12:15], v[224:239]
  buffer_store_dword v7, off, s[40:43], s67 sc1
  ds_read_b64_tr_b16 a[200:201], v4 offset:59392
  ds_read_b64_tr_b16 a[202:203], v4 offset:59904
  v_cvt_pk_bf16_f32 v208, v208, v209
  v_cvt_pk_bf16_f32 v209, v210, v211
  s_waitcnt lgkmcnt(4)
  v_mfma_f32_32x32x16_bf16 v[144:159], a[192:195], a[80:83], v[144:159]
  v_cvt_pk_bf16_f32 v210, v212, v213
  v_cvt_pk_bf16_f32 v211, v214, v215
  v_mfma_f32_32x32x16_bf16 v[160:175], a[192:195], a[84:87], v[160:175]
  buffer_store_dwordx4 v[208:211], v2, s[40:43], s70 offen offset:2048 sc1
  v_mfma_f32_32x32x16_bf16 v[224:239], a[192:195], a[144:147], v[224:239]
  ds_read_b64_tr_b16 a[192:193], v4 offset:53248
  ds_read_b64_tr_b16 a[194:195], v4 offset:53760
  s_waitcnt lgkmcnt(4)
  v_mfma_f32_32x32x16_bf16 v[144:159], a[196:199], a[72:75], v[144:159]
  v_mfma_f32_32x32x16_bf16 v[160:175], a[196:199], a[76:79], v[160:175]
  v_mfma_f32_32x32x16_bf16 v[224:239], a[196:199], a[136:139], v[224:239]
  ds_read_b64_tr_b16 a[196:197], v4 offset:55296
  ds_read_b64_tr_b16 a[198:199], v4 offset:55808
  s_waitcnt lgkmcnt(4)
  v_mfma_f32_32x32x16_bf16 v[144:159], a[200:203], a[148:151], v[144:159]
  s_add_u32 s59, s71, 9216
  v_mfma_f32_32x32x16_bf16 v[160:175], a[200:203], a[24:27], v[160:175]
  buffer_load_dwordx4 v[8:11], off, s[40:43], s59 sc1
  v_mfma_f32_32x32x16_bf16 v[224:239], a[200:203], a[28:31], v[224:239]
  ds_read_b64_tr_b16 a[200:201], v4 offset:49152
  ds_read_b64_tr_b16 a[202:203], v4 offset:49664
  s_waitcnt lgkmcnt(4)
  v_mfma_f32_32x32x16_bf16 v[144:159], a[192:195], a[140:143], v[144:159]
  v_mfma_f32_32x32x16_bf16 v[160:175], a[192:195], a[16:19], v[160:175]
  v_mfma_f32_32x32x16_bf16 v[224:239], a[192:195], a[20:23], v[224:239]
  ds_read_b64_tr_b16 a[192:193], v4 offset:51200
  ds_read_b64_tr_b16 a[194:195], v4 offset:51712
  s_waitcnt lgkmcnt(4)
  v_mfma_f32_32x32x16_bf16 v[144:159], a[196:199], a[88:91], v[144:159]
  v_mfma_f32_32x32x16_bf16 v[160:175], a[196:199], a[92:95], v[160:175]
  v_mfma_f32_32x32x16_bf16 v[224:239], a[196:199], a[152:155], v[224:239]
  ds_read_b64_tr_b16 a[196:197], v5 offset:4096
  ds_read_b64_tr_b16 a[198:199], v5 offset:4608
  s_waitcnt lgkmcnt(4)
  v_mfma_f32_32x32x16_bf16 v[144:159], a[200:203], a[156:159], v[144:159]
  v_mfma_f32_32x32x16_bf16 v[160:175], a[200:203], a[32:35], v[160:175]
  v_mfma_f32_32x32x16_bf16 v[224:239], a[200:203], a[36:39], v[224:239]
  ds_read_b64_tr_b16 a[200:201], v5 offset:6144
  ds_read_b64_tr_b16 a[202:203], v5 offset:6656
  s_waitcnt lgkmcnt(4)
  v_mfma_f32_32x32x16_bf16 v[144:159], a[192:195], a[104:107], v[144:159]
  s_waitcnt vmcnt(6)
  s_barrier
  v_mfma_f32_32x32x16_bf16 v[160:175], a[192:195], a[108:111], v[160:175]
  v_mfma_f32_32x32x16_bf16 v[224:239], a[192:195], a[168:171], v[224:239]
  ds_read_b64_tr_b16 a[192:193], v5 offset:8192
  ds_read_b64_tr_b16 a[194:195], v5 offset:8704
  s_waitcnt lgkmcnt(4)
  v_mfma_f32_32x32x16_bf16 v[144:159], a[196:199], a[96:99], v[144:159]
  v_mfma_f32_32x32x16_bf16 v[160:175], a[196:199], a[100:103], v[160:175]
  v_mfma_f32_32x32x16_bf16 v[224:239], a[196:199], a[160:163], v[224:239]
  ds_read_b64_tr_b16 a[196:197], v5 offset:10240
  ds_read_b64_tr_b16 a[198:199], v5 offset:10752
  s_waitcnt lgkmcnt(4)
  v_mfma_f32_32x32x16_bf16 v[144:159], a[200:203], a[172:175], v[144:159]
  v_mfma_f32_32x32x16_bf16 v[160:175], a[200:203], a[48:51], v[160:175]
  v_mfma_f32_32x32x16_bf16 v[224:239], a[200:203], a[52:55], v[224:239]
  ds_read_b64_tr_b16 a[200:201], v5 offset:12288
  ds_read_b64_tr_b16 a[202:203], v5 offset:12800
  s_waitcnt lgkmcnt(4)
  v_mfma_f32_32x32x16_bf16 v[144:159], a[192:195], a[164:167], v[144:159]
  s_waitcnt vmcnt(0)
  v_min_u32 v8, v8, v9
  v_cmp_eq_u32 vcc, 0, v8
  s_cbranch_vccnz L_sp_p01
L_sb_p01:
  s_add_u32 s59, s71, 0
  v_mfma_f32_32x32x16_bf16 v[160:175], a[192:195], a[40:43], v[160:175]
  buffer_load_dwordx4 v[40:43], v2, s[40:43], s59 offen offset:0 sc1
  v_mfma_f32_32x32x16_bf16 v[224:239], a[192:195], a[44:47], v[224:239]
  buffer_load_dwordx4 v[72:75], v2, s[40:43], s59 offen offset:1024 sc1
  ds_read_b64_tr_b16 a[192:193], v5 offset:14336
  ds_read_b64_tr_b16 a[194:195], v5 offset:14848
  s_waitcnt lgkmcnt(4)
  v_mfma_f32_32x32x16_bf16 v[144:159], a[196:199], a[112:115], v[144:159]
  buffer_load_dwordx4 v[184:187], v2, s[40:43], s59 offen offset:2048 sc1
  s_add_u32 s59, s71, 3072
  v_mfma_f32_32x32x16_bf16 v[160:175], a[196:199], a[116:119], v[160:175]
  buffer_load_dwordx4 v[56:59], v2, s[40:43], s59 offen offset:0 sc1
  v_mfma_f32_32x32x16_bf16 v[224:239], a[196:199], a[176:179], v[224:239]
  buffer_load_dwordx4 v[88:91], v2, s[40:43], s59 offen offset:1024 sc1
  ds_read_b64_tr_b16 a[196:197], v5 offset:16384
  ds_read_b64_tr_b16 a[198:199], v5 offset:16896
  s_waitcnt lgkmcnt(4)
  v_mfma_f32_32x32x16_bf16 v[144:159], a[200:203], a[180:183], v[144:159]
  buffer_load_dwordx4 v[200:203], v2, s[40:43], s59 offen offset:2048 sc1
  v_mfma_f32_32x32x16_bf16 v[160:175], a[200:203], a[56:59], v[160:175]
  v_mfma_f32_32x32x16_bf16 v[224:239], a[200:203], a[60:63], v[224:239]
  ds_read_b64_tr_b16 a[200:201], v5 offset:18432
  ds_read_b64_tr_b16 a[202:203], v5 offset:18944
  s_waitcnt lgkmcnt(4)
  v_mfma_f32_32x32x16_bf16 v[144:159], a[192:195], v[248:251], v[144:159]
  v_mfma_f32_32x32x16_bf16 v[160:175], a[192:195], v[252:255], v[160:175]
  v_mfma_f32_32x32x16_bf16 v[224:239], a[192:195], v[28:31], v[224:239]
  ds_read_b64_tr_b16 a[192:193], v5 offset:20480
  ds_read_b64_tr_b16 a[194:195], v5 offset:20992
  s_waitcnt lgkmcnt(4)
  v_mfma_f32_32x32x16_bf16 v[144:159], a[196:199], a[120:123], v[144:159]
  s_waitcnt vmcnt(5)
  v_lshlrev_b32 v32, 16, v40
  v_and_b32 v33, 0xffff0000, v40
  v_lshlrev_b32 v34, 16, v41
  v_and_b32 v35, 0xffff0000, v41
  v_lshlrev_b32 v36, 16, v42
  v_and_b32 v37, 0xffff0000, v42
  v_mfma_f32_32x32x16_bf16 v[160:175], a[196:199], a[124:127], v[160:175]
  v_lshlrev_b32 v38, 16, v43
  v_and_b32 v39, 0xffff0000, v43
  s_waitcnt vmcnt(4)
  v_lshlrev_b32 v64, 16, v72
  v_and_b32 v65, 0xffff0000, v72
  v_lshlrev_b32 v66, 16, v73
  v_and_b32 v67, 0xffff0000, v73
  v_mfma_f32_32x32x16_bf16 v[224:239], a[196:199], a[184:187], v[224:239]
  ds_read_b64_tr_b16 a[196:197], v5 offset:22528
  ds_read_b64_tr_b16 a[198:199], v5 offset:23040
  v_lshlrev_b32 v68, 16, v74
  v_and_b32 v69, 0xffff0000, v74
  v_lshlrev_b32 v70, 16, v75
  v_and_b32 v71, 0xffff0000, v75
  s_waitcnt lgkmcnt(4)
  v_mfma_f32_32x32x16_bf16 v[144:159], a[200:203], v[20:23], v[144:159]
  s_waitcnt vmcnt(3)
  v_lshlrev_b32 v176, 16, v184
  v_and_b32 v177, 0xffff0000, v184
  v_lshlrev_b32 v178, 16, v185
  v_and_b32 v179, 0xffff0000, v185
  v_lshlrev_b32 v180, 16, v186
  v_and_b32 v181, 0xffff0000, v186
  v_mfma_f32_32x32x16_bf16 v[160:175], a[200:203], v[240:243], v[160:175]
  v_lshlrev_b32 v182, 16, v187
  v_and_b32 v183, 0xffff0000, v187
  s_waitcnt vmcnt(2)
  v_lshlrev_b32 v48, 16, v56
  v_and_b32 v49, 0xffff0000, v56
  v_lshlrev_b32 v50, 16, v57
  v_and_b32 v51, 0xffff0000, v57
  v_mfma_f32_32x32x16_bf16 v[224:239], a[200:203], v[244:247], v[224:239]
  v_lshlrev_b32 v52, 16, v58
  v_and_b32 v53, 0xffff0000, v58
  v_lshlrev_b32 v54, 16, v59
  v_and_b32 v55, 0xffff0000, v59
  v_pk_add_f32 v[32:33], v[32:33], v[48:49]
  s_add_u32 s59, s71, 6144
  s_waitcnt lgkmcnt(2)
  v_mfma_f32_32x32x16_bf16 v[144:159], a[192:195], a[188:191], v[144:159]
  buffer_load_dwordx4 v[136:139], v2, s[40:43], s59 offen offset:0 sc1
  v_pk_add_f32 v[34:35], v[34:35], v[50:51]
  v_pk_add_f32 v[36:37], v[36:37], v[52:53]
  v_pk_add_f32 v[38:39], v[38:39], v[54:55]
  s_waitcnt vmcnt(2)
  v_lshlrev_b32 v80, 16, v88
  v_mfma_f32_32x32x16_bf16 v[160:175], a[192:195], v[112:115], v[160:175]
  buffer_load_dwordx4 v[104:107], v2, s[40:43], s59 offen offset:1024 sc1
  v_and_b32 v81, 0xffff0000, v88
  v_lshlrev_b32 v82, 16, v89
  v_and_b32 v83, 0xffff0000, v89
  v_lshlrev_b32 v84, 16, v90
  v_mfma_f32_32x32x16_bf16 v[224:239], a[192:195], v[116:119], v[224:239]
  buffer_load_dwordx4 v[216:219], v2, s[40:43], s59 offen offset:2048 sc1
  v_and_b32 v85, 0xffff0000, v90
  v_lshlrev_b32 v86, 16, v91
  v_and_b32 v87, 0xffff0000, v91
  v_pk_add_f32 v[64:65], v[64:65], v[80:81]
  s_waitcnt lgkmcnt(0)
  v_mfma_f32_32x32x16_bf16 v[144:159], a[196:199], v[120:123], v[144:159]
  v_pk_add_f32 v[66:67], v[66:67], v[82:83]
  v_pk_add_f32 v[68:69], v[68:69], v[84:85]
  v_pk_add_f32 v[70:71], v[70:71], v[86:87]
  s_waitcnt vmcnt(3)
  v_lshlrev_b32 v192, 16, v200
  v_and_b32 v193, 0xffff0000, v200
  v_lshlrev_b32 v194, 16, v201
  v_mfma_f32_32x32x16_bf16 v[160:175], a[196:199], v[124:127], v[160:175]
  v_and_b32 v195, 0xffff0000, v201
  v_lshlrev_b32 v196, 16, v202
  v_and_b32 v197, 0xffff0000, v202
  v_lshlrev_b32 v198, 16, v203
  v_and_b32 v199, 0xffff0000, v203
  v_pk_add_f32 v[176:177], v[176:177], v[192:193]
  v_mfma_f32_32x32x16_bf16 v[224:239], a[196:199], v[24:27], v[224:239]
  v_pk_add_f32 v[178:179], v[178:179], v[194:195]
  v_pk_add_f32 v[180:181], v[180:181], v[196:197]
  v_pk_add_f32 v[182:183], v[182:183], v[198:199]
  ds_write_b128 v16, v[152:155] offset:24576
  ds_write_b128 v16, v[156:159] offset:25600
  ds_write_b128 v16, v[168:171] offset:26624
  ds_write_b128 v16, v[172:175] offset:27648
  s_nop 4
  ds_write_b128 v16, v[232:235] offset:28672
  ds_write_b128 v16, v[236:239] offset:29696
  s_waitcnt lgkmcnt(0)
  s_barrier
  ds_read_b128 v[152:155], v17 offset:24576
  ds_read_b128 v[156:159], v17 offset:25600
  ds_read_b128 v[168:171], v17 offset:26624
  ds_read_b128 v[172:175], v17 offset:27648
  ds_read_b128 v[232:235], v17 offset:28672
  ds_read_b128 v[236:239], v17 offset:29696
  v_pk_add_f32 v[144:145], v[144:145], v[32:33]
  v_pk_add_f32 v[146:147], v[146:147], v[34:35]
  v_pk_add_f32 v[148:149], v[148:149], v[36:37]
  v_pk_add_f32 v[150:151], v[150:151], v[38:39]
  v_pk_add_f32 v[160:161], v[160:161], v[64:65]
  v_pk_add_f32 v[162:163], v[162:163], v[66:67]
  v_pk_add_f32 v[164:165], v[164:165], v[68:69]
  v_pk_add_f32 v[166:167], v[166:167], v[70:71]
  v_pk_add_f32 v[224:225], v[224:225], v[176:177]
  v_pk_add_f32 v[226:227], v[226:227], v[178:179]
  v_pk_add_f32 v[228:229], v[228:229], v[180:181]
  v_pk_add_f32 v[230:231], v[230:231], v[182:183]
  s_waitcnt lgkmcnt(5)
  v_pk_add_f32 v[144:145], v[144:145], v[152:153]
  v_pk_add_f32 v[146:147], v[146:147], v[154:155]
  s_waitcnt lgkmcnt(4)
  v_pk_add_f32 v[148:149], v[148:149], v[156:157]
  v_pk_add_f32 v[150:151], v[150:151], v[158:159]
  s_waitcnt lgkmcnt(3)
  v_pk_add_f32 v[160:161], v[160:161], v[168:169]
  v_pk_add_f32 v[162:163], v[162:163], v[170:171]
  s_waitcnt lgkmcnt(2)
  v_pk_add_f32 v[164:165], v[164:165], v[172:173]
  v_pk_add_f32 v[166:167], v[166:167], v[174:175]
  s_waitcnt lgkmcnt(1)
  v_pk_add_f32 v[224:225], v[224:225], v[232:233]
  v_pk_add_f32 v[226:227], v[226:227], v[234:235]
  s_waitcnt lgkmcnt(0)
  v_pk_add_f32 v[228:229], v[228:229], v[236:237]
  v_pk_add_f32 v[230:231], v[230:231], v[238:239]
  s_waitcnt vmcnt(2)
  v_max3_u32 v19, v136, v137, v138
  s_waitcnt vmcnt(1)
  v_max3_u32 v19, v19, v139, v104
  v_max3_u32 v19, v19, v105, v106
  s_waitcnt vmcnt(0)
  v_max3_u32 v19, v19, v107, v216
  v_max3_u32 v19, v19, v217, v218
  v_max_u32 v19, v19, v219
  v_cmp_eq_u32 vcc, -1, v19
  s_cbranch_vccnz L_sp_p2
L_sb_p2:
  v_lshlrev_b32 v128, 16, v136
  v_and_b32 v129, 0xffff0000, v136
  v_lshlrev_b32 v130, 16, v137
  v_and_b32 v131, 0xffff0000, v137
  v_lshlrev_b32 v132, 16, v138
  v_and_b32 v133, 0xffff0000, v138
  v_lshlrev_b32 v134, 16, v139
  v_and_b32 v135, 0xffff0000, v139
  v_pk_add_f32 v[144:145], v[144:145], v[128:129]
  v_pk_add_f32 v[146:147], v[146:147], v[130:131]
  v_pk_add_f32 v[148:149], v[148:149], v[132:133]
  v_pk_add_f32 v[150:151], v[150:151], v[134:135]
  v_cvt_pk_bf16_f32 v152, v144, v145
  v_cvt_pk_bf16_f32 v153, v146, v147
  v_cvt_pk_bf16_f32 v154, v148, v149
  v_cvt_pk_bf16_f32 v155, v150, v151
  s_mov_b32 s64, 0
  buffer_store_dwordx4 v[152:155], v18, s[20:23], s64 offen
  v_lshlrev_b32 v96, 16, v104
  v_and_b32 v97, 0xffff0000, v104
  v_lshlrev_b32 v98, 16, v105
  v_and_b32 v99, 0xffff0000, v105
  v_lshlrev_b32 v100, 16, v106
  v_and_b32 v101, 0xffff0000, v106
  v_lshlrev_b32 v102, 16, v107
  v_and_b32 v103, 0xffff0000, v107
  v_pk_add_f32 v[160:161], v[160:161], v[96:97]
  v_pk_add_f32 v[162:163], v[162:163], v[98:99]
  v_pk_add_f32 v[164:165], v[164:165], v[100:101]
  v_pk_add_f32 v[166:167], v[166:167], v[102:103]
  v_cvt_pk_bf16_f32 v168, v160, v161
  v_cvt_pk_bf16_f32 v169, v162, v163
  v_cvt_pk_bf16_f32 v170, v164, v165
  v_cvt_pk_bf16_f32 v171, v166, v167
  s_mov_b32 s64, 32768
  buffer_store_dwordx4 v[168:171], v18, s[20:23], s64 offen
  v_lshlrev_b32 v208, 16, v216
  v_and_b32 v209, 0xffff0000, v216
  v_lshlrev_b32 v210, 16, v217
  v_and_b32 v211, 0xffff0000, v217
  v_lshlrev_b32 v212, 16, v218
  v_and_b32 v213, 0xffff0000, v218
  v_lshlrev_b32 v214, 16, v219
  v_and_b32 v215, 0xffff0000, v219
  v_pk_add_f32 v[224:225], v[224:225], v[208:209]
  v_pk_add_f32 v[226:227], v[226:227], v[210:211]
  v_pk_add_f32 v[228:229], v[228:229], v[212:213]
  v_pk_add_f32 v[230:231], v[230:231], v[214:215]
  v_cvt_pk_bf16_f32 v232, v224, v225
  v_cvt_pk_bf16_f32 v233, v226, v227
  v_cvt_pk_bf16_f32 v234, v228, v229
  v_cvt_pk_bf16_f32 v235, v230, v231
  s_mov_b32 s64, 65536
  buffer_store_dwordx4 v[232:235], v18, s[20:23], s64 offen
L_end:
  s_endpgm
L_sp_arr:
  s_mov_b32 s74, 30000
L_sl_arr:
  buffer_load_dwordx4 v[8:11], v12, s[48:51], 0 offen sc1
  s_waitcnt vmcnt(0)
  v_min3_u32 v8, v8, v9, v10
  v_min_u32 v8, v8, v11
  v_cmp_gt_u32 vcc, s64, v8
  s_cbranch_vccz L_sd_arr
  s_sub_u32 s74, s74, 1
  s_cmp_lg_u32 s74, 0
  s_cbranch_scc1 L_sl_arr
L_sd_arr:
  s_nop 1
  s_branch L_sb_arr
L_tr3:
  s_call_b64 s[56:57], L_rare_0_1_1
  s_branch L_bk3
L_tr4:
  s_call_b64 s[56:57], L_rare_1_0_0
  s_branch L_bk4
L_tr5:
  s_call_b64 s[56:57], L_rare_2_1_1
  s_branch L_bk5
L_tr6:
  s_call_b64 s[56:57], L_rare_0_0_0
  s_branch L_bk6
L_tr7:
  s_call_b64 s[56:57], L_rare_1_1_1
  s_branch L_bk7
L_tr8:
  s_call_b64 s[56:57], L_rare_2_0_0
  s_branch L_bk8
L_tr9:
  s_call_b64 s[56:57], L_rare_0_1_1
  s_branch L_bk9
L_tr10:
  s_call_b64 s[56:57], L_rare_1_0_0
  s_branch L_bk10
L_tr11:
  s_call_b64 s[56:57], L_rare_2_1_1
  s_branch L_bk11
L_tr12:
  s_call_b64 s[56:57], L_rare_0_0_0
  s_branch L_bk12
L_tr13:
  s_call_b64 s[56:57], L_rare_1_1_1
  s_branch L_bk13
L_tr14:
  s_call_b64 s[56:57], L_rare_2_0_0
  s_branch L_bk14
L_tr15:
  s_call_b64 s[56:57], L_rare_0_1_1
  s_branch L_bk15
L_tr16:
  s_call_b64 s[56:57], L_rare_1_0_0
  s_branch L_bk16
L_tr17:
  s_call_b64 s[56:57], L_rare_2_1_1
  s_branch L_bk17
L_tr18:
  s_call_b64 s[56:57], L_rare_0_0_0
  s_branch L_bk18
L_tr19:
  s_call_b64 s[56:57], L_rare_1_1_1
  s_branch L_bk19
L_tr20:
  s_call_b64 s[56:57], L_rare_2_0_0
  s_branch L_bk20
L_tr21:
  s_call_b64 s[56:57], L_rare_0_1_1
  s_branch L_bk21
L_tr22:
  s_call_b64 s[56:57], L_rare_1_0_0
  s_branch L_bk22
L_tr23:
  s_call_b64 s[56:57], L_rare_2_1_1
  s_branch L_bk23
L_tr24:
  s_call_b64 s[56:57], L_rare_0_0_0
  s_branch L_bk24
L_tr25:
  s_call_b64 s[56:57], L_rare_1_1_1
  s_branch L_bk25
L_tr26:
  s_call_b64 s[56:57], L_rare_2_0_0
  s_branch L_bk26
L_tr27:
  s_call_b64 s[56:57], L_rare_0_1_1
  s_branch L_bk27
L_tr28:
  s_call_b64 s[56:57], L_rare_1_0_0
  s_branch L_bk28
L_tr29:
  s_call_b64 s[56:57], L_rare_2_1_1
  s_branch L_bk29
L_tr30:
  s_call_b64 s[56:57], L_rare_0_0_0
  s_branch L_bk30
L_tr31:
  s_call_b64 s[56:57], L_rare_1_1_1
  s_branch L_bk31
L_tr32:
  s_call_b64 s[56:57], L_rare_2_0_0
  s_branch L_bk32
L_tr33:
  s_call_b64 s[56:57], L_rare_0_1_1
  s_branch L_bk33
L_tr34:
  s_call_b64 s[56:57], L_rare_1_0_0
  s_branch L_bk34
L_tr35:
  s_call_b64 s[56:57], L_rare_2_1_1
  s_branch L_bk35
L_tr36:
  s_call_b64 s[56:57], L_rare_0_0_0
  s_branch L_bk36
L_tr37:
  s_call_b64 s[56:57], L_rare_1_1_1
  s_branch L_bk37
L_tr38:
  s_call_b64 s[56:57], L_rare_2_0_0
  s_branch L_bk38
L_tr39:
  s_call_b64 s[56:57], L_rare_0_1_1
  s_branch L_bk39
L_tr40:
  s_call_b64 s[56:57], L_rare_1_0_0
  s_branch L_bk40
L_tr41:
  s_call_b64 s[56:57], L_rare_2_1_1
  s_branch L_bk41
L_tr42:
  s_call_b64 s[56:57], L_rare_0_0_0
  s_branch L_bk42
L_tr43:
  s_call_b64 s[56:57], L_rare_1_1_1
  s_branch L_bk43
L_tr44:
  s_call_b64 s[56:57], L_rare_2_0_0
  s_branch L_bk44
L_tr45:
  s_call_b64 s[56:57], L_rare_0_1_1
  s_branch L_bk45
L_tr46:
  s_call_b64 s[56:57], L_rare_1_0_0
  s_branch L_bk46
L_tr47:
  s_call_b64 s[56:57], L_rare_2_1_1
  s_branch L_bk47
L_sp_f0:
  s_mov_b32 s74, 30000
L_sl_f0:
  buffer_load_dwordx4 v[8:11], off, s[44:47], 0 sc1
  s_waitcnt vmcnt(0)
  v_min3_u32 v8, v8, v9, v10
  v_min_u32 v8, v8, v11
  v_cmp_gt_u32 vcc, 4, v8
  s_cbranch_vccz L_sd_f0
  s_sub_u32 s74, s74, 1
  s_cmp_lg_u32 s74, 0
  s_cbranch_scc1 L_sl_f0
L_sd_f0:
  s_nop 1
  s_branch L_sb_f0
L_sp_f1:
  s_mov_b32 s74, 30000
L_sl_f1:
  buffer_load_dwordx4 v[8:11], off, s[44:47], 0 sc1
  s_waitcnt vmcnt(0)
  v_min3_u32 v8, v8, v9, v10
  v_min_u32 v8, v8, v11
  v_cmp_gt_u32 vcc, 8, v8
  s_cbranch_vccz L_sd_f1
  s_sub_u32 s74, s74, 1
  s_cmp_lg_u32 s74, 0
  s_cbranch_scc1 L_sl_f1
L_sd_f1:
  s_nop 1
  s_branch L_sb_f1
L_sp_p01:
  s_mov_b32 s74, 30000
L_sl_p01:
  buffer_load_dwordx4 v[8:11], off, s[40:43], s59 sc1
  s_waitcnt vmcnt(0)
  v_min_u32 v8, v8, v9
  v_cmp_eq_u32 vcc, 0, v8
  s_cbranch_vccz L_sd_p01
  s_sub_u32 s74, s74, 1
  s_cmp_lg_u32 s74, 0
  s_cbranch_scc1 L_sl_p01
L_sd_p01:
  s_nop 1
  s_branch L_sb_p01
L_sp_p2:
  s_mov_b32 s74, 30000
L_sl_p2:
  buffer_load_dwordx4 v[136:139], v2, s[40:43], s59 offen offset:0 sc1
  buffer_load_dwordx4 v[104:107], v2, s[40:43], s59 offen offset:1024 sc1
  buffer_load_dwordx4 v[216:219], v2, s[40:43], s59 offen offset:2048 sc1
  s_waitcnt vmcnt(0)
  v_max3_u32 v19, v136, v137, v138
  v_max3_u32 v19, v19, v139, v104
  v_max3_u32 v19, v19, v105, v106
  v_max3_u32 v19, v19, v107, v216
  v_max3_u32 v19, v19, v217, v218
  v_max_u32 v19, v19, v219
  v_cmp_eq_u32 vcc, -1, v19
  s_cbranch_vccz L_sd_p2
  s_sub_u32 s74, s74, 1
  s_cmp_lg_u32 s74, 0
  s_cbranch_scc1 L_sl_p2
L_sd_p2:
  s_nop 1
  s_branch L_sb_p2
L_rare_0_1_1:
  s_nop 7
  s_nop 7
  v_max3_f32 v28, v208, v209, v210
  v_max3_f32 v29, v211, v212, v213
  v_max3_f32 v28, v28, v214, v215
  v_max3_f32 v29, v29, v216, v217
  v_max3_f32 v28, v28, v218, v219
  v_max3_f32 v29, v29, v220, v221
  v_max3_f32 v28, v28, v222, v223
  v_max_f32 v28, v28, v29
  v_mov_b32 v29, v28
  s_nop 1
  v_permlane32_swap_b32 v28, v29
  v_max_f32 v28, v28, v29
  v_max_f32 v30, 0, v28
  v_sub_f32 v29, 0, v30
  v_exp_f32 v29, v29
  v_sub_f32 v160, v160, v30
  v_sub_f32 v161, v161, v30
  v_sub_f32 v162, v162, v30
  v_sub_f32 v163, v163, v30
  v_sub_f32 v164, v164, v30
  v_sub_f32 v165, v165, v30
  v_sub_f32 v166, v166, v30
  v_sub_f32 v167, v167, v30
  v_sub_f32 v168, v168, v30
  v_sub_f32 v169, v169, v30
  v_sub_f32 v170, v170, v30
  v_sub_f32 v171, v171, v30
  v_sub_f32 v172, v172, v30
  v_sub_f32 v173, v173, v30
  v_sub_f32 v174, v174, v30
  v_sub_f32 v175, v175, v30
  v_mul_f32 v25, v25, v29
  v_accvgpr_read_b32 v224, a0
  v_accvgpr_read_b32 v225, a1
  v_accvgpr_read_b32 v226, a2
  v_accvgpr_read_b32 v227, a3
  v_accvgpr_read_b32 v228, a4
  v_accvgpr_read_b32 v229, a5
  v_accvgpr_read_b32 v230, a6
  v_accvgpr_read_b32 v231, a7
  v_accvgpr_read_b32 v232, a8
  v_accvgpr_read_b32 v233, a9
  v_accvgpr_read_b32 v234, a10
  v_accvgpr_read_b32 v235, a11
  v_accvgpr_read_b32 v236, a12
  v_accvgpr_read_b32 v237, a13
  v_accvgpr_read_b32 v238, a14
  v_accvgpr_read_b32 v239, a15
  v_mul_f32 v224, v224, v29
  v_mul_f32 v225, v225, v29
  v_mul_f32 v226, v226, v29
  v_mul_f32 v227, v227, v29
  v_mul_f32 v228, v228, v29
  v_mul_f32 v229, v229, v29
  v_mul_f32 v230, v230, v29
  v_mul_f32 v231, v231, v29
  v_mul_f32 v232, v232, v29
  v_mul_f32 v233, v233, v29
  v_mul_f32 v234, v234, v29
  v_mul_f32 v235, v235, v29
  v_mul_f32 v236, v236, v29
  v_mul_f32 v237, v237, v29
  v_mul_f32 v238, v238, v29
  v_mul_f32 v239, v239, v29
  v_accvgpr_write_b32 a0, v224
  v_accvgpr_write_b32 a1, v225
  v_accvgpr_write_b32 a2, v226
  v_accvgpr_write_b32 a3, v227
  v_accvgpr_write_b32 a4, v228
  v_accvgpr_write_b32 a5, v229
  v_accvgpr_write_b32 a6, v230
  v_accvgpr_write_b32 a7, v231
  v_accvgpr_write_b32 a8, v232
  v_accvgpr_write_b32 a9, v233
  v_accvgpr_write_b32 a10, v234
  v_accvgpr_write_b32 a11, v235
  v_accvgpr_write_b32 a12, v236
  v_accvgpr_write_b32 a13, v237
  v_accvgpr_write_b32 a14, v238
  v_accvgpr_write_b32 a15, v239
  v_accvgpr_read_b32 v224, a16
  v_accvgpr_read_b32 v225, a17
  v_accvgpr_read_b32 v226, a18
  v_accvgpr_read_b32 v227, a19
  v_accvgpr_read_b32 v228, a20
  v_accvgpr_read_b32 v229, a21
  v_accvgpr_read_b32 v230, a22
  v_accvgpr_read_b32 v231, a23
  v_accvgpr_read_b32 v232, a24
  v_accvgpr_read_b32 v233, a25
  v_accvgpr_read_b32 v234, a26
  v_accvgpr_read_b32 v235, a27
  v_accvgpr_read_b32 v236, a28
  v_accvgpr_read_b32 v237, a29
  v_accvgpr_read_b32 v238, a30
  v_accvgpr_read_b32 v239, a31
  v_mul_f32 v224, v224, v29
  v_mul_f32 v225, v225, v29
  v_mul_f32 v226, v226, v29
  v_mul_f32 v227, v227, v29
  v_mul_f32 v228, v228, v29
  v_mul_f32 v229, v229, v29
  v_mul_f32 v230, v230, v29
  v_mul_f32 v231, v231, v29
  v_mul_f32 v232, v232, v29
  v_mul_f32 v233, v233, v29
  v_mul_f32 v234, v234, v29
  v_mul_f32 v235, v235, v29
  v_mul_f32 v236, v236, v29
  v_mul_f32 v237, v237, v29
  v_mul_f32 v238, v238, v29
  v_mul_f32 v239, v239, v29
  v_accvgpr_write_b32 a16, v224
  v_accvgpr_write_b32 a17, v225
  v_accvgpr_write_b32 a18, v226
  v_accvgpr_write_b32 a19, v227
  v_accvgpr_write_b32 a20, v228
  v_accvgpr_write_b32 a21, v229
  v_accvgpr_write_b32 a22, v230
  v_accvgpr_write_b32 a23, v231
  v_accvgpr_write_b32 a24, v232
  v_accvgpr_write_b32 a25, v233
  v_accvgpr_write_b32 a26, v234
  v_accvgpr_write_b32 a27, v235
  v_accvgpr_write_b32 a28, v236
  v_accvgpr_write_b32 a29, v237
  v_accvgpr_write_b32 a30, v238
  v_accvgpr_write_b32 a31, v239
  v_accvgpr_read_b32 v224, a32
  v_accvgpr_read_b32 v225, a33
  v_accvgpr_read_b32 v226, a34
  v_accvgpr_read_b32 v227, a35
  v_accvgpr_read_b32 v228, a36
  v_accvgpr_read_b32 v229, a37
  v_accvgpr_read_b32 v230, a38
  v_accvgpr_read_b32 v231, a39
  v_accvgpr_read_b32 v232, a40
  v_accvgpr_read_b32 v233, a41
  v_accvgpr_read_b32 v234, a42
  v_accvgpr_read_b32 v235, a43
  v_accvgpr_read_b32 v236, a44
  v_accvgpr_read_b32 v237, a45
  v_accvgpr_read_b32 v238, a46
  v_accvgpr_read_b32 v239, a47
  v_mul_f32 v224, v224, v29
  v_mul_f32 v225, v225, v29
  v_mul_f32 v226, v226, v29
  v_mul_f32 v227, v227, v29
  v_mul_f32 v228, v228, v29
  v_mul_f32 v229, v229, v29
  v_mul_f32 v230, v230, v29
  v_mul_f32 v231, v231, v29
  v_mul_f32 v232, v232, v29
  v_mul_f32 v233, v233, v29
  v_mul_f32 v234, v234, v29
  v_mul_f32 v235, v235, v29
  v_mul_f32 v236, v236, v29
  v_mul_f32 v237, v237, v29
  v_mul_f32 v238, v238, v29
  v_mul_f32 v239, v239, v29
  v_accvgpr_write_b32 a32, v224
  v_accvgpr_write_b32 a33, v225
  v_accvgpr_write_b32 a34, v226
  v_accvgpr_write_b32 a35, v227
  v_accvgpr_write_b32 a36, v228
  v_accvgpr_write_b32 a37, v229
  v_accvgpr_write_b32 a38, v230
  v_accvgpr_write_b32 a39, v231
  v_accvgpr_write_b32 a40, v232
  v_accvgpr_write_b32 a41, v233
  v_accvgpr_write_b32 a42, v234
  v_accvgpr_write_b32 a43, v235
  v_accvgpr_write_b32 a44, v236
  v_accvgpr_write_b32 a45, v237
  v_accvgpr_write_b32 a46, v238
  v_accvgpr_write_b32 a47, v239
  v_accvgpr_read_b32 v224, a48
  v_accvgpr_read_b32 v225, a49
  v_accvgpr_read_b32 v226, a50
  v_accvgpr_read_b32 v227, a51
  v_accvgpr_read_b32 v228, a52
  v_accvgpr_read_b32 v229, a53
  v_accvgpr_read_b32 v230, a54
  v_accvgpr_read_b32 v231, a55
  v_accvgpr_read_b32 v232, a56
  v_accvgpr_read_b32 v233, a57
  v_accvgpr_read_b32 v234, a58
  v_accvgpr_read_b32 v235, a59
  v_accvgpr_read_b32 v236, a60
  v_accvgpr_read_b32 v237, a61
  v_accvgpr_read_b32 v238, a62
  v_accvgpr_read_b32 v239, a63
  v_mul_f32 v224, v224, v29
  v_mul_f32 v225, v225, v29
  v_mul_f32 v226, v226, v29
  v_mul_f32 v227, v227, v29
  v_mul_f32 v228, v228, v29
  v_mul_f32 v229, v229, v29
  v_mul_f32 v230, v230, v29
  v_mul_f32 v231, v231, v29
  v_mul_f32 v232, v232, v29
  v_mul_f32 v233, v233, v29
  v_mul_f32 v234, v234, v29
  v_mul_f32 v235, v235, v29
  v_mul_f32 v236, v236, v29
  v_mul_f32 v237, v237, v29
  v_mul_f32 v238, v238, v29
  v_mul_f32 v239, v239, v29
  v_accvgpr_write_b32 a48, v224
  v_accvgpr_write_b32 a49, v225
  v_accvgpr_write_b32 a50, v226
  v_accvgpr_write_b32 a51, v227
  v_accvgpr_write_b32 a52, v228
  v_accvgpr_write_b32 a53, v229
  v_accvgpr_write_b32 a54, v230
  v_accvgpr_write_b32 a55, v231
  v_accvgpr_write_b32 a56, v232
  v_accvgpr_write_b32 a57, v233
  v_accvgpr_write_b32 a58, v234
  v_accvgpr_write_b32 a59, v235
  v_accvgpr_write_b32 a60, v236
  v_accvgpr_write_b32 a61, v237
  v_accvgpr_write_b32 a62, v238
  v_accvgpr_write_b32 a63, v239
  v_sub_f32 v224, v208, v30
  v_sub_f32 v225, v209, v30
  v_sub_f32 v226, v210, v30
  v_sub_f32 v227, v211, v30
  v_sub_f32 v228, v212, v30
  v_sub_f32 v229, v213, v30
  v_sub_f32 v230, v214, v30
  v_sub_f32 v231, v215, v30
  v_sub_f32 v232, v216, v30
  v_sub_f32 v233, v217, v30
  v_sub_f32 v234, v218, v30
  v_sub_f32 v235, v219, v30
  v_sub_f32 v236, v220, v30
  v_sub_f32 v237, v221, v30
  v_sub_f32 v238, v222, v30
  v_sub_f32 v239, v223, v30
  v_exp_f32 v224, v224
  v_exp_f32 v225, v225
  v_exp_f32 v226, v226
  v_exp_f32 v227, v227
  v_exp_f32 v228, v228
  v_exp_f32 v229, v229
  v_exp_f32 v230, v230
  v_exp_f32 v231, v231
  v_exp_f32 v232, v232
  v_exp_f32 v233, v233
  v_exp_f32 v234, v234
  v_exp_f32 v235, v235
  v_exp_f32 v236, v236
  v_exp_f32 v237, v237
  v_exp_f32 v238, v238
  v_exp_f32 v239, v239
  v_add_f32 v28, v224, v225
  v_add_f32 v29, v226, v227
  v_add_f32 v28, v28, v228
  v_add_f32 v29, v29, v229
  v_add_f32 v28, v28, v230
  v_add_f32 v29, v29, v231
  v_add_f32 v28, v28, v232
  v_add_f32 v29, v29, v233
  v_add_f32 v28, v28, v234
  v_add_f32 v29, v29, v235
  v_add_f32 v28, v28, v236
  v_add_f32 v29, v29, v237
  v_add_f32 v28, v28, v238
  v_add_f32 v29, v29, v239
  v_cvt_pk_bf16_f32 v248, v224, v225
  v_cvt_pk_bf16_f32 v249, v226, v227
  v_cvt_pk_bf16_f32 v250, v228, v229
  v_cvt_pk_bf16_f32 v251, v230, v231
  v_cvt_pk_bf16_f32 v252, v232, v233
  v_cvt_pk_bf16_f32 v253, v234, v235
  v_cvt_pk_bf16_f32 v254, v236, v237
  v_cvt_pk_bf16_f32 v255, v238, v239
  v_add_f32 v28, v28, v29
  s_nop 3
  s_setpc_b64 s[56:57]
L_rare_1_0_0:
  s_nop 7
  s_nop 7
  v_max3_f32 v28, v192, v193, v194
  v_max3_f32 v29, v195, v196, v197
  v_max3_f32 v28, v28, v198, v199
  v_max3_f32 v29, v29, v200, v201
  v_max3_f32 v28, v28, v202, v203
  v_max3_f32 v29, v29, v204, v205
  v_max3_f32 v28, v28, v206, v207
  v_max_f32 v28, v28, v29
  v_mov_b32 v29, v28
  s_nop 1
  v_permlane32_swap_b32 v28, v29
  v_max_f32 v28, v28, v29
  v_max_f32 v30, 0, v28
  v_sub_f32 v29, 0, v30
  v_exp_f32 v29, v29
  v_sub_f32 v176, v176, v30
  v_sub_f32 v177, v177, v30
  v_sub_f32 v178, v178, v30
  v_sub_f32 v179, v179, v30
  v_sub_f32 v180, v180, v30
  v_sub_f32 v181, v181, v30
  v_sub_f32 v182, v182, v30
  v_sub_f32 v183, v183, v30
  v_sub_f32 v184, v184, v30
  v_sub_f32 v185, v185, v30
  v_sub_f32 v186, v186, v30
  v_sub_f32 v187, v187, v30
  v_sub_f32 v188, v188, v30
  v_sub_f32 v189, v189, v30
  v_sub_f32 v190, v190, v30
  v_sub_f32 v191, v191, v30
  v_mul_f32 v26, v26, v29
  v_accvgpr_read_b32 v224, a64
  v_accvgpr_read_b32 v225, a65
  v_accvgpr_read_b32 v226, a66
  v_accvgpr_read_b32 v227, a67
  v_accvgpr_read_b32 v228, a68
  v_accvgpr_read_b32 v229, a69
  v_accvgpr_read_b32 v230, a70
  v_accvgpr_read_b32 v231, a71
  v_accvgpr_read_b32 v232, a72
  v_accvgpr_read_b32 v233, a73
  v_accvgpr_read_b32 v234, a74
  v_accvgpr_read_b32 v235, a75
  v_accvgpr_read_b32 v236, a76
  v_accvgpr_read_b32 v237, a77
  v_accvgpr_read_b32 v238, a78
  v_accvgpr_read_b32 v239, a79
  v_mul_f32 v224, v224, v29
  v_mul_f32 v225, v225, v29
  v_mul_f32 v226, v226, v29
  v_mul_f32 v227, v227, v29
  v_mul_f32 v228, v228, v29
  v_mul_f32 v229, v229, v29
  v_mul_f32 v230, v230, v29
  v_mul_f32 v231, v231, v29
  v_mul_f32 v232, v232, v29
  v_mul_f32 v233, v233, v29
  v_mul_f32 v234, v234, v29
  v_mul_f32 v235, v235, v29
  v_mul_f32 v236, v236, v29
  v_mul_f32 v237, v237, v29
  v_mul_f32 v238, v238, v29
  v_mul_f32 v239, v239, v29
  v_accvgpr_write_b32 a64, v224
  v_accvgpr_write_b32 a65, v225
  v_accvgpr_write_b32 a66, v226
  v_accvgpr_write_b32 a67, v227
  v_accvgpr_write_b32 a68, v228
  v_accvgpr_write_b32 a69, v229
  v_accvgpr_write_b32 a70, v230
  v_accvgpr_write_b32 a71, v231
  v_accvgpr_write_b32 a72, v232
  v_accvgpr_write_b32 a73, v233
  v_accvgpr_write_b32 a74, v234
  v_accvgpr_write_b32 a75, v235
  v_accvgpr_write_b32 a76, v236
  v_accvgpr_write_b32 a77, v237
  v_accvgpr_write_b32 a78, v238
  v_accvgpr_write_b32 a79, v239
  v_accvgpr_read_b32 v224, a80
  v_accvgpr_read_b32 v225, a81
  v_accvgpr_read_b32 v226, a82
  v_accvgpr_read_b32 v227, a83
  v_accvgpr_read_b32 v228, a84
  v_accvgpr_read_b32 v229, a85
  v_accvgpr_read_b32 v230, a86
  v_accvgpr_read_b32 v231, a87
  v_accvgpr_read_b32 v232, a88
  v_accvgpr_read_b32 v233, a89
  v_accvgpr_read_b32 v234, a90
  v_accvgpr_read_b32 v235, a91
  v_accvgpr_read_b32 v236, a92
  v_accvgpr_read_b32 v237, a93
  v_accvgpr_read_b32 v238, a94
  v_accvgpr_read_b32 v239, a95
  v_mul_f32 v224, v224, v29
  v_mul_f32 v225, v225, v29
  v_mul_f32 v226, v226, v29
  v_mul_f32 v227, v227, v29
  v_mul_f32 v228, v228, v29
  v_mul_f32 v229, v229, v29
  v_mul_f32 v230, v230, v29
  v_mul_f32 v231, v231, v29
  v_mul_f32 v232, v232, v29
  v_mul_f32 v233, v233, v29
  v_mul_f32 v234, v234, v29
  v_mul_f32 v235, v235, v29
  v_mul_f32 v236, v236, v29
  v_mul_f32 v237, v237, v29
  v_mul_f32 v238, v238, v29
  v_mul_f32 v239, v239, v29
  v_accvgpr_write_b32 a80, v224
  v_accvgpr_write_b32 a81, v225
  v_accvgpr_write_b32 a82, v226
  v_accvgpr_write_b32 a83, v227
  v_accvgpr_write_b32 a84, v228
  v_accvgpr_write_b32 a85, v229
  v_accvgpr_write_b32 a86, v230
  v_accvgpr_write_b32 a87, v231
  v_accvgpr_write_b32 a88, v232
  v_accvgpr_write_b32 a89, v233
  v_accvgpr_write_b32 a90, v234
  v_accvgpr_write_b32 a91, v235
  v_accvgpr_write_b32 a92, v236
  v_accvgpr_write_b32 a93, v237
  v_accvgpr_write_b32 a94, v238
  v_accvgpr_write_b32 a95, v239
  v_accvgpr_read_b32 v224, a96
  v_accvgpr_read_b32 v225, a97
  v_accvgpr_read_b32 v226, a98
  v_accvgpr_read_b32 v227, a99
  v_accvgpr_read_b32 v228, a100
  v_accvgpr_read_b32 v229, a101
  v_accvgpr_read_b32 v230, a102
  v_accvgpr_read_b32 v231, a103
  v_accvgpr_read_b32 v232, a104
  v_accvgpr_read_b32 v233, a105
  v_accvgpr_read_b32 v234, a106
  v_accvgpr_read_b32 v235, a107
  v_accvgpr_read_b32 v236, a108
  v_accvgpr_read_b32 v237, a109
  v_accvgpr_read_b32 v238, a110
  v_accvgpr_read_b32 v239, a111
  v_mul_f32 v224, v224, v29
  v_mul_f32 v225, v225, v29
  v_mul_f32 v226, v226, v29
  v_mul_f32 v227, v227, v29
  v_mul_f32 v228, v228, v29
  v_mul_f32 v229, v229, v29
  v_mul_f32 v230, v230, v29
  v_mul_f32 v231, v231, v29
  v_mul_f32 v232, v232, v29
  v_mul_f32 v233, v233, v29
  v_mul_f32 v234, v234, v29
  v_mul_f32 v235, v235, v29
  v_mul_f32 v236, v236, v29
  v_mul_f32 v237, v237, v29
  v_mul_f32 v238, v238, v29
  v_mul_f32 v239, v239, v29
  v_accvgpr_write_b32 a96, v224
  v_accvgpr_write_b32 a97, v225
  v_accvgpr_write_b32 a98, v226
  v_accvgpr_write_b32 a99, v227
  v_accvgpr_write_b32 a100, v228
  v_accvgpr_write_b32 a101, v229
  v_accvgpr_write_b32 a102, v230
  v_accvgpr_write_b32 a103, v231
  v_accvgpr_write_b32 a104, v232
  v_accvgpr_write_b32 a105, v233
  v_accvgpr_write_b32 a106, v234
  v_accvgpr_write_b32 a107, v235
  v_accvgpr_write_b32 a108, v236
  v_accvgpr_write_b32 a109, v237
  v_accvgpr_write_b32 a110, v238
  v_accvgpr_write_b32 a111, v239
  v_accvgpr_read_b32 v224, a112
  v_accvgpr_read_b32 v225, a113
  v_accvgpr_read_b32 v226, a114
  v_accvgpr_read_b32 v227, a115
  v_accvgpr_read_b32 v228, a116
  v_accvgpr_read_b32 v229, a117
  v_accvgpr_read_b32 v230, a118
  v_accvgpr_read_b32 v231, a119
  v_accvgpr_read_b32 v232, a120
  v_accvgpr_read_b32 v233, a121
  v_accvgpr_read_b32 v234, a122
  v_accvgpr_read_b32 v235, a123
  v_accvgpr_read_b32 v236, a124
  v_accvgpr_read_b32 v237, a125
  v_accvgpr_read_b32 v238, a126
  v_accvgpr_read_b32 v239, a127
  v_mul_f32 v224, v224, v29
  v_mul_f32 v225, v225, v29
  v_mul_f32 v226, v226, v29
  v_mul_f32 v227, v227, v29
  v_mul_f32 v228, v228, v29
  v_mul_f32 v229, v229, v29
  v_mul_f32 v230, v230, v29
  v_mul_f32 v231, v231, v29
  v_mul_f32 v232, v232, v29
  v_mul_f32 v233, v233, v29
  v_mul_f32 v234, v234, v29
  v_mul_f32 v235, v235, v29
  v_mul_f32 v236, v236, v29
  v_mul_f32 v237, v237, v29
  v_mul_f32 v238, v238, v29
  v_mul_f32 v239, v239, v29
  v_accvgpr_write_b32 a112, v224
  v_accvgpr_write_b32 a113, v225
  v_accvgpr_write_b32 a114, v226
  v_accvgpr_write_b32 a115, v227
  v_accvgpr_write_b32 a116, v228
  v_accvgpr_write_b32 a117, v229
  v_accvgpr_write_b32 a118, v230
  v_accvgpr_write_b32 a119, v231
  v_accvgpr_write_b32 a120, v232
  v_accvgpr_write_b32 a121, v233
  v_accvgpr_write_b32 a122, v234
  v_accvgpr_write_b32 a123, v235
  v_accvgpr_write_b32 a124, v236
  v_accvgpr_write_b32 a125, v237
  v_accvgpr_write_b32 a126, v238
  v_accvgpr_write_b32 a127, v239
  v_sub_f32 v224, v192, v30
  v_sub_f32 v225, v193, v30
  v_sub_f32 v226, v194, v30
  v_sub_f32 v227, v195, v30
  v_sub_f32 v228, v196, v30
  v_sub_f32 v229, v197, v30
  v_sub_f32 v230, v198, v30
  v_sub_f32 v231, v199, v30
  v_sub_f32 v232, v200, v30
  v_sub_f32 v233, v201, v30
  v_sub_f32 v234, v202, v30
  v_sub_f32 v235, v203, v30
  v_sub_f32 v236, v204, v30
  v_sub_f32 v237, v205, v30
  v_sub_f32 v238, v206, v30
  v_sub_f32 v239, v207, v30
  v_exp_f32 v224, v224
  v_exp_f32 v225, v225
  v_exp_f32 v226, v226
  v_exp_f32 v227, v227
  v_exp_f32 v228, v228
  v_exp_f32 v229, v229
  v_exp_f32 v230, v230
  v_exp_f32 v231, v231
  v_exp_f32 v232, v232
  v_exp_f32 v233, v233
  v_exp_f32 v234, v234
  v_exp_f32 v235, v235
  v_exp_f32 v236, v236
  v_exp_f32 v237, v237
  v_exp_f32 v238, v238
  v_exp_f32 v239, v239
  v_add_f32 v28, v224, v225
  v_add_f32 v29, v226, v227
  v_add_f32 v28, v28, v228
  v_add_f32 v29, v29, v229
  v_add_f32 v28, v28, v230
  v_add_f32 v29, v29, v231
  v_add_f32 v28, v28, v232
  v_add_f32 v29, v29, v233
  v_add_f32 v28, v28, v234
  v_add_f32 v29, v29, v235
  v_add_f32 v28, v28, v236
  v_add_f32 v29, v29, v237
  v_add_f32 v28, v28, v238
  v_add_f32 v29, v29, v239
  v_cvt_pk_bf16_f32 v240, v224, v225
  v_cvt_pk_bf16_f32 v241, v226, v227
  v_cvt_pk_bf16_f32 v242, v228, v229
  v_cvt_pk_bf16_f32 v243, v230, v231
  v_cvt_pk_bf16_f32 v244, v232, v233
  v_cvt_pk_bf16_f32 v245, v234, v235
  v_cvt_pk_bf16_f32 v246, v236, v237
  v_cvt_pk_bf16_f32 v247, v238, v239
  v_add_f32 v28, v28, v29
  s_nop 3
  s_setpc_b64 s[56:57]
L_rare_2_1_1:
  s_nop 7
  s_nop 7
  v_max3_f32 v28, v208, v209, v210
  v_max3_f32 v29, v211, v212, v213
  v_max3_f32 v28, v28, v214, v215
  v_max3_f32 v29, v29, v216, v217
  v_max3_f32 v28, v28, v218, v219
  v_max3_f32 v29, v29, v220, v221
  v_max3_f32 v28, v28, v222, v223
  v_max_f32 v28, v28, v29
  v_mov_b32 v29, v28
  s_nop 1
  v_permlane32_swap_b32 v28, v29
  v_max_f32 v28, v28, v29
  v_max_f32 v30, 0, v28
  v_sub_f32 v29, 0, v30
  v_exp_f32 v29, v29
  v_sub_f32 v96, v96, v30
  v_sub_f32 v97, v97, v30
  v_sub_f32 v98, v98, v30
  v_sub_f32 v99, v99, v30
  v_sub_f32 v100, v100, v30
  v_sub_f32 v101, v101, v30
  v_sub_f32 v102, v102, v30
  v_sub_f32 v103, v103, v30
  v_sub_f32 v104, v104, v30
  v_sub_f32 v105, v105, v30
  v_sub_f32 v106, v106, v30
  v_sub_f32 v107, v107, v30
  v_sub_f32 v108, v108, v30
  v_sub_f32 v109, v109, v30
  v_sub_f32 v110, v110, v30
  v_sub_f32 v111, v111, v30
  v_mul_f32 v27, v27, v29
  v_accvgpr_read_b32 v224, a128
  v_accvgpr_read_b32 v225, a129
  v_accvgpr_read_b32 v226, a130
  v_accvgpr_read_b32 v227, a131
  v_accvgpr_read_b32 v228, a132
  v_accvgpr_read_b32 v229, a133
  v_accvgpr_read_b32 v230, a134
  v_accvgpr_read_b32 v231, a135
  v_accvgpr_read_b32 v232, a136
  v_accvgpr_read_b32 v233, a137
  v_accvgpr_read_b32 v234, a138
  v_accvgpr_read_b32 v235, a139
  v_accvgpr_read_b32 v236, a140
  v_accvgpr_read_b32 v237, a141
  v_accvgpr_read_b32 v238, a142
  v_accvgpr_read_b32 v239, a143
  v_mul_f32 v224, v224, v29
  v_mul_f32 v225, v225, v29
  v_mul_f32 v226, v226, v29
  v_mul_f32 v227, v227, v29
  v_mul_f32 v228, v228, v29
  v_mul_f32 v229, v229, v29
  v_mul_f32 v230, v230, v29
  v_mul_f32 v231, v231, v29
  v_mul_f32 v232, v232, v29
  v_mul_f32 v233, v233, v29
  v_mul_f32 v234, v234, v29
  v_mul_f32 v235, v235, v29
  v_mul_f32 v236, v236, v29
  v_mul_f32 v237, v237, v29
  v_mul_f32 v238, v238, v29
  v_mul_f32 v239, v239, v29
  v_accvgpr_write_b32 a128, v224
  v_accvgpr_write_b32 a129, v225
  v_accvgpr_write_b32 a130, v226
  v_accvgpr_write_b32 a131, v227
  v_accvgpr_write_b32 a132, v228
  v_accvgpr_write_b32 a133, v229
  v_accvgpr_write_b32 a134, v230
  v_accvgpr_write_b32 a135, v231
  v_accvgpr_write_b32 a136, v232
  v_accvgpr_write_b32 a137, v233
  v_accvgpr_write_b32 a138, v234
  v_accvgpr_write_b32 a139, v235
  v_accvgpr_write_b32 a140, v236
  v_accvgpr_write_b32 a141, v237
  v_accvgpr_write_b32 a142, v238
  v_accvgpr_write_b32 a143, v239
  v_accvgpr_read_b32 v224, a144
  v_accvgpr_read_b32 v225, a145
  v_accvgpr_read_b32 v226, a146
  v_accvgpr_read_b32 v227, a147
  v_accvgpr_read_b32 v228, a148
  v_accvgpr_read_b32 v229, a149
  v_accvgpr_read_b32 v230, a150
  v_accvgpr_read_b32 v231, a151
  v_accvgpr_read_b32 v232, a152
  v_accvgpr_read_b32 v233, a153
  v_accvgpr_read_b32 v234, a154
  v_accvgpr_read_b32 v235, a155
  v_accvgpr_read_b32 v236, a156
  v_accvgpr_read_b32 v237, a157
  v_accvgpr_read_b32 v238, a158
  v_accvgpr_read_b32 v239, a159
  v_mul_f32 v224, v224, v29
  v_mul_f32 v225, v225, v29
  v_mul_f32 v226, v226, v29
  v_mul_f32 v227, v227, v29
  v_mul_f32 v228, v228, v29
  v_mul_f32 v229, v229, v29
  v_mul_f32 v230, v230, v29
  v_mul_f32 v231, v231, v29
  v_mul_f32 v232, v232, v29
  v_mul_f32 v233, v233, v29
  v_mul_f32 v234, v234, v29
  v_mul_f32 v235, v235, v29
  v_mul_f32 v236, v236, v29
  v_mul_f32 v237, v237, v29
  v_mul_f32 v238, v238, v29
  v_mul_f32 v239, v239, v29
  v_accvgpr_write_b32 a144, v224
  v_accvgpr_write_b32 a145, v225
  v_accvgpr_write_b32 a146, v226
  v_accvgpr_write_b32 a147, v227
  v_accvgpr_write_b32 a148, v228
  v_accvgpr_write_b32 a149, v229
  v_accvgpr_write_b32 a150, v230
  v_accvgpr_write_b32 a151, v231
  v_accvgpr_write_b32 a152, v232
  v_accvgpr_write_b32 a153, v233
  v_accvgpr_write_b32 a154, v234
  v_accvgpr_write_b32 a155, v235
  v_accvgpr_write_b32 a156, v236
  v_accvgpr_write_b32 a157, v237
  v_accvgpr_write_b32 a158, v238
  v_accvgpr_write_b32 a159, v239
  v_accvgpr_read_b32 v224, a160
  v_accvgpr_read_b32 v225, a161
  v_accvgpr_read_b32 v226, a162
  v_accvgpr_read_b32 v227, a163
  v_accvgpr_read_b32 v228, a164
  v_accvgpr_read_b32 v229, a165
  v_accvgpr_read_b32 v230, a166
  v_accvgpr_read_b32 v231, a167
  v_accvgpr_read_b32 v232, a168
  v_accvgpr_read_b32 v233, a169
  v_accvgpr_read_b32 v234, a170
  v_accvgpr_read_b32 v235, a171
  v_accvgpr_read_b32 v236, a172
  v_accvgpr_read_b32 v237, a173
  v_accvgpr_read_b32 v238, a174
  v_accvgpr_read_b32 v239, a175
  v_mul_f32 v224, v224, v29
  v_mul_f32 v225, v225, v29
  v_mul_f32 v226, v226, v29
  v_mul_f32 v227, v227, v29
  v_mul_f32 v228, v228, v29
  v_mul_f32 v229, v229, v29
  v_mul_f32 v230, v230, v29
  v_mul_f32 v231, v231, v29
  v_mul_f32 v232, v232, v29
  v_mul_f32 v233, v233, v29
  v_mul_f32 v234, v234, v29
  v_mul_f32 v235, v235, v29
  v_mul_f32 v236, v236, v29
  v_mul_f32 v237, v237, v29
  v_mul_f32 v238, v238, v29
  v_mul_f32 v239, v239, v29
  v_accvgpr_write_b32 a160, v224
  v_accvgpr_write_b32 a161, v225
  v_accvgpr_write_b32 a162, v226
  v_accvgpr_write_b32 a163, v227
  v_accvgpr_write_b32 a164, v228
  v_accvgpr_write_b32 a165, v229
  v_accvgpr_write_b32 a166, v230
  v_accvgpr_write_b32 a167, v231
  v_accvgpr_write_b32 a168, v232
  v_accvgpr_write_b32 a169, v233
  v_accvgpr_write_b32 a170, v234
  v_accvgpr_write_b32 a171, v235
  v_accvgpr_write_b32 a172, v236
  v_accvgpr_write_b32 a173, v237
  v_accvgpr_write_b32 a174, v238
  v_accvgpr_write_b32 a175, v239
  v_accvgpr_read_b32 v224, a176
  v_accvgpr_read_b32 v225, a177
  v_accvgpr_read_b32 v226, a178
  v_accvgpr_read_b32 v227, a179
  v_accvgpr_read_b32 v228, a180
  v_accvgpr_read_b32 v229, a181
  v_accvgpr_read_b32 v230, a182
  v_accvgpr_read_b32 v231, a183
  v_accvgpr_read_b32 v232, a184
  v_accvgpr_read_b32 v233, a185
  v_accvgpr_read_b32 v234, a186
  v_accvgpr_read_b32 v235, a187
  v_accvgpr_read_b32 v236, a188
  v_accvgpr_read_b32 v237, a189
  v_accvgpr_read_b32 v238, a190
  v_accvgpr_read_b32 v239, a191
  v_mul_f32 v224, v224, v29
  v_mul_f32 v225, v225, v29
  v_mul_f32 v226, v226, v29
  v_mul_f32 v227, v227, v29
  v_mul_f32 v228, v228, v29
  v_mul_f32 v229, v229, v29
  v_mul_f32 v230, v230, v29
  v_mul_f32 v231, v231, v29
  v_mul_f32 v232, v232, v29
  v_mul_f32 v233, v233, v29
  v_mul_f32 v234, v234, v29
  v_mul_f32 v235, v235, v29
  v_mul_f32 v236, v236, v29
  v_mul_f32 v237, v237, v29
  v_mul_f32 v238, v238, v29
  v_mul_f32 v239, v239, v29
  v_accvgpr_write_b32 a176, v224
  v_accvgpr_write_b32 a177, v225
  v_accvgpr_write_b32 a178, v226
  v_accvgpr_write_b32 a179, v227
  v_accvgpr_write_b32 a180, v228
  v_accvgpr_write_b32 a181, v229
  v_accvgpr_write_b32 a182, v230
  v_accvgpr_write_b32 a183, v231
  v_accvgpr_write_b32 a184, v232
  v_accvgpr_write_b32 a185, v233
  v_accvgpr_write_b32 a186, v234
  v_accvgpr_write_b32 a187, v235
  v_accvgpr_write_b32 a188, v236
  v_accvgpr_write_b32 a189, v237
  v_accvgpr_write_b32 a190, v238
  v_accvgpr_write_b32 a191, v239
  v_sub_f32 v224, v208, v30
  v_sub_f32 v225, v209, v30
  v_sub_f32 v226, v210, v30
  v_sub_f32 v227, v211, v30
  v_sub_f32 v228, v212, v30
  v_sub_f32 v229, v213, v30
  v_sub_f32 v230, v214, v30
  v_sub_f32 v231, v215, v30
  v_sub_f32 v232, v216, v30
  v_sub_f32 v233, v217, v30
  v_sub_f32 v234, v218, v30
  v_sub_f32 v235, v219, v30
  v_sub_f32 v236, v220, v30
  v_sub_f32 v237, v221, v30
  v_sub_f32 v238, v222, v30
  v_sub_f32 v239, v223, v30
  v_exp_f32 v224, v224
  v_exp_f32 v225, v225
  v_exp_f32 v226, v226
  v_exp_f32 v227, v227
  v_exp_f32 v228, v228
  v_exp_f32 v229, v229
  v_exp_f32 v230, v230
  v_exp_f32 v231, v231
  v_exp_f32 v232, v232
  v_exp_f32 v233, v233
  v_exp_f32 v234, v234
  v_exp_f32 v235, v235
  v_exp_f32 v236, v236
  v_exp_f32 v237, v237
  v_exp_f32 v238, v238
  v_exp_f32 v239, v239
  v_add_f32 v28, v224, v225
  v_add_f32 v29, v226, v227
  v_add_f32 v28, v28, v228
  v_add_f32 v29, v29, v229
  v_add_f32 v28, v28, v230
  v_add_f32 v29, v29, v231
  v_add_f32 v28, v28, v232
  v_add_f32 v29, v29, v233
  v_add_f32 v28, v28, v234
  v_add_f32 v29, v29, v235
  v_add_f32 v28, v28, v236
  v_add_f32 v29, v29, v237
  v_add_f32 v28, v28, v238
  v_add_f32 v29, v29, v239
  v_cvt_pk_bf16_f32 v248, v224, v225
  v_cvt_pk_bf16_f32 v249, v226, v227
  v_cvt_pk_bf16_f32 v250, v228, v229
  v_cvt_pk_bf16_f32 v251, v230, v231
  v_cvt_pk_bf16_f32 v252, v232, v233
  v_cvt_pk_bf16_f32 v253, v234, v235
  v_cvt_pk_bf16_f32 v254, v236, v237
  v_cvt_pk_bf16_f32 v255, v238, v239
  v_add_f32 v28, v28, v29
  s_nop 3
  s_setpc_b64 s[56:57]
L_rare_0_0_0:
  s_nop 7
  s_nop 7
  v_max3_f32 v28, v192, v193, v194
  v_max3_f32 v29, v195, v196, v197
  v_max3_f32 v28, v28, v198, v199
  v_max3_f32 v29, v29, v200, v201
  v_max3_f32 v28, v28, v202, v203
  v_max3_f32 v29, v29, v204, v205
  v_max3_f32 v28, v28, v206, v207
  v_max_f32 v28, v28, v29
  v_mov_b32 v29, v28
  s_nop 1
  v_permlane32_swap_b32 v28, v29
  v_max_f32 v28, v28, v29
  v_max_f32 v30, 0, v28
  v_sub_f32 v29, 0, v30
  v_exp_f32 v29, v29
  v_sub_f32 v160, v160, v30
  v_sub_f32 v161, v161, v30
  v_sub_f32 v162, v162, v30
  v_sub_f32 v163, v163, v30
  v_sub_f32 v164, v164, v30
  v_sub_f32 v165, v165, v30
  v_sub_f32 v166, v166, v30
  v_sub_f32 v167, v167, v30
  v_sub_f32 v168, v168, v30
  v_sub_f32 v169, v169, v30
  v_sub_f32 v170, v170, v30
  v_sub_f32 v171, v171, v30
  v_sub_f32 v172, v172, v30
  v_sub_f32 v173, v173, v30
  v_sub_f32 v174, v174, v30
  v_sub_f32 v175, v175, v30
  v_mul_f32 v25, v25, v29
  v_accvgpr_read_b32 v224, a0
  v_accvgpr_read_b32 v225, a1
  v_accvgpr_read_b32 v226, a2
  v_accvgpr_read_b32 v227, a3
  v_accvgpr_read_b32 v228, a4
  v_accvgpr_read_b32 v229, a5
  v_accvgpr_read_b32 v230, a6
  v_accvgpr_read_b32 v231, a7
  v_accvgpr_read_b32 v232, a8
  v_accvgpr_read_b32 v233, a9
  v_accvgpr_read_b32 v234, a10
  v_accvgpr_read_b32 v235, a11
  v_accvgpr_read_b32 v236, a12
  v_accvgpr_read_b32 v237, a13
  v_accvgpr_read_b32 v238, a14
  v_accvgpr_read_b32 v239, a15
  v_mul_f32 v224, v224, v29
  v_mul_f32 v225, v225, v29
  v_mul_f32 v226, v226, v29
  v_mul_f32 v227, v227, v29
  v_mul_f32 v228, v228, v29
  v_mul_f32 v229, v229, v29
  v_mul_f32 v230, v230, v29
  v_mul_f32 v231, v231, v29
  v_mul_f32 v232, v232, v29
  v_mul_f32 v233, v233, v29
  v_mul_f32 v234, v234, v29
  v_mul_f32 v235, v235, v29
  v_mul_f32 v236, v236, v29
  v_mul_f32 v237, v237, v29
  v_mul_f32 v238, v238, v29
  v_mul_f32 v239, v239, v29
  v_accvgpr_write_b32 a0, v224
  v_accvgpr_write_b32 a1, v225
  v_accvgpr_write_b32 a2, v226
  v_accvgpr_write_b32 a3, v227
  v_accvgpr_write_b32 a4, v228
  v_accvgpr_write_b32 a5, v229
  v_accvgpr_write_b32 a6, v230
  v_accvgpr_write_b32 a7, v231
  v_accvgpr_write_b32 a8, v232
  v_accvgpr_write_b32 a9, v233
  v_accvgpr_write_b32 a10, v234
  v_accvgpr_write_b32 a11, v235
  v_accvgpr_write_b32 a12, v236
  v_accvgpr_write_b32 a13, v237
  v_accvgpr_write_b32 a14, v238
  v_accvgpr_write_b32 a15, v239
  v_accvgpr_read_b32 v224, a16
  v_accvgpr_read_b32 v225, a17
  v_accvgpr_read_b32 v226, a18
  v_accvgpr_read_b32 v227, a19
  v_accvgpr_read_b32 v228, a20
  v_accvgpr_read_b32 v229, a21
  v_accvgpr_read_b32 v230, a22
  v_accvgpr_read_b32 v231, a23
  v_accvgpr_read_b32 v232, a24
  v_accvgpr_read_b32 v233, a25
  v_accvgpr_read_b32 v234, a26
  v_accvgpr_read_b32 v235, a27
  v_accvgpr_read_b32 v236, a28
  v_accvgpr_read_b32 v237, a29
  v_accvgpr_read_b32 v238, a30
  v_accvgpr_read_b32 v239, a31
  v_mul_f32 v224, v224, v29
  v_mul_f32 v225, v225, v29
  v_mul_f32 v226, v226, v29
  v_mul_f32 v227, v227, v29
  v_mul_f32 v228, v228, v29
  v_mul_f32 v229, v229, v29
  v_mul_f32 v230, v230, v29
  v_mul_f32 v231, v231, v29
  v_mul_f32 v232, v232, v29
  v_mul_f32 v233, v233, v29
  v_mul_f32 v234, v234, v29
  v_mul_f32 v235, v235, v29
  v_mul_f32 v236, v236, v29
  v_mul_f32 v237, v237, v29
  v_mul_f32 v238, v238, v29
  v_mul_f32 v239, v239, v29
  v_accvgpr_write_b32 a16, v224
  v_accvgpr_write_b32 a17, v225
  v_accvgpr_write_b32 a18, v226
  v_accvgpr_write_b32 a19, v227
  v_accvgpr_write_b32 a20, v228
  v_accvgpr_write_b32 a21, v229
  v_accvgpr_write_b32 a22, v230
  v_accvgpr_write_b32 a23, v231
  v_accvgpr_write_b32 a24, v232
  v_accvgpr_write_b32 a25, v233
  v_accvgpr_write_b32 a26, v234
  v_accvgpr_write_b32 a27, v235
  v_accvgpr_write_b32 a28, v236
  v_accvgpr_write_b32 a29, v237
  v_accvgpr_write_b32 a30, v238
  v_accvgpr_write_b32 a31, v239
  v_accvgpr_read_b32 v224, a32
  v_accvgpr_read_b32 v225, a33
  v_accvgpr_read_b32 v226, a34
  v_accvgpr_read_b32 v227, a35
  v_accvgpr_read_b32 v228, a36
  v_accvgpr_read_b32 v229, a37
  v_accvgpr_read_b32 v230, a38
  v_accvgpr_read_b32 v231, a39
  v_accvgpr_read_b32 v232, a40
  v_accvgpr_read_b32 v233, a41
  v_accvgpr_read_b32 v234, a42
  v_accvgpr_read_b32 v235, a43
  v_accvgpr_read_b32 v236, a44
  v_accvgpr_read_b32 v237, a45
  v_accvgpr_read_b32 v238, a46
  v_accvgpr_read_b32 v239, a47
  v_mul_f32 v224, v224, v29
  v_mul_f32 v225, v225, v29
  v_mul_f32 v226, v226, v29
  v_mul_f32 v227, v227, v29
  v_mul_f32 v228, v228, v29
  v_mul_f32 v229, v229, v29
  v_mul_f32 v230, v230, v29
  v_mul_f32 v231, v231, v29
  v_mul_f32 v232, v232, v29
  v_mul_f32 v233, v233, v29
  v_mul_f32 v234, v234, v29
  v_mul_f32 v235, v235, v29
  v_mul_f32 v236, v236, v29
  v_mul_f32 v237, v237, v29
  v_mul_f32 v238, v238, v29
  v_mul_f32 v239, v239, v29
  v_accvgpr_write_b32 a32, v224
  v_accvgpr_write_b32 a33, v225
  v_accvgpr_write_b32 a34, v226
  v_accvgpr_write_b32 a35, v227
  v_accvgpr_write_b32 a36, v228
  v_accvgpr_write_b32 a37, v229
  v_accvgpr_write_b32 a38, v230
  v_accvgpr_write_b32 a39, v231
  v_accvgpr_write_b32 a40, v232
  v_accvgpr_write_b32 a41, v233
  v_accvgpr_write_b32 a42, v234
  v_accvgpr_write_b32 a43, v235
  v_accvgpr_write_b32 a44, v236
  v_accvgpr_write_b32 a45, v237
  v_accvgpr_write_b32 a46, v238
  v_accvgpr_write_b32 a47, v239
  v_accvgpr_read_b32 v224, a48
  v_accvgpr_read_b32 v225, a49
  v_accvgpr_read_b32 v226, a50
  v_accvgpr_read_b32 v227, a51
  v_accvgpr_read_b32 v228, a52
  v_accvgpr_read_b32 v229, a53
  v_accvgpr_read_b32 v230, a54
  v_accvgpr_read_b32 v231, a55
  v_accvgpr_read_b32 v232, a56
  v_accvgpr_read_b32 v233, a57
  v_accvgpr_read_b32 v234, a58
  v_accvgpr_read_b32 v235, a59
  v_accvgpr_read_b32 v236, a60
  v_accvgpr_read_b32 v237, a61
  v_accvgpr_read_b32 v238, a62
  v_accvgpr_read_b32 v239, a63
  v_mul_f32 v224, v224, v29
  v_mul_f32 v225, v225, v29
  v_mul_f32 v226, v226, v29
  v_mul_f32 v227, v227, v29
  v_mul_f32 v228, v228, v29
  v_mul_f32 v229, v229, v29
  v_mul_f32 v230, v230, v29
  v_mul_f32 v231, v231, v29
  v_mul_f32 v232, v232, v29
  v_mul_f32 v233, v233, v29
  v_mul_f32 v234, v234, v29
  v_mul_f32 v235, v235, v29
  v_mul_f32 v236, v236, v29
  v_mul_f32 v237, v237, v29
  v_mul_f32 v238, v238, v29
  v_mul_f32 v239, v239, v29
  v_accvgpr_write_b32 a48, v224
  v_accvgpr_write_b32 a49, v225
  v_accvgpr_write_b32 a50, v226
  v_accvgpr_write_b32 a51, v227
  v_accvgpr_write_b32 a52, v228
  v_accvgpr_write_b32 a53, v229
  v_accvgpr_write_b32 a54, v230
  v_accvgpr_write_b32 a55, v231
  v_accvgpr_write_b32 a56, v232
  v_accvgpr_write_b32 a57, v233
  v_accvgpr_write_b32 a58, v234
  v_accvgpr_write_b32 a59, v235
  v_accvgpr_write_b32 a60, v236
  v_accvgpr_write_b32 a61, v237
  v_accvgpr_write_b32 a62, v238
  v_accvgpr_write_b32 a63, v239
  v_sub_f32 v224, v192, v30
  v_sub_f32 v225, v193, v30
  v_sub_f32 v226, v194, v30
  v_sub_f32 v227, v195, v30
  v_sub_f32 v228, v196, v30
  v_sub_f32 v229, v197, v30
  v_sub_f32 v230, v198, v30
  v_sub_f32 v231, v199, v30
  v_sub_f32 v232, v200, v30
  v_sub_f32 v233, v201, v30
  v_sub_f32 v234, v202, v30
  v_sub_f32 v235, v203, v30
  v_sub_f32 v236, v204, v30
  v_sub_f32 v237, v205, v30
  v_sub_f32 v238, v206, v30
  v_sub_f32 v239, v207, v30
  v_exp_f32 v224, v224
  v_exp_f32 v225, v225
  v_exp_f32 v226, v226
  v_exp_f32 v227, v227
  v_exp_f32 v228, v228
  v_exp_f32 v229, v229
  v_exp_f32 v230, v230
  v_exp_f32 v231, v231
  v_exp_f32 v232, v232
  v_exp_f32 v233, v233
  v_exp_f32 v234, v234
  v_exp_f32 v235, v235
  v_exp_f32 v236, v236
  v_exp_f32 v237, v237
  v_exp_f32 v238, v238
  v_exp_f32 v239, v239
  v_add_f32 v28, v224, v225
  v_add_f32 v29, v226, v227
  v_add_f32 v28, v28, v228
  v_add_f32 v29, v29, v229
  v_add_f32 v28, v28, v230
  v_add_f32 v29, v29, v231
  v_add_f32 v28, v28, v232
  v_add_f32 v29, v29, v233
  v_add_f32 v28, v28, v234
  v_add_f32 v29, v29, v235
  v_add_f32 v28, v28, v236
  v_add_f32 v29, v29, v237
  v_add_f32 v28, v28, v238
  v_add_f32 v29, v29, v239
  v_cvt_pk_bf16_f32 v240, v224, v225
  v_cvt_pk_bf16_f32 v241, v226, v227
  v_cvt_pk_bf16_f32 v242, v228, v229
  v_cvt_pk_bf16_f32 v243, v230, v231
  v_cvt_pk_bf16_f32 v244, v232, v233
  v_cvt_pk_bf16_f32 v245, v234, v235
  v_cvt_pk_bf16_f32 v246, v236, v237
  v_cvt_pk_bf16_f32 v247, v238, v239
  v_add_f32 v28, v28, v29
  s_nop 3
  s_setpc_b64 s[56:57]
L_rare_1_1_1:
  s_nop 7
  s_nop 7
  v_max3_f32 v28, v208, v209, v210
  v_max3_f32 v29, v211, v212, v213
  v_max3_f32 v28, v28, v214, v215
  v_max3_f32 v29, v29, v216, v217
  v_max3_f32 v28, v28, v218, v219
  v_max3_f32 v29, v29, v220, v221
  v_max3_f32 v28, v28, v222, v223
  v_max_f32 v28, v28, v29
  v_mov_b32 v29, v28
  s_nop 1
  v_permlane32_swap_b32 v28, v29
  v_max_f32 v28, v28, v29
  v_max_f32 v30, 0, v28
  v_sub_f32 v29, 0, v30
  v_exp_f32 v29, v29
  v_sub_f32 v176, v176, v30
  v_sub_f32 v177, v177, v30
  v_sub_f32 v178, v178, v30
  v_sub_f32 v179, v179, v30
  v_sub_f32 v180, v180, v30
  v_sub_f32 v181, v181, v30
  v_sub_f32 v182, v182, v30
  v_sub_f32 v183, v183, v30
  v_sub_f32 v184, v184, v30
  v_sub_f32 v185, v185, v30
  v_sub_f32 v186, v186, v30
  v_sub_f32 v187, v187, v30
  v_sub_f32 v188, v188, v30
  v_sub_f32 v189, v189, v30
  v_sub_f32 v190, v190, v30
  v_sub_f32 v191, v191, v30
  v_mul_f32 v26, v26, v29
  v_accvgpr_read_b32 v224, a64
  v_accvgpr_read_b32 v225, a65
  v_accvgpr_read_b32 v226, a66
  v_accvgpr_read_b32 v227, a67
  v_accvgpr_read_b32 v228, a68
  v_accvgpr_read_b32 v229, a69
  v_accvgpr_read_b32 v230, a70
  v_accvgpr_read_b32 v231, a71
  v_accvgpr_read_b32 v232, a72
  v_accvgpr_read_b32 v233, a73
  v_accvgpr_read_b32 v234, a74
  v_accvgpr_read_b32 v235, a75
  v_accvgpr_read_b32 v236, a76
  v_accvgpr_read_b32 v237, a77
  v_accvgpr_read_b32 v238, a78
  v_accvgpr_read_b32 v239, a79
  v_mul_f32 v224, v224, v29
  v_mul_f32 v225, v225, v29
  v_mul_f32 v226, v226, v29
  v_mul_f32 v227, v227, v29
  v_mul_f32 v228, v228, v29
  v_mul_f32 v229, v229, v29
  v_mul_f32 v230, v230, v29
  v_mul_f32 v231, v231, v29
  v_mul_f32 v232, v232, v29
  v_mul_f32 v233, v233, v29
  v_mul_f32 v234, v234, v29
  v_mul_f32 v235, v235, v29
  v_mul_f32 v236, v236, v29
  v_mul_f32 v237, v237, v29
  v_mul_f32 v238, v238, v29
  v_mul_f32 v239, v239, v29
  v_accvgpr_write_b32 a64, v224
  v_accvgpr_write_b32 a65, v225
  v_accvgpr_write_b32 a66, v226
  v_accvgpr_write_b32 a67, v227
  v_accvgpr_write_b32 a68, v228
  v_accvgpr_write_b32 a69, v229
  v_accvgpr_write_b32 a70, v230
  v_accvgpr_write_b32 a71, v231
  v_accvgpr_write_b32 a72, v232
  v_accvgpr_write_b32 a73, v233
  v_accvgpr_write_b32 a74, v234
  v_accvgpr_write_b32 a75, v235
  v_accvgpr_write_b32 a76, v236
  v_accvgpr_write_b32 a77, v237
  v_accvgpr_write_b32 a78, v238
  v_accvgpr_write_b32 a79, v239
  v_accvgpr_read_b32 v224, a80
  v_accvgpr_read_b32 v225, a81
  v_accvgpr_read_b32 v226, a82
  v_accvgpr_read_b32 v227, a83
  v_accvgpr_read_b32 v228, a84
  v_accvgpr_read_b32 v229, a85
  v_accvgpr_read_b32 v230, a86
  v_accvgpr_read_b32 v231, a87
  v_accvgpr_read_b32 v232, a88
  v_accvgpr_read_b32 v233, a89
  v_accvgpr_read_b32 v234, a90
  v_accvgpr_read_b32 v235, a91
  v_accvgpr_read_b32 v236, a92
  v_accvgpr_read_b32 v237, a93
  v_accvgpr_read_b32 v238, a94
  v_accvgpr_read_b32 v239, a95
  v_mul_f32 v224, v224, v29
  v_mul_f32 v225, v225, v29
  v_mul_f32 v226, v226, v29
  v_mul_f32 v227, v227, v29
  v_mul_f32 v228, v228, v29
  v_mul_f32 v229, v229, v29
  v_mul_f32 v230, v230, v29
  v_mul_f32 v231, v231, v29
  v_mul_f32 v232, v232, v29
  v_mul_f32 v233, v233, v29
  v_mul_f32 v234, v234, v29
  v_mul_f32 v235, v235, v29
  v_mul_f32 v236, v236, v29
  v_mul_f32 v237, v237, v29
  v_mul_f32 v238, v238, v29
  v_mul_f32 v239, v239, v29
  v_accvgpr_write_b32 a80, v224
  v_accvgpr_write_b32 a81, v225
  v_accvgpr_write_b32 a82, v226
  v_accvgpr_write_b32 a83, v227
  v_accvgpr_write_b32 a84, v228
  v_accvgpr_write_b32 a85, v229
  v_accvgpr_write_b32 a86, v230
  v_accvgpr_write_b32 a87, v231
  v_accvgpr_write_b32 a88, v232
  v_accvgpr_write_b32 a89, v233
  v_accvgpr_write_b32 a90, v234
  v_accvgpr_write_b32 a91, v235
  v_accvgpr_write_b32 a92, v236
  v_accvgpr_write_b32 a93, v237
  v_accvgpr_write_b32 a94, v238
  v_accvgpr_write_b32 a95, v239
  v_accvgpr_read_b32 v224, a96
  v_accvgpr_read_b32 v225, a97
  v_accvgpr_read_b32 v226, a98
  v_accvgpr_read_b32 v227, a99
  v_accvgpr_read_b32 v228, a100
  v_accvgpr_read_b32 v229, a101
  v_accvgpr_read_b32 v230, a102
  v_accvgpr_read_b32 v231, a103
  v_accvgpr_read_b32 v232, a104
  v_accvgpr_read_b32 v233, a105
  v_accvgpr_read_b32 v234, a106
  v_accvgpr_read_b32 v235, a107
  v_accvgpr_read_b32 v236, a108
  v_accvgpr_read_b32 v237, a109
  v_accvgpr_read_b32 v238, a110
  v_accvgpr_read_b32 v239, a111
  v_mul_f32 v224, v224, v29
  v_mul_f32 v225, v225, v29
  v_mul_f32 v226, v226, v29
  v_mul_f32 v227, v227, v29
  v_mul_f32 v228, v228, v29
  v_mul_f32 v229, v229, v29
  v_mul_f32 v230, v230, v29
  v_mul_f32 v231, v231, v29
  v_mul_f32 v232, v232, v29
  v_mul_f32 v233, v233, v29
  v_mul_f32 v234, v234, v29
  v_mul_f32 v235, v235, v29
  v_mul_f32 v236, v236, v29
  v_mul_f32 v237, v237, v29
  v_mul_f32 v238, v238, v29
  v_mul_f32 v239, v239, v29
  v_accvgpr_write_b32 a96, v224
  v_accvgpr_write_b32 a97, v225
  v_accvgpr_write_b32 a98, v226
  v_accvgpr_write_b32 a99, v227
  v_accvgpr_write_b32 a100, v228
  v_accvgpr_write_b32 a101, v229
  v_accvgpr_write_b32 a102, v230
  v_accvgpr_write_b32 a103, v231
  v_accvgpr_write_b32 a104, v232
  v_accvgpr_write_b32 a105, v233
  v_accvgpr_write_b32 a106, v234
  v_accvgpr_write_b32 a107, v235
  v_accvgpr_write_b32 a108, v236
  v_accvgpr_write_b32 a109, v237
  v_accvgpr_write_b32 a110, v238
  v_accvgpr_write_b32 a111, v239
  v_accvgpr_read_b32 v224, a112
  v_accvgpr_read_b32 v225, a113
  v_accvgpr_read_b32 v226, a114
  v_accvgpr_read_b32 v227, a115
  v_accvgpr_read_b32 v228, a116
  v_accvgpr_read_b32 v229, a117
  v_accvgpr_read_b32 v230, a118
  v_accvgpr_read_b32 v231, a119
  v_accvgpr_read_b32 v232, a120
  v_accvgpr_read_b32 v233, a121
  v_accvgpr_read_b32 v234, a122
  v_accvgpr_read_b32 v235, a123
  v_accvgpr_read_b32 v236, a124
  v_accvgpr_read_b32 v237, a125
  v_accvgpr_read_b32 v238, a126
  v_accvgpr_read_b32 v239, a127
  v_mul_f32 v224, v224, v29
  v_mul_f32 v225, v225, v29
  v_mul_f32 v226, v226, v29
  v_mul_f32 v227, v227, v29
  v_mul_f32 v228, v228, v29
  v_mul_f32 v229, v229, v29
  v_mul_f32 v230, v230, v29
  v_mul_f32 v231, v231, v29
  v_mul_f32 v232, v232, v29
  v_mul_f32 v233, v233, v29
  v_mul_f32 v234, v234, v29
  v_mul_f32 v235, v235, v29
  v_mul_f32 v236, v236, v29
  v_mul_f32 v237, v237, v29
  v_mul_f32 v238, v238, v29
  v_mul_f32 v239, v239, v29
  v_accvgpr_write_b32 a112, v224
  v_accvgpr_write_b32 a113, v225
  v_accvgpr_write_b32 a114, v226
  v_accvgpr_write_b32 a115, v227
  v_accvgpr_write_b32 a116, v228
  v_accvgpr_write_b32 a117, v229
  v_accvgpr_write_b32 a118, v230
  v_accvgpr_write_b32 a119, v231
  v_accvgpr_write_b32 a120, v232
  v_accvgpr_write_b32 a121, v233
  v_accvgpr_write_b32 a122, v234
  v_accvgpr_write_b32 a123, v235
  v_accvgpr_write_b32 a124, v236
  v_accvgpr_write_b32 a125, v237
  v_accvgpr_write_b32 a126, v238
  v_accvgpr_write_b32 a127, v239
  v_sub_f32 v224, v208, v30
  v_sub_f32 v225, v209, v30
  v_sub_f32 v226, v210, v30
  v_sub_f32 v227, v211, v30
  v_sub_f32 v228, v212, v30
  v_sub_f32 v229, v213, v30
  v_sub_f32 v230, v214, v30
  v_sub_f32 v231, v215, v30
  v_sub_f32 v232, v216, v30
  v_sub_f32 v233, v217, v30
  v_sub_f32 v234, v218, v30
  v_sub_f32 v235, v219, v30
  v_sub_f32 v236, v220, v30
  v_sub_f32 v237, v221, v30
  v_sub_f32 v238, v222, v30
  v_sub_f32 v239, v223, v30
  v_exp_f32 v224, v224
  v_exp_f32 v225, v225
  v_exp_f32 v226, v226
  v_exp_f32 v227, v227
  v_exp_f32 v228, v228
  v_exp_f32 v229, v229
  v_exp_f32 v230, v230
  v_exp_f32 v231, v231
  v_exp_f32 v232, v232
  v_exp_f32 v233, v233
  v_exp_f32 v234, v234
  v_exp_f32 v235, v235
  v_exp_f32 v236, v236
  v_exp_f32 v237, v237
  v_exp_f32 v238, v238
  v_exp_f32 v239, v239
  v_add_f32 v28, v224, v225
  v_add_f32 v29, v226, v227
  v_add_f32 v28, v28, v228
  v_add_f32 v29, v29, v229
  v_add_f32 v28, v28, v230
  v_add_f32 v29, v29, v231
  v_add_f32 v28, v28, v232
  v_add_f32 v29, v29, v233
  v_add_f32 v28, v28, v234
  v_add_f32 v29, v29, v235
  v_add_f32 v28, v28, v236
  v_add_f32 v29, v29, v237
  v_add_f32 v28, v28, v238
  v_add_f32 v29, v29, v239
  v_cvt_pk_bf16_f32 v248, v224, v225
  v_cvt_pk_bf16_f32 v249, v226, v227
  v_cvt_pk_bf16_f32 v250, v228, v229
  v_cvt_pk_bf16_f32 v251, v230, v231
  v_cvt_pk_bf16_f32 v252, v232, v233
  v_cvt_pk_bf16_f32 v253, v234, v235
  v_cvt_pk_bf16_f32 v254, v236, v237
  v_cvt_pk_bf16_f32 v255, v238, v239
  v_add_f32 v28, v28, v29
  s_nop 3
  s_setpc_b64 s[56:57]
L_rare_2_0_0:
  s_nop 7
  s_nop 7
  v_max3_f32 v28, v192, v193, v194
  v_max3_f32 v29, v195, v196, v197
  v_max3_f32 v28, v28, v198, v199
  v_max3_f32 v29, v29, v200, v201
  v_max3_f32 v28, v28, v202, v203
  v_max3_f32 v29, v29, v204, v205
  v_max3_f32 v28, v28, v206, v207
  v_max_f32 v28, v28, v29
  v_mov_b32 v29, v28
  s_nop 1
  v_permlane32_swap_b32 v28, v29
  v_max_f32 v28, v28, v29
  v_max_f32 v30, 0, v28
  v_sub_f32 v29, 0, v30
  v_exp_f32 v29, v29
  v_sub_f32 v96, v96, v30
  v_sub_f32 v97, v97, v30
  v_sub_f32 v98, v98, v30
  v_sub_f32 v99, v99, v30
  v_sub_f32 v100, v100, v30
  v_sub_f32 v101, v101, v30
  v_sub_f32 v102, v102, v30
  v_sub_f32 v103, v103, v30
  v_sub_f32 v104, v104, v30
  v_sub_f32 v105, v105, v30
  v_sub_f32 v106, v106, v30
  v_sub_f32 v107, v107, v30
  v_sub_f32 v108, v108, v30
  v_sub_f32 v109, v109, v30
  v_sub_f32 v110, v110, v30
  v_sub_f32 v111, v111, v30
  v_mul_f32 v27, v27, v29
  v_accvgpr_read_b32 v224, a128
  v_accvgpr_read_b32 v225, a129
  v_accvgpr_read_b32 v226, a130
  v_accvgpr_read_b32 v227, a131
  v_accvgpr_read_b32 v228, a132
  v_accvgpr_read_b32 v229, a133
  v_accvgpr_read_b32 v230, a134
  v_accvgpr_read_b32 v231, a135
  v_accvgpr_read_b32 v232, a136
  v_accvgpr_read_b32 v233, a137
  v_accvgpr_read_b32 v234, a138
  v_accvgpr_read_b32 v235, a139
  v_accvgpr_read_b32 v236, a140
  v_accvgpr_read_b32 v237, a141
  v_accvgpr_read_b32 v238, a142
  v_accvgpr_read_b32 v239, a143
  v_mul_f32 v224, v224, v29
  v_mul_f32 v225, v225, v29
  v_mul_f32 v226, v226, v29
  v_mul_f32 v227, v227, v29
  v_mul_f32 v228, v228, v29
  v_mul_f32 v229, v229, v29
  v_mul_f32 v230, v230, v29
  v_mul_f32 v231, v231, v29
  v_mul_f32 v232, v232, v29
  v_mul_f32 v233, v233, v29
  v_mul_f32 v234, v234, v29
  v_mul_f32 v235, v235, v29
  v_mul_f32 v236, v236, v29
  v_mul_f32 v237, v237, v29
  v_mul_f32 v238, v238, v29
  v_mul_f32 v239, v239, v29
  v_accvgpr_write_b32 a128, v224
  v_accvgpr_write_b32 a129, v225
  v_accvgpr_write_b32 a130, v226
  v_accvgpr_write_b32 a131, v227
  v_accvgpr_write_b32 a132, v228
  v_accvgpr_write_b32 a133, v229
  v_accvgpr_write_b32 a134, v230
  v_accvgpr_write_b32 a135, v231
  v_accvgpr_write_b32 a136, v232
  v_accvgpr_write_b32 a137, v233
  v_accvgpr_write_b32 a138, v234
  v_accvgpr_write_b32 a139, v235
  v_accvgpr_write_b32 a140, v236
  v_accvgpr_write_b32 a141, v237
  v_accvgpr_write_b32 a142, v238
  v_accvgpr_write_b32 a143, v239
  v_accvgpr_read_b32 v224, a144
  v_accvgpr_read_b32 v225, a145
  v_accvgpr_read_b32 v226, a146
  v_accvgpr_read_b32 v227, a147
  v_accvgpr_read_b32 v228, a148
  v_accvgpr_read_b32 v229, a149
  v_accvgpr_read_b32 v230, a150
  v_accvgpr_read_b32 v231, a151
  v_accvgpr_read_b32 v232, a152
  v_accvgpr_read_b32 v233, a153
  v_accvgpr_read_b32 v234, a154
  v_accvgpr_read_b32 v235, a155
  v_accvgpr_read_b32 v236, a156
  v_accvgpr_read_b32 v237, a157
  v_accvgpr_read_b32 v238, a158
  v_accvgpr_read_b32 v239, a159
  v_mul_f32 v224, v224, v29
  v_mul_f32 v225, v225, v29
  v_mul_f32 v226, v226, v29
  v_mul_f32 v227, v227, v29
  v_mul_f32 v228, v228, v29
  v_mul_f32 v229, v229, v29
  v_mul_f32 v230, v230, v29
  v_mul_f32 v231, v231, v29
  v_mul_f32 v232, v232, v29
  v_mul_f32 v233, v233, v29
  v_mul_f32 v234, v234, v29
  v_mul_f32 v235, v235, v29
  v_mul_f32 v236, v236, v29
  v_mul_f32 v237, v237, v29
  v_mul_f32 v238, v238, v29
  v_mul_f32 v239, v239, v29
  v_accvgpr_write_b32 a144, v224
  v_accvgpr_write_b32 a145, v225
  v_accvgpr_write_b32 a146, v226
  v_accvgpr_write_b32 a147, v227
  v_accvgpr_write_b32 a148, v228
  v_accvgpr_write_b32 a149, v229
  v_accvgpr_write_b32 a150, v230
  v_accvgpr_write_b32 a151, v231
  v_accvgpr_write_b32 a152, v232
  v_accvgpr_write_b32 a153, v233
  v_accvgpr_write_b32 a154, v234
  v_accvgpr_write_b32 a155, v235
  v_accvgpr_write_b32 a156, v236
  v_accvgpr_write_b32 a157, v237
  v_accvgpr_write_b32 a158, v238
  v_accvgpr_write_b32 a159, v239
  v_accvgpr_read_b32 v224, a160
  v_accvgpr_read_b32 v225, a161
  v_accvgpr_read_b32 v226, a162
  v_accvgpr_read_b32 v227, a163
  v_accvgpr_read_b32 v228, a164
  v_accvgpr_read_b32 v229, a165
  v_accvgpr_read_b32 v230, a166
  v_accvgpr_read_b32 v231, a167
  v_accvgpr_read_b32 v232, a168
  v_accvgpr_read_b32 v233, a169
  v_accvgpr_read_b32 v234, a170
  v_accvgpr_read_b32 v235, a171
  v_accvgpr_read_b32 v236, a172
  v_accvgpr_read_b32 v237, a173
  v_accvgpr_read_b32 v238, a174
  v_accvgpr_read_b32 v239, a175
  v_mul_f32 v224, v224, v29
  v_mul_f32 v225, v225, v29
  v_mul_f32 v226, v226, v29
  v_mul_f32 v227, v227, v29
  v_mul_f32 v228, v228, v29
  v_mul_f32 v229, v229, v29
  v_mul_f32 v230, v230, v29
  v_mul_f32 v231, v231, v29
  v_mul_f32 v232, v232, v29
  v_mul_f32 v233, v233, v29
  v_mul_f32 v234, v234, v29
  v_mul_f32 v235, v235, v29
  v_mul_f32 v236, v236, v29
  v_mul_f32 v237, v237, v29
  v_mul_f32 v238, v238, v29
  v_mul_f32 v239, v239, v29
  v_accvgpr_write_b32 a160, v224
  v_accvgpr_write_b32 a161, v225
  v_accvgpr_write_b32 a162, v226
  v_accvgpr_write_b32 a163, v227
  v_accvgpr_write_b32 a164, v228
  v_accvgpr_write_b32 a165, v229
  v_accvgpr_write_b32 a166, v230
  v_accvgpr_write_b32 a167, v231
  v_accvgpr_write_b32 a168, v232
  v_accvgpr_write_b32 a169, v233
  v_accvgpr_write_b32 a170, v234
  v_accvgpr_write_b32 a171, v235
  v_accvgpr_write_b32 a172, v236
  v_accvgpr_write_b32 a173, v237
  v_accvgpr_write_b32 a174, v238
  v_accvgpr_write_b32 a175, v239
  v_accvgpr_read_b32 v224, a176
  v_accvgpr_read_b32 v225, a177
  v_accvgpr_read_b32 v226, a178
  v_accvgpr_read_b32 v227, a179
  v_accvgpr_read_b32 v228, a180
  v_accvgpr_read_b32 v229, a181
  v_accvgpr_read_b32 v230, a182
  v_accvgpr_read_b32 v231, a183
  v_accvgpr_read_b32 v232, a184
  v_accvgpr_read_b32 v233, a185
  v_accvgpr_read_b32 v234, a186
  v_accvgpr_read_b32 v235, a187
  v_accvgpr_read_b32 v236, a188
  v_accvgpr_read_b32 v237, a189
  v_accvgpr_read_b32 v238, a190
  v_accvgpr_read_b32 v239, a191
  v_mul_f32 v224, v224, v29
  v_mul_f32 v225, v225, v29
  v_mul_f32 v226, v226, v29
  v_mul_f32 v227, v227, v29
  v_mul_f32 v228, v228, v29
  v_mul_f32 v229, v229, v29
  v_mul_f32 v230, v230, v29
  v_mul_f32 v231, v231, v29
  v_mul_f32 v232, v232, v29
  v_mul_f32 v233, v233, v29
  v_mul_f32 v234, v234, v29
  v_mul_f32 v235, v235, v29
  v_mul_f32 v236, v236, v29
  v_mul_f32 v237, v237, v29
  v_mul_f32 v238, v238, v29
  v_mul_f32 v239, v239, v29
  v_accvgpr_write_b32 a176, v224
  v_accvgpr_write_b32 a177, v225
  v_accvgpr_write_b32 a178, v226
  v_accvgpr_write_b32 a179, v227
  v_accvgpr_write_b32 a180, v228
  v_accvgpr_write_b32 a181, v229
  v_accvgpr_write_b32 a182, v230
  v_accvgpr_write_b32 a183, v231
  v_accvgpr_write_b32 a184, v232
  v_accvgpr_write_b32 a185, v233
  v_accvgpr_write_b32 a186, v234
  v_accvgpr_write_b32 a187, v235
  v_accvgpr_write_b32 a188, v236
  v_accvgpr_write_b32 a189, v237
  v_accvgpr_write_b32 a190, v238
  v_accvgpr_write_b32 a191, v239
  v_sub_f32 v224, v192, v30
  v_sub_f32 v225, v193, v30
  v_sub_f32 v226, v194, v30
  v_sub_f32 v227, v195, v30
  v_sub_f32 v228, v196, v30
  v_sub_f32 v229, v197, v30
  v_sub_f32 v230, v198, v30
  v_sub_f32 v231, v199, v30
  v_sub_f32 v232, v200, v30
  v_sub_f32 v233, v201, v30
  v_sub_f32 v234, v202, v30
  v_sub_f32 v235, v203, v30
  v_sub_f32 v236, v204, v30
  v_sub_f32 v237, v205, v30
  v_sub_f32 v238, v206, v30
  v_sub_f32 v239, v207, v30
  v_exp_f32 v224, v224
  v_exp_f32 v225, v225
  v_exp_f32 v226, v226
  v_exp_f32 v227, v227
  v_exp_f32 v228, v228
  v_exp_f32 v229, v229
  v_exp_f32 v230, v230
  v_exp_f32 v231, v231
  v_exp_f32 v232, v232
  v_exp_f32 v233, v233
  v_exp_f32 v234, v234
  v_exp_f32 v235, v235
  v_exp_f32 v236, v236
  v_exp_f32 v237, v237
  v_exp_f32 v238, v238
  v_exp_f32 v239, v239
  v_add_f32 v28, v224, v225
  v_add_f32 v29, v226, v227
  v_add_f32 v28, v28, v228
  v_add_f32 v29, v29, v229
  v_add_f32 v28, v28, v230
  v_add_f32 v29, v29, v231
  v_add_f32 v28, v28, v232
  v_add_f32 v29, v29, v233
  v_add_f32 v28, v28, v234
  v_add_f32 v29, v29, v235
  v_add_f32 v28, v28, v236
  v_add_f32 v29, v29, v237
  v_add_f32 v28, v28, v238
  v_add_f32 v29, v29, v239
  v_cvt_pk_bf16_f32 v240, v224, v225
  v_cvt_pk_bf16_f32 v241, v226, v227
  v_cvt_pk_bf16_f32 v242, v228, v229
  v_cvt_pk_bf16_f32 v243, v230, v231
  v_cvt_pk_bf16_f32 v244, v232, v233
  v_cvt_pk_bf16_f32 v245, v234, v235
  v_cvt_pk_bf16_f32 v246, v236, v237
  v_cvt_pk_bf16_f32 v247, v238, v239
  v_add_f32 v28, v28, v29
  s_nop 3
  s_setpc_b64 s[56:57]
L_cend:
.section .rodata,"a"
.p2align 6
.amdhsa_kernel standalone__gqa_block_cached__near_ridge_kernel
  .amdhsa_next_free_vgpr 512
  .amdhsa_next_free_sgpr 102
  .amdhsa_accum_offset 256
  .amdhsa_group_segment_fixed_size 0
  .amdhsa_kernarg_size 64
  .amdhsa_user_sgpr_count 2
  .amdhsa_user_sgpr_kernarg_segment_ptr 1
  .amdhsa_system_sgpr_workgroup_id_x 1
.end_amdhsa_kernel
```
